```python
import torch

def _softmax(x, axis=-1):
    return torch.softmax(x, dim=axis)

def _gelu(x):
    return torch.nn.functional.gelu(x, approximate='tanh')

def _silu(x):
    return torch.nn.functional.silu(x)

def _sigmoid(x):
    return torch.sigmoid(x)

def _layernorm(x, axis=-1, eps=1e-05):
    m = x.mean(dim=axis, keepdim=True)
    v = x.var(dim=axis, keepdim=True, unbiased=False)
    return (x - m) / torch.sqrt(v + eps)

def _scatter_add(tgt, idx, src, axis=0):
    return tgt.clone().index_add_(axis, idx, src)

def _segment_sum(src, seg, n):
    out = torch.zeros((n,) + src.shape[1:], dtype=src.dtype)
    return out.index_add_(0, seg, src)

def _pad(x, pw):
    flat = tuple((v for pair in reversed(pw) for v in pair))
    return torch.nn.functional.pad(x, flat)
kernel_name = 'interleave_layers__memory_aug_recurrent_mem_tr__spectral_gfnet__prompt'

def setup_inputs():

    _w = lambda a: (lambda t: t.to(torch.bfloat16) if t.is_floating_point() else t)(torch.as_tensor(a))

    def _A_setup():
        B, S, Dm = (1, 2048, 576)
        H, Dh = (32, 128)
        M, seg = (8, 32)
        seg = min(seg, S)
        S = S // seg * seg
        return {'x': _w((lambda *s: torch.randn(*s, dtype=torch.bfloat16) * 0.05)(B, S, Dm)), 'mem0': _w((lambda *s: torch.randn(*s, dtype=torch.bfloat16) * 0.2)(B, M, Dm)), 'Wq': _w((lambda *s: torch.randn(*s, dtype=torch.bfloat16) * 1.6)(Dm, H, Dh) * Dm ** (-0.5)), 'Wk': _w((lambda *s: torch.randn(*s, dtype=torch.bfloat16) * 1.6)(Dm, H, Dh) * Dm ** (-0.5)), 'Wv': _w((lambda *s: torch.randn(*s, dtype=torch.bfloat16) * 0.2)(Dm, H, Dh) * Dm ** (-0.5)), 'Wo': _w((lambda *s: torch.randn(*s, dtype=torch.bfloat16) * 0.2)(H, Dh, Dm) * (H * Dh) ** (-0.5)), 'seg_len': seg}
    _A_in = _A_setup()

    def _B_setup():
        B, S, D = (1, 2048, 576)
        Df = D // 2 + 1
        return {'x': _w((lambda *s: torch.randn(*s, dtype=torch.bfloat16) * 0.05)(B, S, D)), 'w_r': _w((lambda *s: torch.randn(*s, dtype=torch.bfloat16) * 0.4)(S, Df) * 0.02), 'w_i': _w((lambda *s: torch.randn(*s, dtype=torch.bfloat16) * 0.4)(S, Df) * 0.02)}
    _B_in = _B_setup()
    return {'A_x': _A_in['x'], 'A_mem0': _A_in['mem0'], 'A_Wq': _A_in['Wq'], 'A_Wk': _A_in['Wk'], 'A_Wv': _A_in['Wv'], 'A_Wo': _A_in['Wo'], 'A_seg_len': _A_in['seg_len'], 'B_x': _B_in['x'], 'B_w_r': _B_in['w_r'], 'B_w_i': _B_in['w_i']}

def reference(A_x, A_mem0, A_Wq, A_Wk, A_Wv, A_Wo, A_seg_len, B_x, B_w_r, B_w_i):

    def _A_ref(x, mem0, Wq, Wk, Wv, Wo, seg_len):
        B, S, Dm = x.shape
        H, Dh = (Wq.shape[1], Wq.shape[2])
        M = mem0.shape[1]
        scale = Dh ** (-0.5)
        n_seg = S // seg_len
        L = M + seg_len
        idx = torch.arange(L)
        mask = (idx[:, None] < M) | (idx[:, None] >= idx[None, :])
        mem = mem0
        outs = []
        for s in range(n_seg):
            xs = x[:, s * seg_len:(s + 1) * seg_len, :].clone()
            h = torch.concatenate([mem, xs], axis=1)
            q = torch.einsum('btd,dhe->bhte', h, Wq)
            k = torch.einsum('btd,dhe->bhte', h, Wk)
            v = torch.einsum('btd,dhe->bhte', h, Wv)
            scores = torch.einsum('bhqe,bhke->bhqk', q, k) * scale
            scores = torch.where(mask[None, None], scores, -1000000000.0)
            p = _softmax(scores, axis=-1)
            o = torch.einsum('bhqk,bhke->bhqe', p, v)
            o = torch.einsum('bhte,hed->btd', o, Wo)
            mem = o[:, :M, :].clone()
            outs.append(o[:, M:, :])
        return torch.concatenate(outs, axis=1)

    def _B_ref(x, w_r, w_i):
        B, S, D = x.shape
        X = (lambda x, axes=(-2, -1): torch.fft.rfft2(x.float(), dim=axes))(x, axes=(-2, -1))
        W = w_r + 1j * w_i
        X = X * W
        y = (lambda x, s, axes=(-2, -1): torch.fft.irfft2(x, s=s, dim=axes).to(torch.bfloat16))(X, (S, D), axes=(-2, -1))
        return y
    x = A_x
    x = x + _A_ref(_layernorm(x, axis=-1), A_mem0, A_Wq, A_Wk, A_Wv, A_Wo, A_seg_len)
    x = x + _B_ref(_layernorm(x, axis=-1), B_w_r, B_w_i)
    x = x + _A_ref(_layernorm(x, axis=-1), A_mem0, A_Wq, A_Wk, A_Wv, A_Wo, A_seg_len)
    x = x + _B_ref(_layernorm(x, axis=-1), B_w_r, B_w_i)
    return x
```

```asm
; @launch grid=(256,1,1) block=(256,1,1) lds=163840
.amdgcn_target "amdgcn-amd-amdhsa--gfx950"
.text
.globl interleave_layers__memory_aug_recurrent_mem_tr__spectral_gfnet__prompt_kernel
.p2align 8
.type interleave_layers__memory_aug_recurrent_mem_tr__spectral_gfnet__prompt_kernel,@function
interleave_layers__memory_aug_recurrent_mem_tr__spectral_gfnet__prompt_kernel:
    s_cmp_ge_u32 s2, 256
    s_cbranch_scc1 M_end
    s_load_dwordx2 s[16:17], s[0:1], 96
    s_load_dwordx2 s[28:29], s[0:1], 88
    s_load_dwordx2 s[18:19], s[0:1], 0
    s_load_dwordx4 s[8:11], s[0:1], 16
    s_load_dwordx4 s[12:15], s[0:1], 32
    s_getpc_b64 s[30:31]
    v_lshlrev_b32 v63, 7, v0
    global_load_dword v64, v63, s[30:31]
    v_add_u32 v63, 32768, v63
    v_min_u32 v63, M_L5_end-M_A, v63
    global_load_dword v64, v63, s[30:31]
    s_getreg_b32 s3, hwreg(HW_REG_XCC_ID, 0, 4)
    v_lshrrev_b32 v1, 6, v0
    v_and_b32 v0, 63, v0
    v_readfirstlane_b32 s5, v1
    s_mov_b32 s94, 400000
    s_mov_b32 s90, 0
    s_mov_b32 s91, 0
    s_mov_b32 s92, 0
    s_mov_b32 s93, 0
    s_waitcnt lgkmcnt(0)
    s_mov_b32 s20, s16
    s_and_b32 s21, s17, 0xffff
    s_mov_b32 s22, 268435456
    s_mov_b32 s23, 0x00020000
    s_mov_b32 s84, s16
    s_and_b32 s85, s17, 0xffff
    s_mov_b32 s86, 268435456
    s_mov_b32 s87, 0x00020000
    s_mov_b32 s95, 0
    s_mov_b32 s24, s18
    s_and_b32 s25, s19, 0xffff
    s_mov_b32 s26, 2359296
    s_mov_b32 s27, 0x00020000
    s_mov_b32 s64, s8
    s_and_b32 s65, s9, 0xffff
    s_mov_b32 s66, 4718592
    s_mov_b32 s67, 0x00020000
    s_mov_b32 s68, s10
    s_and_b32 s69, s11, 0xffff
    s_mov_b32 s70, 4718592
    s_mov_b32 s71, 0x00020000
    s_mov_b32 s72, s12
    s_and_b32 s73, s13, 0xffff
    s_mov_b32 s74, 4718592
    s_mov_b32 s75, 0x00020000
    s_mov_b32 s76, s14
    s_and_b32 s77, s15, 0xffff
    s_mov_b32 s78, 4718592
    s_mov_b32 s79, 0x00020000
    v_mov_b32 v4, 15360
    s_lshl_b32 s6, s3, 2
    s_lshr_b32 s6, 0x43210765, s6
    s_and_b32 s6, s6, 7
    s_cmp_lt_u32 s3, 8
    s_cselect_b32 s3, s6, 7
    s_cmp_lg_u32 s5, 0
    s_cbranch_scc1 M_el_pf
    s_lshl_b32 s6, s3, 2
    s_cselect_b32 s6, s6, 128
    v_mov_b32 v2, s6
    v_mov_b32 v3, 1
    s_mov_b64 exec, 1
    global_atomic_add v5, v2, v3, s[28:29] sc0
    s_mov_b64 exec, -1
    s_waitcnt vmcnt(0)
    v_readfirstlane_b32 s7, v5
    s_lshl_b32 s4, s3, 5
    s_add_u32 s4, s4, s7
    s_cmp_lt_u32 s7, 32
    s_cbranch_scc1 M_el_pub
    v_mov_b32 v2, 32
    s_mov_b64 exec, 1
    global_atomic_add v5, v2, v3, s[28:29] sc0
    s_waitcnt vmcnt(0)
    s_mov_b64 exec, -1
    v_readfirstlane_b32 s7, v5
    v_and_b32 v2, 7, v0
    v_lshlrev_b32 v2, 2, v2
    v_mov_b32 v3, 128
    v_cmp_eq_u32 vcc, 0, v2
    s_nop 1
    v_cndmask_b32 v2, v2, v3, vcc
M_el_w:
    global_load_dword v5, v2, s[28:29] sc1
    s_waitcnt vmcnt(0)
    s_mov_b32 s8, 0
    v_readlane_b32 s40, v5, 0
    s_add_u32 s8, s8, s40
    v_readlane_b32 s41, v5, 1
    s_add_u32 s8, s8, s41
    v_readlane_b32 s42, v5, 2
    s_add_u32 s8, s8, s42
    v_readlane_b32 s43, v5, 3
    s_add_u32 s8, s8, s43
    v_readlane_b32 s44, v5, 4
    s_add_u32 s8, s8, s44
    v_readlane_b32 s45, v5, 5
    s_add_u32 s8, s8, s45
    v_readlane_b32 s46, v5, 6
    s_add_u32 s8, s8, s46
    v_readlane_b32 s47, v5, 7
    s_add_u32 s8, s8, s47
    s_cmp_ge_u32 s8, 256
    s_cbranch_scc1 M_el_s
    s_sleep 2
    s_sub_u32 s94, s94, 1
    s_cbranch_scc0 M_el_w
    s_mov_b32 s94, 0
M_el_s:
    s_mov_b32 s4, 255
    s_min_u32 s9, s40, 32
    s_sub_u32 s10, 32, s9
    s_add_u32 s11, s9, s7
    s_add_u32 s11, s11, 0
    s_cmp_lt_u32 s7, s10
    s_cselect_b32 s4, s11, s4
    s_cselect_b32 s7, 0x10000, s7
    s_sub_u32 s7, s7, s10
    s_min_u32 s9, s41, 32
    s_sub_u32 s10, 32, s9
    s_add_u32 s11, s9, s7
    s_add_u32 s11, s11, 32
    s_cmp_lt_u32 s7, s10
    s_cselect_b32 s4, s11, s4
    s_cselect_b32 s7, 0x10000, s7
    s_sub_u32 s7, s7, s10
    s_min_u32 s9, s42, 32
    s_sub_u32 s10, 32, s9
    s_add_u32 s11, s9, s7
    s_add_u32 s11, s11, 64
    s_cmp_lt_u32 s7, s10
    s_cselect_b32 s4, s11, s4
    s_cselect_b32 s7, 0x10000, s7
    s_sub_u32 s7, s7, s10
    s_min_u32 s9, s43, 32
    s_sub_u32 s10, 32, s9
    s_add_u32 s11, s9, s7
    s_add_u32 s11, s11, 96
    s_cmp_lt_u32 s7, s10
    s_cselect_b32 s4, s11, s4
    s_cselect_b32 s7, 0x10000, s7
    s_sub_u32 s7, s7, s10
    s_min_u32 s9, s44, 32
    s_sub_u32 s10, 32, s9
    s_add_u32 s11, s9, s7
    s_add_u32 s11, s11, 128
    s_cmp_lt_u32 s7, s10
    s_cselect_b32 s4, s11, s4
    s_cselect_b32 s7, 0x10000, s7
    s_sub_u32 s7, s7, s10
    s_min_u32 s9, s45, 32
    s_sub_u32 s10, 32, s9
    s_add_u32 s11, s9, s7
    s_add_u32 s11, s11, 160
    s_cmp_lt_u32 s7, s10
    s_cselect_b32 s4, s11, s4
    s_cselect_b32 s7, 0x10000, s7
    s_sub_u32 s7, s7, s10
    s_min_u32 s9, s46, 32
    s_sub_u32 s10, 32, s9
    s_add_u32 s11, s9, s7
    s_add_u32 s11, s11, 192
    s_cmp_lt_u32 s7, s10
    s_cselect_b32 s4, s11, s4
    s_cselect_b32 s7, 0x10000, s7
    s_sub_u32 s7, s7, s10
    s_min_u32 s9, s47, 32
    s_sub_u32 s10, 32, s9
    s_add_u32 s11, s9, s7
    s_add_u32 s11, s11, 224
    s_cmp_lt_u32 s7, s10
    s_cselect_b32 s4, s11, s4
    s_cselect_b32 s7, 0x10000, s7
    s_sub_u32 s7, s7, s10
M_el_pub:
    v_mov_b32 v5, s4
    ds_write_b32 v4, v5
    s_waitcnt lgkmcnt(0)
    s_branch M_el_done
M_el_pf:
    s_cmp_eq_u32 s3, 0
    s_cbranch_scc1 M_el_done
    s_mov_b32 s10, s2
    v_lshlrev_b32 v1, 4, v0
M_pf:
    s_mul_i32 s8, s10, 3
    s_add_u32 s8, s8, s5
    s_sub_u32 s8, s8, 1
    s_lshl_b32 s8, s8, 10
    buffer_load_dwordx4 v[64:67], v1, s[64:67], s8 offen
    buffer_load_dwordx4 v[64:67], v1, s[68:71], s8 offen
    buffer_load_dwordx4 v[64:67], v1, s[72:75], s8 offen
    buffer_load_dwordx4 v[64:67], v1, s[76:79], s8 offen
    s_add_u32 s8, s8, 786432
    buffer_load_dwordx4 v[64:67], v1, s[64:67], s8 offen
    buffer_load_dwordx4 v[64:67], v1, s[68:71], s8 offen
    buffer_load_dwordx4 v[64:67], v1, s[72:75], s8 offen
    buffer_load_dwordx4 v[64:67], v1, s[76:79], s8 offen
    s_add_u32 s8, s8, 786432
    buffer_load_dwordx4 v[64:67], v1, s[64:67], s8 offen
    buffer_load_dwordx4 v[64:67], v1, s[68:71], s8 offen
    buffer_load_dwordx4 v[64:67], v1, s[72:75], s8 offen
    buffer_load_dwordx4 v[64:67], v1, s[76:79], s8 offen
    s_add_u32 s8, s8, 786432
    buffer_load_dwordx4 v[64:67], v1, s[64:67], s8 offen
    buffer_load_dwordx4 v[64:67], v1, s[68:71], s8 offen
    buffer_load_dwordx4 v[64:67], v1, s[72:75], s8 offen
    buffer_load_dwordx4 v[64:67], v1, s[76:79], s8 offen
    s_add_u32 s8, s8, 786432
    buffer_load_dwordx4 v[64:67], v1, s[64:67], s8 offen
    buffer_load_dwordx4 v[64:67], v1, s[68:71], s8 offen
    buffer_load_dwordx4 v[64:67], v1, s[72:75], s8 offen
    buffer_load_dwordx4 v[64:67], v1, s[76:79], s8 offen
    s_add_u32 s8, s8, 786432
    buffer_load_dwordx4 v[64:67], v1, s[64:67], s8 offen
    buffer_load_dwordx4 v[64:67], v1, s[68:71], s8 offen
    buffer_load_dwordx4 v[64:67], v1, s[72:75], s8 offen
    buffer_load_dwordx4 v[64:67], v1, s[76:79], s8 offen
    s_add_u32 s8, s8, 786432
    s_cmp_lg_u32 s3, 7
    s_cbranch_scc1 M_el_done
    s_cmp_lg_u32 s10, s2
    s_cbranch_scc1 M_el_done
    s_xor_b32 s10, s2, 1
    s_branch M_pf
M_el_done:
    s_barrier
    ds_read_b32 v5, v4
    s_waitcnt lgkmcnt(0)
    v_readfirstlane_b32 s4, v5
    s_barrier
    s_cmp_lt_u32 s4, 32
    s_cbranch_scc1 M_A
    s_cmp_lt_u32 s4, 160
    s_cbranch_scc1 M_B
    s_sub_u32 s44, s4, 208
    s_cmp_ge_u32 s4, 224
    s_cbranch_scc1 M_O
    s_and_b32 s8, s4, 31
    s_cmp_ge_u32 s4, 192
    s_cselect_b32 s44, 72, 48
    s_add_u32 s44, s44, s8
    s_cmp_lt_u32 s8, 24
    s_cbranch_scc1 M_O
    s_sub_u32 s44, s8, 24
    s_cmp_ge_u32 s4, 192
    s_cselect_b32 s9, 8, 0
    s_add_u32 s44, s44, s9
    s_branch M_O
M_end:
    s_endpgm
M_A:
    v_and_b32 v10, 15, v0
    v_lshrrev_b32 v11, 4, v0
    v_mov_b32 v1, 0x4444
    v_mov_b32 v12, 0xeeee
    v_and_b32 v13, 2, v0
    v_cmp_eq_u32 vcc, 2, v13
    s_nop 1
    v_cndmask_b32 v1, v1, v12, vcc
    s_lshl_b32 s8, s5, 9
    v_lshrrev_b32 v12, 3, v10
    v_lshl_add_u32 v13, v12, 8, s8
    v_and_b32 v12, 7, v10
    v_lshl_add_u32 v13, v12, 4, v13
    v_lshl_add_u32 v13, v11, 2, v13
    v_add_u32 v13, 9216, v13
    v_lshl_add_u32 v14, v0, 3, s8
    v_add_u32 v14, 11264, v14
    v_lshl_or_b32 v4, v14, 16, v13
    v_lshrrev_b32 v12, 1, v11
    v_lshlrev_b32 v13, 8, v12
    v_lshlrev_b32 v14, 9, v12
    v_and_b32 v12, 1, v11
    v_lshl_add_u32 v13, v12, 6, v13
    v_lshl_add_u32 v14, v12, 6, v14
    v_bfe_u32 v12, v0, 3, 1
    v_lshl_add_u32 v13, v12, 7, v13
    v_bfe_u32 v12, v0, 2, 1
    v_lshl_add_u32 v13, v12, 4, v13
    v_and_b32 v12, 1, v0
    v_lshl_add_u32 v13, v12, 3, v13
    v_add_u32 v13, 9216, v13
    v_bfe_u32 v12, v0, 2, 2
    v_lshl_add_u32 v14, v12, 3, v14
    v_and_b32 v12, 3, v0
    v_lshl_add_u32 v14, v12, 7, v14
    v_add_u32 v14, 11264, v14
    v_lshl_or_b32 v5, v14, 16, v13
    v_lshl_add_u32 v13, v11, 7, s8
    v_and_b32 v12, 7, v0
    v_lshl_add_u32 v13, v12, 4, v13
    v_and_b32 v12, 8, v0
    v_add_u32 v13, v13, v12
    v_add_u32 v13, 13312, v13
    s_lshr_b32 s9, s4, 3
    s_mul_i32 s9, s9, 18
    s_and_b32 s10, s4, 7
    s_add_u32 s9, s9, s10
    s_lshl_b32 s10, s5, 3
    s_add_u32 s9, s9, s10
    s_lshr_b32 s10, s4, 1
    s_mul_i32 s10, s10, 18
    s_and_b32 s11, s4, 1
    s_add_u32 s10, s10, s11
    s_add_u32 s10, s10, 16
    s_cmp_lt_u32 s5, 2
    s_cselect_b32 s40, s9, s10
    s_cselect_b32 s41, 1, 0
    s_cmp_eq_u32 s5, 2
    s_cselect_b32 s9, 1, 0
    s_cmp_lt_u32 s4, 8
    s_cselect_b32 s10, 1, 0
    s_and_b32 s9, s9, s10
    s_or_b32 s41, s41, s9
    s_min_u32 s40, s40, 71
    s_mul_hi_u32 s42, s40, 238609295
    s_mul_i32 s9, s42, 18
    s_sub_u32 s43, s40, s9
    v_and_b32 v18, 7, v10
    s_cmp_ge_u32 s43, 16
    s_cbranch_scc1 M_A_u8
    s_lshl_b32 s44, s42, 7
    s_and_b32 s9, s43, 1
    s_lshl_b32 s9, s9, 5
    s_add_u32 s44, s44, s9
    s_lshr_b32 s9, s43, 3
    s_lshl_b32 s9, s9, 6
    s_add_u32 s44, s44, s9
    v_lshl_add_u32 v14, v18, 2, s44
    s_bfe_u32 s9, s43, 0x20001
    v_mov_b32 v15, s9
    s_branch M_A_uj
M_A_u8:
    s_lshl_b32 s44, s42, 4
    s_add_u32 s44, s44, 512
    v_and_b32 v12, 3, v10
    v_lshl_add_u32 v14, v12, 2, s44
    s_sub_u32 s9, s43, 16
    s_lshl_b32 s9, s9, 1
    v_lshrrev_b32 v15, 2, v18
    v_add_u32 v15, s9, v15
M_A_uj:
    v_and_b32 v12, 2, v11
    v_add_u32 v14, v14, v12
    v_lshrrev_b32 v16, 4, v14
    v_lshlrev_b32 v16, 8, v16
    v_lshl_add_u32 v16, v15, 6, v16
    v_bfe_u32 v12, v14, 1, 1
    v_lshl_add_u32 v16, v12, 5, v16
    v_and_b32 v12, 1, v11
    v_lshl_add_u32 v16, v12, 4, v16
    v_bfe_u32 v12, v14, 2, 2
    v_lshl_add_u32 v16, v12, 2, v16
    v_lshrrev_b32 v12, 3, v10
    v_mul_u32_u24 v12, 9216, v12
    v_add_u32 v16, v16, v12
    s_and_b32 s15, s4, 1
    s_mul_i32 s15, s15, 9216
    v_lshl_or_b32 v6, v16, 16, v13
    v_lshrrev_b32 v12, 3, v0
    v_lshlrev_b32 v13, 12, v12
    v_and_b32 v12, 7, v0
    v_lshl_add_u32 v13, v12, 4, v13
    v_lshrrev_b32 v12, 5, v0
    v_lshlrev_b32 v14, 12, v12
    v_and_b32 v12, 31, v0
    v_lshl_add_u32 v14, v12, 2, v14
    v_mov_b32 v7, v13
    v_mov_b32 v19, v14
    v_mov_b32 v12, 0x3f80
    v_mov_b32 v13, 0x3f800000
    v_and_b32 v14, 4, v10
    v_cmp_eq_u32 vcc, 4, v14
    s_nop 1
    v_cndmask_b32 v12, v12, v13, vcc
    v_and_b32 v14, 2, v10
    v_cmp_eq_u32 vcc, 0, v14
    s_nop 1
    v_cndmask_b32 v12, 0, v12, vcc
    v_lshrrev_b32 v13, 3, v10
    v_lshlrev_b32 v13, 1, v13
    v_and_b32 v14, 1, v10
    v_add_u32 v13, v13, v14
    v_cmp_eq_u32 vcc, 0, v13
    s_nop 1
    v_cndmask_b32 v20, 0, v12, vcc
    v_cmp_eq_u32 vcc, 1, v13
    s_nop 1
    v_cndmask_b32 v21, 0, v12, vcc
    v_cmp_eq_u32 vcc, 2, v13
    s_nop 1
    v_cndmask_b32 v22, 0, v12, vcc
    v_cmp_eq_u32 vcc, 3, v13
    s_nop 1
    v_cndmask_b32 v23, 0, v12, vcc
    v_lshlrev_b32 v2, 4, v0
    ds_write_b128 v2, v[20:23] offset:15360
    s_mul_i32 s9, s5, 32768
    s_add_u32 s45, s9, 32768
    v_add_u32 v3, s45, v2
    s_mul_i32 s32, s5, 73728
    s_lshl_b32 s9, s4, 7
    s_add_u32 s32, s32, s9
    s_add_u32 s32, s32, 207618048
    s_add_u32 s11, s32, 32768
    s_add_u32 s12, s32, 65536
    s_mul_i32 s33, s40, 4096
    s_mov_b32 s54, 4096
    s_add_u32 s33, s33, 207618048
    s_mov_b32 s35, 1040356334
    s_mov_b32 s48, 1040356334
    s_mov_b32 s49, 1040356334
    s_lshl_b32 s9, s4, 2
    s_add_u32 s9, s9, s5
    s_lshl_b32 s47, s9, 12
    s_add_u32 s47, s47, 209715200
    s_and_b32 s55, s4, 7
    s_lshl_b32 s55, s55, 8
    s_add_u32 s55, s55, 208732160
    v_lshrrev_b32 v20, 2, v0
    v_and_b32 v21, 3, v0
    v_and_b32 v22, 3, v20
    v_lshlrev_b32 v22, 4, v22
    v_add_u32 v22, v22, v11
    v_lshlrev_b32 v8, 13, v22
    v_lshl_add_u32 v8, v21, 4, v8
    v_lshlrev_b32 v9, 13, v20
    v_lshl_add_u32 v9, v21, 4, v9
    v_mul_u32_u24 v12, 1152, v20
    v_lshl_add_u32 v12, v21, 4, v12
    v_lshrrev_b32 v22, 1, v0
    v_mul_u32_u24 v13, 1152, v22
    v_and_b32 v23, 1, v0
    v_lshl_add_u32 v13, v23, 4, v13
    v_and_b32 v22, 3, v20
    v_lshl_add_u32 v22, v11, 3, v22
    s_lshl_b32 s9, s5, 12
    s_add_u32 s9, s9, 16384
    v_lshlrev_b32 v23, 6, v22
    v_lshl_add_u32 v24, v21, 4, v23
    v_add_u32 v14, s9, v24
    v_add_u32 v18, s45, v24
    v_and_b32 v24, 1, v20
    v_lshl_add_u32 v24, v11, 2, v24
    v_lshlrev_b32 v24, 6, v24
    v_bfe_u32 v23, v20, 1, 1
    v_lshl_add_u32 v24, v23, 5, v24
    v_lshl_add_u32 v24, v21, 3, v24
    v_add_u32 v15, s9, v24
    v_lshlrev_b32 v23, 5, v22
    v_lshl_add_u32 v24, v21, 3, v23
    v_add_u32 v16, s9, v24
    v_add_u32 v17, s9, v2
    s_lshl_b32 s30, s4, 8
    s_lshl_b32 s9, s5, 6
    s_add_u32 s30, s30, s9
    s_mul_i32 s31, s4, 147456
    s_lshl_b32 s9, s5, 5
    s_add_u32 s36, s31, s9
    s_lshl_b32 s9, s5, 8
    s_add_u32 s31, s31, s9
    s_add_u32 s9, s30, 0
    buffer_load_dwordx4 a[0:3], v8, s[64:67], s9 offen
    s_add_u32 s9, s30, 32768
    buffer_load_dwordx4 a[4:7], v8, s[64:67], s9 offen
    s_add_u32 s9, s30, 65536
    buffer_load_dwordx4 a[24:27], v8, s[64:67], s9 offen
    s_add_u32 s9, s30, 98304
    buffer_load_dwordx4 a[28:31], v8, s[64:67], s9 offen
    s_add_u32 s9, s30, 0
    buffer_load_dwordx4 a[8:11], v8, s[68:71], s9 offen
    s_add_u32 s9, s30, 32768
    buffer_load_dwordx4 a[12:15], v8, s[68:71], s9 offen
    s_add_u32 s9, s30, 65536
    buffer_load_dwordx4 a[32:35], v8, s[68:71], s9 offen
    s_add_u32 s9, s30, 98304
    buffer_load_dwordx4 a[36:39], v8, s[68:71], s9 offen
    s_add_u32 s9, s30, 0
    s_add_u32 m0, s45, 0
    s_nop 0
    buffer_load_dwordx4 v8, s[72:75], s9 offen  lds
    s_add_u32 s9, s30, 32768
    s_add_u32 m0, s45, 1024
    s_nop 0
    buffer_load_dwordx4 v8, s[72:75], s9 offen  lds
    s_add_u32 s9, s30, 65536
    s_add_u32 m0, s45, 2048
    s_nop 0
    buffer_load_dwordx4 v8, s[72:75], s9 offen  lds
    s_add_u32 s9, s30, 98304
    s_add_u32 m0, s45, 3072
    s_nop 0
    buffer_load_dwordx4 v8, s[72:75], s9 offen  lds
    s_add_u32 s9, s30, 1048576
    buffer_load_dwordx4 a[40:43], v8, s[64:67], s9 offen
    s_add_u32 s9, s30, 1081344
    buffer_load_dwordx4 a[44:47], v8, s[64:67], s9 offen
    s_add_u32 s9, s30, 1114112
    buffer_load_dwordx4 a[56:59], v8, s[64:67], s9 offen
    s_add_u32 s9, s30, 1146880
    buffer_load_dwordx4 a[60:63], v8, s[64:67], s9 offen
    s_waitcnt vmcnt(12)
    s_barrier
    ds_write_b128 v17, a[0:3] offset:0
    ds_write_b128 v17, a[4:7] offset:1024
    ds_write_b128 v17, a[24:27] offset:2048
    ds_write_b128 v17, a[28:31] offset:3072
    ds_read_b64_tr_b16 a[0:1], v14 offset:0
    ds_read_b64_tr_b16 a[2:3], v14 offset:256
    ds_read_b64_tr_b16 a[4:5], v14 offset:2048
    ds_read_b64_tr_b16 a[6:7], v14 offset:2304
    ds_read_b64_tr_b16 a[24:25], v14 offset:8
    ds_read_b64_tr_b16 a[26:27], v14 offset:264
    ds_read_b64_tr_b16 a[28:29], v14 offset:2056
    ds_read_b64_tr_b16 a[30:31], v14 offset:2312
    s_add_u32 s9, s30, 1048576
    buffer_load_dwordx4 a[48:51], v8, s[68:71], s9 offen
    s_add_u32 s9, s30, 1081344
    buffer_load_dwordx4 a[52:55], v8, s[68:71], s9 offen
    s_add_u32 s9, s30, 1114112
    buffer_load_dwordx4 a[64:67], v8, s[68:71], s9 offen
    s_add_u32 s9, s30, 1146880
    buffer_load_dwordx4 a[68:71], v8, s[68:71], s9 offen
    s_waitcnt vmcnt(12)
    s_barrier
    ds_write_b128 v17, a[8:11] offset:0
    ds_write_b128 v17, a[12:15] offset:1024
    ds_write_b128 v17, a[32:35] offset:2048
    ds_write_b128 v17, a[36:39] offset:3072
    ds_read_b64_tr_b16 a[8:9], v14 offset:0
    ds_read_b64_tr_b16 a[10:11], v14 offset:256
    ds_read_b64_tr_b16 a[12:13], v14 offset:2048
    ds_read_b64_tr_b16 a[14:15], v14 offset:2304
    ds_read_b64_tr_b16 a[32:33], v14 offset:8
    ds_read_b64_tr_b16 a[34:35], v14 offset:264
    ds_read_b64_tr_b16 a[36:37], v14 offset:2056
    ds_read_b64_tr_b16 a[38:39], v14 offset:2312
    s_add_u32 s9, s30, 1048576
    s_add_u32 m0, s45, 4096
    s_nop 0
    buffer_load_dwordx4 v8, s[72:75], s9 offen  lds
    s_add_u32 s9, s30, 1081344
    s_add_u32 m0, s45, 5120
    s_nop 0
    buffer_load_dwordx4 v8, s[72:75], s9 offen  lds
    s_add_u32 s9, s30, 1114112
    s_add_u32 m0, s45, 6144
    s_nop 0
    buffer_load_dwordx4 v8, s[72:75], s9 offen  lds
    s_add_u32 s9, s30, 1146880
    s_add_u32 m0, s45, 7168
    s_nop 0
    buffer_load_dwordx4 v8, s[72:75], s9 offen  lds
    s_waitcnt vmcnt(12)
    s_barrier
    ds_read_b64_tr_b16 a[16:17], v18 offset:0
    ds_read_b64_tr_b16 a[18:19], v18 offset:256
    ds_read_b64_tr_b16 a[20:21], v18 offset:2048
    ds_read_b64_tr_b16 a[22:23], v18 offset:2304
    ds_read_b64_tr_b16 v[32:33], v18 offset:8
    ds_read_b64_tr_b16 v[34:35], v18 offset:264
    ds_read_b64_tr_b16 v[36:37], v18 offset:2056
    ds_read_b64_tr_b16 v[38:39], v18 offset:2312
    s_waitcnt lgkmcnt(0)
    ds_write_b128 v3, v[32:35] offset:2048
    ds_write_b128 v3, v[36:39] offset:3072
    s_add_u32 s9, s30, 2097152
    buffer_load_dwordx4 a[72:75], v8, s[64:67], s9 offen
    s_add_u32 s9, s30, 2129920
    buffer_load_dwordx4 a[76:79], v8, s[64:67], s9 offen
    s_add_u32 s9, s30, 2162688
    buffer_load_dwordx4 a[88:91], v8, s[64:67], s9 offen
    s_add_u32 s9, s30, 2195456
    buffer_load_dwordx4 a[92:95], v8, s[64:67], s9 offen
    s_waitcnt vmcnt(12)
    s_barrier
    ds_write_b128 v17, a[40:43] offset:0
    ds_write_b128 v17, a[44:47] offset:1024
    ds_write_b128 v17, a[56:59] offset:2048
    ds_write_b128 v17, a[60:63] offset:3072
    ds_read_b64_tr_b16 a[40:41], v14 offset:0
    ds_read_b64_tr_b16 a[42:43], v14 offset:256
    ds_read_b64_tr_b16 a[44:45], v14 offset:2048
    ds_read_b64_tr_b16 a[46:47], v14 offset:2304
    ds_read_b64_tr_b16 a[56:57], v14 offset:8
    ds_read_b64_tr_b16 a[58:59], v14 offset:264
    ds_read_b64_tr_b16 a[60:61], v14 offset:2056
    ds_read_b64_tr_b16 a[62:63], v14 offset:2312
    s_add_u32 s9, s30, 2097152
    buffer_load_dwordx4 a[80:83], v8, s[68:71], s9 offen
    s_add_u32 s9, s30, 2129920
    buffer_load_dwordx4 a[84:87], v8, s[68:71], s9 offen
    s_add_u32 s9, s30, 2162688
    buffer_load_dwordx4 a[96:99], v8, s[68:71], s9 offen
    s_add_u32 s9, s30, 2195456
    buffer_load_dwordx4 a[100:103], v8, s[68:71], s9 offen
    s_waitcnt vmcnt(12)
    s_barrier
    ds_write_b128 v17, a[48:51] offset:0
    ds_write_b128 v17, a[52:55] offset:1024
    ds_write_b128 v17, a[64:67] offset:2048
    ds_write_b128 v17, a[68:71] offset:3072
    ds_read_b64_tr_b16 a[48:49], v14 offset:0
    ds_read_b64_tr_b16 a[50:51], v14 offset:256
    ds_read_b64_tr_b16 a[52:53], v14 offset:2048
    ds_read_b64_tr_b16 a[54:55], v14 offset:2304
    ds_read_b64_tr_b16 a[64:65], v14 offset:8
    ds_read_b64_tr_b16 a[66:67], v14 offset:264
    ds_read_b64_tr_b16 a[68:69], v14 offset:2056
    ds_read_b64_tr_b16 a[70:71], v14 offset:2312
    s_add_u32 s9, s30, 2097152
    s_add_u32 m0, s45, 8192
    s_nop 0
    buffer_load_dwordx4 v8, s[72:75], s9 offen  lds
    s_add_u32 s9, s30, 2129920
    s_add_u32 m0, s45, 9216
    s_nop 0
    buffer_load_dwordx4 v8, s[72:75], s9 offen  lds
    s_add_u32 s9, s30, 2162688
    s_add_u32 m0, s45, 10240
    s_nop 0
    buffer_load_dwordx4 v8, s[72:75], s9 offen  lds
    s_add_u32 s9, s30, 2195456
    s_add_u32 m0, s45, 11264
    s_nop 0
    buffer_load_dwordx4 v8, s[72:75], s9 offen  lds
    s_waitcnt vmcnt(12)
    s_barrier
    ds_read_b64_tr_b16 v[24:25], v18 offset:4096
    ds_read_b64_tr_b16 v[26:27], v18 offset:4352
    ds_read_b64_tr_b16 v[28:29], v18 offset:6144
    ds_read_b64_tr_b16 v[30:31], v18 offset:6400
    ds_read_b64_tr_b16 v[32:33], v18 offset:4104
    ds_read_b64_tr_b16 v[34:35], v18 offset:4360
    ds_read_b64_tr_b16 v[36:37], v18 offset:6152
    ds_read_b64_tr_b16 v[38:39], v18 offset:6408
    s_waitcnt lgkmcnt(0)
    ds_write_b128 v3, v[24:27] offset:4096
    ds_write_b128 v3, v[28:31] offset:5120
    ds_write_b128 v3, v[32:35] offset:6144
    ds_write_b128 v3, v[36:39] offset:7168
    s_add_u32 s9, s30, 3145728
    buffer_load_dwordx4 a[104:107], v8, s[64:67], s9 offen
    s_add_u32 s9, s30, 3178496
    buffer_load_dwordx4 a[108:111], v8, s[64:67], s9 offen
    s_add_u32 s9, s30, 3211264
    buffer_load_dwordx4 a[120:123], v8, s[64:67], s9 offen
    s_add_u32 s9, s30, 3244032
    buffer_load_dwordx4 a[124:127], v8, s[64:67], s9 offen
    s_waitcnt vmcnt(12)
    s_barrier
    ds_write_b128 v17, a[72:75] offset:0
    ds_write_b128 v17, a[76:79] offset:1024
    ds_write_b128 v17, a[88:91] offset:2048
    ds_write_b128 v17, a[92:95] offset:3072
    ds_read_b64_tr_b16 a[72:73], v14 offset:0
    ds_read_b64_tr_b16 a[74:75], v14 offset:256
    ds_read_b64_tr_b16 a[76:77], v14 offset:2048
    ds_read_b64_tr_b16 a[78:79], v14 offset:2304
    ds_read_b64_tr_b16 a[88:89], v14 offset:8
    ds_read_b64_tr_b16 a[90:91], v14 offset:264
    ds_read_b64_tr_b16 a[92:93], v14 offset:2056
    ds_read_b64_tr_b16 a[94:95], v14 offset:2312
    s_add_u32 s9, s30, 3145728
    buffer_load_dwordx4 a[112:115], v8, s[68:71], s9 offen
    s_add_u32 s9, s30, 3178496
    buffer_load_dwordx4 a[116:119], v8, s[68:71], s9 offen
    s_add_u32 s9, s30, 3211264
    buffer_load_dwordx4 a[128:131], v8, s[68:71], s9 offen
    s_add_u32 s9, s30, 3244032
    buffer_load_dwordx4 a[132:135], v8, s[68:71], s9 offen
    s_waitcnt vmcnt(12)
    s_barrier
    ds_write_b128 v17, a[80:83] offset:0
    ds_write_b128 v17, a[84:87] offset:1024
    ds_write_b128 v17, a[96:99] offset:2048
    ds_write_b128 v17, a[100:103] offset:3072
    ds_read_b64_tr_b16 a[80:81], v14 offset:0
    ds_read_b64_tr_b16 a[82:83], v14 offset:256
    ds_read_b64_tr_b16 a[84:85], v14 offset:2048
    ds_read_b64_tr_b16 a[86:87], v14 offset:2304
    ds_read_b64_tr_b16 a[96:97], v14 offset:8
    ds_read_b64_tr_b16 a[98:99], v14 offset:264
    ds_read_b64_tr_b16 a[100:101], v14 offset:2056
    ds_read_b64_tr_b16 a[102:103], v14 offset:2312
    s_add_u32 s9, s30, 3145728
    s_add_u32 m0, s45, 12288
    s_nop 0
    buffer_load_dwordx4 v8, s[72:75], s9 offen  lds
    s_add_u32 s9, s30, 3178496
    s_add_u32 m0, s45, 13312
    s_nop 0
    buffer_load_dwordx4 v8, s[72:75], s9 offen  lds
    s_add_u32 s9, s30, 3211264
    s_add_u32 m0, s45, 14336
    s_nop 0
    buffer_load_dwordx4 v8, s[72:75], s9 offen  lds
    s_add_u32 s9, s30, 3244032
    s_add_u32 m0, s45, 15360
    s_nop 0
    buffer_load_dwordx4 v8, s[72:75], s9 offen  lds
    s_waitcnt vmcnt(12)
    s_barrier
    ds_read_b64_tr_b16 v[24:25], v18 offset:8192
    ds_read_b64_tr_b16 v[26:27], v18 offset:8448
    ds_read_b64_tr_b16 v[28:29], v18 offset:10240
    ds_read_b64_tr_b16 v[30:31], v18 offset:10496
    ds_read_b64_tr_b16 v[32:33], v18 offset:8200
    ds_read_b64_tr_b16 v[34:35], v18 offset:8456
    ds_read_b64_tr_b16 v[36:37], v18 offset:10248
    ds_read_b64_tr_b16 v[38:39], v18 offset:10504
    s_waitcnt lgkmcnt(0)
    ds_write_b128 v3, v[24:27] offset:8192
    ds_write_b128 v3, v[28:31] offset:9216
    ds_write_b128 v3, v[32:35] offset:10240
    ds_write_b128 v3, v[36:39] offset:11264
    s_add_u32 s9, s30, 4194304
    buffer_load_dwordx4 a[136:139], v9, s[64:67], s9 offen
    s_add_u32 s9, s30, 4325376
    buffer_load_dwordx4 a[140:143], v9, s[64:67], s9 offen
    s_add_u32 s9, s30, 4456448
    buffer_load_dwordx4 a[152:155], v9, s[64:67], s9 offen
    s_add_u32 s9, s30, 4587520
    buffer_load_dwordx4 a[156:159], v9, s[64:67], s9 offen
    s_waitcnt vmcnt(12)
    s_barrier
    ds_write_b128 v17, a[104:107] offset:0
    ds_write_b128 v17, a[108:111] offset:1024
    ds_write_b128 v17, a[120:123] offset:2048
    ds_write_b128 v17, a[124:127] offset:3072
    ds_read_b64_tr_b16 a[104:105], v14 offset:0
    ds_read_b64_tr_b16 a[106:107], v14 offset:256
    ds_read_b64_tr_b16 a[108:109], v14 offset:2048
    ds_read_b64_tr_b16 a[110:111], v14 offset:2304
    ds_read_b64_tr_b16 a[120:121], v14 offset:8
    ds_read_b64_tr_b16 a[122:123], v14 offset:264
    ds_read_b64_tr_b16 a[124:125], v14 offset:2056
    ds_read_b64_tr_b16 a[126:127], v14 offset:2312
    s_add_u32 s9, s30, 4194304
    buffer_load_dwordx4 a[144:147], v9, s[68:71], s9 offen
    s_add_u32 s9, s30, 4325376
    buffer_load_dwordx4 a[148:151], v9, s[68:71], s9 offen
    s_add_u32 s9, s30, 4456448
    buffer_load_dwordx4 a[160:163], v9, s[68:71], s9 offen
    s_add_u32 s9, s30, 4587520
    buffer_load_dwordx4 a[164:167], v9, s[68:71], s9 offen
    s_waitcnt vmcnt(12)
    s_barrier
    ds_write_b128 v17, a[112:115] offset:0
    ds_write_b128 v17, a[116:119] offset:1024
    ds_write_b128 v17, a[128:131] offset:2048
    ds_write_b128 v17, a[132:135] offset:3072
    ds_read_b64_tr_b16 a[112:113], v14 offset:0
    ds_read_b64_tr_b16 a[114:115], v14 offset:256
    ds_read_b64_tr_b16 a[116:117], v14 offset:2048
    ds_read_b64_tr_b16 a[118:119], v14 offset:2304
    ds_read_b64_tr_b16 a[128:129], v14 offset:8
    ds_read_b64_tr_b16 a[130:131], v14 offset:264
    ds_read_b64_tr_b16 a[132:133], v14 offset:2056
    ds_read_b64_tr_b16 a[134:135], v14 offset:2312
    s_add_u32 s9, s30, 4194304
    s_add_u32 m0, s45, 16384
    s_nop 0
    buffer_load_dwordx4 v9, s[72:75], s9 offen  lds
    s_add_u32 s9, s30, 4325376
    s_add_u32 m0, s45, 17408
    s_nop 0
    buffer_load_dwordx4 v9, s[72:75], s9 offen  lds
    s_add_u32 s9, s30, 4456448
    s_add_u32 m0, s45, 18432
    s_nop 0
    buffer_load_dwordx4 v9, s[72:75], s9 offen  lds
    s_add_u32 s9, s30, 4587520
    s_add_u32 m0, s45, 19456
    s_nop 0
    buffer_load_dwordx4 v9, s[72:75], s9 offen  lds
    s_waitcnt vmcnt(12)
    s_barrier
    ds_read_b64_tr_b16 v[24:25], v18 offset:12288
    ds_read_b64_tr_b16 v[26:27], v18 offset:12544
    ds_read_b64_tr_b16 v[28:29], v18 offset:14336
    ds_read_b64_tr_b16 v[30:31], v18 offset:14592
    ds_read_b64_tr_b16 v[32:33], v18 offset:12296
    ds_read_b64_tr_b16 v[34:35], v18 offset:12552
    ds_read_b64_tr_b16 v[36:37], v18 offset:14344
    ds_read_b64_tr_b16 v[38:39], v18 offset:14600
    s_waitcnt lgkmcnt(0)
    ds_write_b128 v3, v[24:27] offset:12288
    ds_write_b128 v3, v[28:31] offset:13312
    ds_write_b128 v3, v[32:35] offset:14336
    ds_write_b128 v3, v[36:39] offset:15360
    s_add_u32 s9, s30, 524288
    buffer_load_dwordx4 a[168:171], v8, s[64:67], s9 offen
    s_add_u32 s9, s30, 557056
    buffer_load_dwordx4 a[172:175], v8, s[64:67], s9 offen
    s_add_u32 s9, s30, 589824
    buffer_load_dwordx4 a[184:187], v8, s[64:67], s9 offen
    s_add_u32 s9, s30, 622592
    buffer_load_dwordx4 a[188:191], v8, s[64:67], s9 offen
    s_waitcnt vmcnt(12)
    s_barrier
    ds_write_b128 v17, a[136:139] offset:0
    ds_write_b128 v17, a[140:143] offset:1024
    ds_write_b128 v17, a[152:155] offset:2048
    ds_write_b128 v17, a[156:159] offset:3072
    ds_read_b64_tr_b16 a[136:137], v14 offset:0
    ds_read_b64_tr_b16 a[138:139], v14 offset:256
    ds_read_b64_tr_b16 a[140:141], v14 offset:2048
    ds_read_b64_tr_b16 a[142:143], v14 offset:2304
    ds_read_b64_tr_b16 a[152:153], v14 offset:8
    ds_read_b64_tr_b16 a[154:155], v14 offset:264
    ds_read_b64_tr_b16 a[156:157], v14 offset:2056
    ds_read_b64_tr_b16 a[158:159], v14 offset:2312
    s_add_u32 s9, s30, 524288
    s_add_u32 m0, s45, 24576
    s_nop 0
    buffer_load_dwordx4 v8, s[68:71], s9 offen  lds
    s_add_u32 s9, s30, 557056
    s_add_u32 m0, s45, 25600
    s_nop 0
    buffer_load_dwordx4 v8, s[68:71], s9 offen  lds
    s_add_u32 s9, s30, 589824
    s_add_u32 m0, s45, 26624
    s_nop 0
    buffer_load_dwordx4 v8, s[68:71], s9 offen  lds
    s_add_u32 s9, s30, 622592
    s_add_u32 m0, s45, 27648
    s_nop 0
    buffer_load_dwordx4 v8, s[68:71], s9 offen  lds
    s_waitcnt vmcnt(12)
    s_barrier
    ds_write_b128 v17, a[144:147] offset:0
    ds_write_b128 v17, a[148:151] offset:1024
    ds_write_b128 v17, a[160:163] offset:2048
    ds_write_b128 v17, a[164:167] offset:3072
    ds_read_b64_tr_b16 a[144:145], v14 offset:0
    ds_read_b64_tr_b16 a[146:147], v14 offset:256
    ds_read_b64_tr_b16 a[148:149], v14 offset:2048
    ds_read_b64_tr_b16 a[150:151], v14 offset:2304
    ds_read_b64_tr_b16 a[160:161], v14 offset:8
    ds_read_b64_tr_b16 a[162:163], v14 offset:264
    ds_read_b64_tr_b16 a[164:165], v14 offset:2056
    ds_read_b64_tr_b16 a[166:167], v14 offset:2312
    s_add_u32 s9, s30, 524288
    buffer_load_dwordx4 a[248:251], v8, s[72:75], s9 offen
    s_add_u32 s9, s30, 557056
    buffer_load_dwordx4 a[252:255], v8, s[72:75], s9 offen
    s_add_u32 s9, s30, 589824
    buffer_load_dwordx4 v[72:75], v8, s[72:75], s9 offen
    s_add_u32 s9, s30, 622592
    buffer_load_dwordx4 v[76:79], v8, s[72:75], s9 offen
    s_waitcnt vmcnt(12)
    s_barrier
    ds_read_b64_tr_b16 v[24:25], v18 offset:16384
    ds_read_b64_tr_b16 v[26:27], v18 offset:16640
    ds_read_b64_tr_b16 v[28:29], v18 offset:18432
    ds_read_b64_tr_b16 v[30:31], v18 offset:18688
    ds_read_b64_tr_b16 v[32:33], v18 offset:16392
    ds_read_b64_tr_b16 v[34:35], v18 offset:16648
    ds_read_b64_tr_b16 v[36:37], v18 offset:18440
    ds_read_b64_tr_b16 v[38:39], v18 offset:18696
    s_waitcnt lgkmcnt(0)
    ds_write_b128 v3, v[24:27] offset:16384
    ds_write_b128 v3, v[28:31] offset:17408
    ds_write_b128 v3, v[32:35] offset:18432
    ds_write_b128 v3, v[36:39] offset:19456
    s_add_u32 s9, s30, 1572864
    s_add_u32 m0, s45, 20480
    s_nop 0
    buffer_load_dwordx4 v8, s[64:67], s9 offen  lds
    s_add_u32 s9, s30, 1605632
    s_add_u32 m0, s45, 21504
    s_nop 0
    buffer_load_dwordx4 v8, s[64:67], s9 offen  lds
    s_add_u32 s9, s30, 1638400
    s_add_u32 m0, s45, 22528
    s_nop 0
    buffer_load_dwordx4 v8, s[64:67], s9 offen  lds
    s_add_u32 s9, s30, 1671168
    s_add_u32 m0, s45, 23552
    s_nop 0
    buffer_load_dwordx4 v8, s[64:67], s9 offen  lds
    s_waitcnt vmcnt(12)
    s_barrier
    ds_write_b128 v17, a[168:171] offset:0
    ds_write_b128 v17, a[172:175] offset:1024
    ds_write_b128 v17, a[184:187] offset:2048
    ds_write_b128 v17, a[188:191] offset:3072
    ds_read_b64_tr_b16 a[168:169], v14 offset:0
    ds_read_b64_tr_b16 a[170:171], v14 offset:256
    ds_read_b64_tr_b16 a[172:173], v14 offset:2048
    ds_read_b64_tr_b16 a[174:175], v14 offset:2304
    ds_read_b64_tr_b16 a[184:185], v14 offset:8
    ds_read_b64_tr_b16 a[186:187], v14 offset:264
    ds_read_b64_tr_b16 a[188:189], v14 offset:2056
    ds_read_b64_tr_b16 a[190:191], v14 offset:2312
    s_add_u32 s9, s30, 1572864
    buffer_load_dwordx4 a[216:219], v8, s[68:71], s9 offen
    s_add_u32 s9, s30, 1605632
    buffer_load_dwordx4 a[220:223], v8, s[68:71], s9 offen
    s_add_u32 s9, s30, 1638400
    buffer_load_dwordx4 a[232:235], v8, s[68:71], s9 offen
    s_add_u32 s9, s30, 1671168
    buffer_load_dwordx4 a[236:239], v8, s[68:71], s9 offen
    s_waitcnt vmcnt(12)
    s_barrier
    ds_read_b64_tr_b16 v[24:25], v18 offset:24576
    ds_read_b64_tr_b16 v[26:27], v18 offset:24832
    ds_read_b64_tr_b16 v[28:29], v18 offset:26624
    ds_read_b64_tr_b16 v[30:31], v18 offset:26880
    ds_read_b64_tr_b16 v[32:33], v18 offset:24584
    ds_read_b64_tr_b16 v[34:35], v18 offset:24840
    ds_read_b64_tr_b16 v[36:37], v18 offset:26632
    ds_read_b64_tr_b16 v[38:39], v18 offset:26888
    s_waitcnt lgkmcnt(0)
    ds_write_b128 v3, v[24:27] offset:24576
    ds_write_b128 v3, v[28:31] offset:25600
    ds_write_b128 v3, v[32:35] offset:26624
    ds_write_b128 v3, v[36:39] offset:27648
    s_add_u32 s9, s30, 1572864
    buffer_load_dwordx4 v[80:83], v8, s[72:75], s9 offen
    s_add_u32 s9, s30, 1605632
    buffer_load_dwordx4 v[84:87], v8, s[72:75], s9 offen
    s_add_u32 s9, s30, 1638400
    buffer_load_dwordx4 v[88:91], v8, s[72:75], s9 offen
    s_add_u32 s9, s30, 1671168
    buffer_load_dwordx4 v[92:95], v8, s[72:75], s9 offen
    s_waitcnt vmcnt(12)
    s_barrier
    ds_write_b128 v17, a[248:251] offset:0
    ds_write_b128 v17, a[252:255] offset:1024
    ds_write_b128 v17, v[72:75] offset:2048
    ds_write_b128 v17, v[76:79] offset:3072
    ds_read_b64_tr_b16 a[248:249], v14 offset:0
    ds_read_b64_tr_b16 a[250:251], v14 offset:256
    ds_read_b64_tr_b16 a[252:253], v14 offset:2048
    ds_read_b64_tr_b16 a[254:255], v14 offset:2304
    ds_read_b64_tr_b16 v[72:73], v14 offset:8
    ds_read_b64_tr_b16 v[74:75], v14 offset:264
    ds_read_b64_tr_b16 v[76:77], v14 offset:2056
    ds_read_b64_tr_b16 v[78:79], v14 offset:2312
    s_add_u32 s9, s30, 2621440
    buffer_load_dwordx4 a[176:179], v8, s[64:67], s9 offen
    s_add_u32 s9, s30, 2654208
    buffer_load_dwordx4 a[180:183], v8, s[64:67], s9 offen
    s_add_u32 s9, s30, 2686976
    buffer_load_dwordx4 a[200:203], v8, s[64:67], s9 offen
    s_add_u32 s9, s30, 2719744
    buffer_load_dwordx4 a[204:207], v8, s[64:67], s9 offen
    s_waitcnt vmcnt(12)
    s_barrier
    ds_read_b64_tr_b16 v[24:25], v18 offset:20480
    ds_read_b64_tr_b16 v[26:27], v18 offset:20736
    ds_read_b64_tr_b16 v[28:29], v18 offset:22528
    ds_read_b64_tr_b16 v[30:31], v18 offset:22784
    ds_read_b64_tr_b16 v[32:33], v18 offset:20488
    ds_read_b64_tr_b16 v[34:35], v18 offset:20744
    ds_read_b64_tr_b16 v[36:37], v18 offset:22536
    ds_read_b64_tr_b16 v[38:39], v18 offset:22792
    s_waitcnt lgkmcnt(0)
    ds_write_b128 v3, v[24:27] offset:20480
    ds_write_b128 v3, v[28:31] offset:21504
    ds_write_b128 v3, v[32:35] offset:22528
    ds_write_b128 v3, v[36:39] offset:23552
    s_add_u32 s9, s30, 2621440
    s_add_u32 m0, s45, 28672
    s_nop 0
    buffer_load_dwordx4 v8, s[68:71], s9 offen  lds
    s_add_u32 s9, s30, 2654208
    s_add_u32 m0, s45, 29696
    s_nop 0
    buffer_load_dwordx4 v8, s[68:71], s9 offen  lds
    s_add_u32 s9, s30, 2686976
    s_add_u32 m0, s45, 30720
    s_nop 0
    buffer_load_dwordx4 v8, s[68:71], s9 offen  lds
    s_add_u32 s9, s30, 2719744
    s_add_u32 m0, s45, 31744
    s_nop 0
    buffer_load_dwordx4 v8, s[68:71], s9 offen  lds
    s_waitcnt vmcnt(12)
    s_barrier
    ds_write_b128 v17, a[216:219] offset:0
    ds_write_b128 v17, a[220:223] offset:1024
    ds_write_b128 v17, a[232:235] offset:2048
    ds_write_b128 v17, a[236:239] offset:3072
    ds_read_b64_tr_b16 a[216:217], v14 offset:0
    ds_read_b64_tr_b16 a[218:219], v14 offset:256
    ds_read_b64_tr_b16 a[220:221], v14 offset:2048
    ds_read_b64_tr_b16 a[222:223], v14 offset:2304
    ds_read_b64_tr_b16 a[232:233], v14 offset:8
    ds_read_b64_tr_b16 a[234:235], v14 offset:264
    ds_read_b64_tr_b16 a[236:237], v14 offset:2056
    ds_read_b64_tr_b16 a[238:239], v14 offset:2312
    s_add_u32 s9, s30, 2621440
    buffer_load_dwordx4 v[96:99], v8, s[72:75], s9 offen
    s_add_u32 s9, s30, 2654208
    buffer_load_dwordx4 v[100:103], v8, s[72:75], s9 offen
    s_add_u32 s9, s30, 2686976
    buffer_load_dwordx4 v[104:107], v8, s[72:75], s9 offen
    s_add_u32 s9, s30, 2719744
    buffer_load_dwordx4 v[108:111], v8, s[72:75], s9 offen
    s_waitcnt vmcnt(12)
    s_barrier
    ds_write_b128 v17, v[80:83] offset:0
    ds_write_b128 v17, v[84:87] offset:1024
    ds_write_b128 v17, v[88:91] offset:2048
    ds_write_b128 v17, v[92:95] offset:3072
    ds_read_b64_tr_b16 v[80:81], v14 offset:0
    ds_read_b64_tr_b16 v[82:83], v14 offset:256
    ds_read_b64_tr_b16 v[84:85], v14 offset:2048
    ds_read_b64_tr_b16 v[86:87], v14 offset:2304
    ds_read_b64_tr_b16 v[88:89], v14 offset:8
    ds_read_b64_tr_b16 v[90:91], v14 offset:264
    ds_read_b64_tr_b16 v[92:93], v14 offset:2056
    ds_read_b64_tr_b16 v[94:95], v14 offset:2312
    s_add_u32 s9, s30, 3670016
    buffer_load_dwordx4 a[192:195], v8, s[64:67], s9 offen
    s_add_u32 s9, s30, 3702784
    buffer_load_dwordx4 a[196:199], v8, s[64:67], s9 offen
    s_add_u32 s9, s30, 3735552
    buffer_load_dwordx4 a[208:211], v8, s[64:67], s9 offen
    s_add_u32 s9, s30, 3768320
    buffer_load_dwordx4 a[212:215], v8, s[64:67], s9 offen
    s_waitcnt vmcnt(12)
    s_barrier
    ds_write_b128 v17, a[176:179] offset:0
    ds_write_b128 v17, a[180:183] offset:1024
    ds_write_b128 v17, a[200:203] offset:2048
    ds_write_b128 v17, a[204:207] offset:3072
    ds_read_b64_tr_b16 a[176:177], v14 offset:0
    ds_read_b64_tr_b16 a[178:179], v14 offset:256
    ds_read_b64_tr_b16 a[180:181], v14 offset:2048
    ds_read_b64_tr_b16 a[182:183], v14 offset:2304
    ds_read_b64_tr_b16 a[200:201], v14 offset:8
    ds_read_b64_tr_b16 a[202:203], v14 offset:264
    ds_read_b64_tr_b16 a[204:205], v14 offset:2056
    ds_read_b64_tr_b16 a[206:207], v14 offset:2312
    s_add_u32 s9, s30, 3670016
    buffer_load_dwordx4 a[224:227], v8, s[68:71], s9 offen
    s_add_u32 s9, s30, 3702784
    buffer_load_dwordx4 a[228:231], v8, s[68:71], s9 offen
    s_add_u32 s9, s30, 3735552
    buffer_load_dwordx4 a[240:243], v8, s[68:71], s9 offen
    s_add_u32 s9, s30, 3768320
    buffer_load_dwordx4 a[244:247], v8, s[68:71], s9 offen
    s_waitcnt vmcnt(12)
    s_barrier
    ds_read_b64_tr_b16 v[24:25], v18 offset:28672
    ds_read_b64_tr_b16 v[26:27], v18 offset:28928
    ds_read_b64_tr_b16 v[28:29], v18 offset:30720
    ds_read_b64_tr_b16 v[30:31], v18 offset:30976
    ds_read_b64_tr_b16 v[32:33], v18 offset:28680
    ds_read_b64_tr_b16 v[34:35], v18 offset:28936
    ds_read_b64_tr_b16 v[36:37], v18 offset:30728
    ds_read_b64_tr_b16 v[38:39], v18 offset:30984
    s_waitcnt lgkmcnt(0)
    ds_write_b128 v3, v[24:27] offset:28672
    ds_write_b128 v3, v[28:31] offset:29696
    ds_write_b128 v3, v[32:35] offset:30720
    ds_write_b128 v3, v[36:39] offset:31744
    s_add_u32 s9, s30, 3670016
    buffer_load_dwordx4 v[112:115], v8, s[72:75], s9 offen
    s_add_u32 s9, s30, 3702784
    buffer_load_dwordx4 v[116:119], v8, s[72:75], s9 offen
    s_add_u32 s9, s30, 3735552
    buffer_load_dwordx4 v[120:123], v8, s[72:75], s9 offen
    s_add_u32 s9, s30, 3768320
    buffer_load_dwordx4 v[124:127], v8, s[72:75], s9 offen
    s_waitcnt vmcnt(12)
    s_barrier
    ds_write_b128 v17, v[96:99] offset:0
    ds_write_b128 v17, v[100:103] offset:1024
    ds_write_b128 v17, v[104:107] offset:2048
    ds_write_b128 v17, v[108:111] offset:3072
    ds_read_b64_tr_b16 v[96:97], v14 offset:0
    ds_read_b64_tr_b16 v[98:99], v14 offset:256
    ds_read_b64_tr_b16 v[100:101], v14 offset:2048
    ds_read_b64_tr_b16 v[102:103], v14 offset:2304
    ds_read_b64_tr_b16 v[104:105], v14 offset:8
    ds_read_b64_tr_b16 v[106:107], v14 offset:264
    ds_read_b64_tr_b16 v[108:109], v14 offset:2056
    ds_read_b64_tr_b16 v[110:111], v14 offset:2312
    s_add_u32 s9, s36, 1024
    buffer_load_dwordx4 v[128:131], v13, s[76:79], s9 offen
    s_add_u32 s9, s36, 37888
    buffer_load_dwordx4 v[132:135], v13, s[76:79], s9 offen
    s_add_u32 s9, s36, 74752
    buffer_load_dwordx4 v[136:139], v13, s[76:79], s9 offen
    s_add_u32 s9, s36, 111616
    buffer_load_dwordx4 v[140:143], v13, s[76:79], s9 offen
    s_waitcnt vmcnt(12)
    s_barrier
    ds_write_b128 v17, a[192:195] offset:0
    ds_write_b128 v17, a[196:199] offset:1024
    ds_write_b128 v17, a[208:211] offset:2048
    ds_write_b128 v17, a[212:215] offset:3072
    ds_read_b64_tr_b16 a[192:193], v14 offset:0
    ds_read_b64_tr_b16 a[194:195], v14 offset:256
    ds_read_b64_tr_b16 a[196:197], v14 offset:2048
    ds_read_b64_tr_b16 a[198:199], v14 offset:2304
    ds_read_b64_tr_b16 a[208:209], v14 offset:8
    ds_read_b64_tr_b16 a[210:211], v14 offset:264
    ds_read_b64_tr_b16 a[212:213], v14 offset:2056
    ds_read_b64_tr_b16 a[214:215], v14 offset:2312
    s_add_u32 s9, s31, 0
    buffer_load_dwordx4 v[144:147], v12, s[76:79], s9 offen
    s_add_u32 s9, s31, 18432
    buffer_load_dwordx4 v[148:151], v12, s[76:79], s9 offen
    s_add_u32 s9, s31, 36864
    buffer_load_dwordx4 v[160:163], v12, s[76:79], s9 offen
    s_add_u32 s9, s31, 55296
    buffer_load_dwordx4 v[164:167], v12, s[76:79], s9 offen
    s_waitcnt vmcnt(12)
    s_barrier
    ds_write_b128 v17, a[224:227] offset:0
    ds_write_b128 v17, a[228:231] offset:1024
    ds_write_b128 v17, a[240:243] offset:2048
    ds_write_b128 v17, a[244:247] offset:3072
    ds_read_b64_tr_b16 a[224:225], v14 offset:0
    ds_read_b64_tr_b16 a[226:227], v14 offset:256
    ds_read_b64_tr_b16 a[228:229], v14 offset:2048
    ds_read_b64_tr_b16 a[230:231], v14 offset:2304
    ds_read_b64_tr_b16 a[240:241], v14 offset:8
    ds_read_b64_tr_b16 a[242:243], v14 offset:264
    ds_read_b64_tr_b16 a[244:245], v14 offset:2056
    ds_read_b64_tr_b16 a[246:247], v14 offset:2312
    s_add_u32 s9, s31, 73728
    buffer_load_dwordx4 v[152:155], v12, s[76:79], s9 offen
    s_add_u32 s9, s31, 92160
    buffer_load_dwordx4 v[156:159], v12, s[76:79], s9 offen
    s_add_u32 s9, s31, 110592
    buffer_load_dwordx4 v[168:171], v12, s[76:79], s9 offen
    s_add_u32 s9, s31, 129024
    buffer_load_dwordx4 v[172:175], v12, s[76:79], s9 offen
    s_waitcnt vmcnt(12)
    s_barrier
    ds_write_b128 v17, v[112:115] offset:0
    ds_write_b128 v17, v[116:119] offset:1024
    ds_write_b128 v17, v[120:123] offset:2048
    ds_write_b128 v17, v[124:127] offset:3072
    ds_read_b64_tr_b16 v[112:113], v14 offset:0
    ds_read_b64_tr_b16 v[114:115], v14 offset:256
    ds_read_b64_tr_b16 v[116:117], v14 offset:2048
    ds_read_b64_tr_b16 v[118:119], v14 offset:2304
    ds_read_b64_tr_b16 v[120:121], v14 offset:8
    ds_read_b64_tr_b16 v[122:123], v14 offset:264
    ds_read_b64_tr_b16 v[124:125], v14 offset:2056
    ds_read_b64_tr_b16 v[126:127], v14 offset:2312
    s_add_u32 s9, s31, 64
    buffer_load_dwordx4 v[176:179], v12, s[76:79], s9 offen
    s_add_u32 s9, s31, 18496
    buffer_load_dwordx4 v[180:183], v12, s[76:79], s9 offen
    s_add_u32 s9, s31, 36928
    buffer_load_dwordx4 v[192:195], v12, s[76:79], s9 offen
    s_add_u32 s9, s31, 55360
    buffer_load_dwordx4 v[196:199], v12, s[76:79], s9 offen
    s_waitcnt vmcnt(12)
    s_barrier
    ds_write_b128 v17, v[128:131] offset:0
    ds_write_b128 v17, v[132:135] offset:1024
    ds_write_b128 v17, v[136:139] offset:2048
    ds_write_b128 v17, v[140:143] offset:3072
    ds_read_b64_tr_b16 v[128:129], v16 offset:0
    ds_read_b64_tr_b16 v[130:131], v16 offset:128
    ds_read_b64_tr_b16 v[132:133], v16 offset:1024
    ds_read_b64_tr_b16 v[134:135], v16 offset:1152
    ds_read_b64_tr_b16 v[136:137], v16 offset:2048
    ds_read_b64_tr_b16 v[138:139], v16 offset:2176
    ds_read_b64_tr_b16 v[140:141], v16 offset:3072
    ds_read_b64_tr_b16 v[142:143], v16 offset:3200
    s_add_u32 s9, s31, 73792
    buffer_load_dwordx4 v[184:187], v12, s[76:79], s9 offen
    s_add_u32 s9, s31, 92224
    buffer_load_dwordx4 v[188:191], v12, s[76:79], s9 offen
    s_add_u32 s9, s31, 110656
    buffer_load_dwordx4 v[200:203], v12, s[76:79], s9 offen
    s_add_u32 s9, s31, 129088
    buffer_load_dwordx4 v[204:207], v12, s[76:79], s9 offen
    s_waitcnt vmcnt(12)
    s_barrier
    ds_write_b128 v17, v[144:147] offset:0
    ds_write_b128 v17, v[148:151] offset:1024
    ds_write_b128 v17, v[160:163] offset:2048
    ds_write_b128 v17, v[164:167] offset:3072
    ds_read_b64_tr_b16 v[144:145], v15 offset:0
    ds_read_b64_tr_b16 v[146:147], v15 offset:128
    ds_read_b64_tr_b16 v[148:149], v15 offset:1024
    ds_read_b64_tr_b16 v[150:151], v15 offset:1152
    ds_read_b64_tr_b16 v[160:161], v15 offset:2048
    ds_read_b64_tr_b16 v[162:163], v15 offset:2176
    ds_read_b64_tr_b16 v[164:165], v15 offset:3072
    ds_read_b64_tr_b16 v[166:167], v15 offset:3200
    s_add_u32 s9, s31, 128
    buffer_load_dwordx4 v[208:211], v12, s[76:79], s9 offen
    s_add_u32 s9, s31, 18560
    buffer_load_dwordx4 v[212:215], v12, s[76:79], s9 offen
    s_add_u32 s9, s31, 36992
    buffer_load_dwordx4 v[224:227], v12, s[76:79], s9 offen
    s_add_u32 s9, s31, 55424
    buffer_load_dwordx4 v[228:231], v12, s[76:79], s9 offen
    s_waitcnt vmcnt(12)
    s_barrier
    ds_write_b128 v17, v[152:155] offset:0
    ds_write_b128 v17, v[156:159] offset:1024
    ds_write_b128 v17, v[168:171] offset:2048
    ds_write_b128 v17, v[172:175] offset:3072
    ds_read_b64_tr_b16 v[152:153], v15 offset:0
    ds_read_b64_tr_b16 v[154:155], v15 offset:128
    ds_read_b64_tr_b16 v[156:157], v15 offset:1024
    ds_read_b64_tr_b16 v[158:159], v15 offset:1152
    ds_read_b64_tr_b16 v[168:169], v15 offset:2048
    ds_read_b64_tr_b16 v[170:171], v15 offset:2176
    ds_read_b64_tr_b16 v[172:173], v15 offset:3072
    ds_read_b64_tr_b16 v[174:175], v15 offset:3200
    s_add_u32 s9, s31, 73856
    buffer_load_dwordx4 v[216:219], v12, s[76:79], s9 offen
    s_add_u32 s9, s31, 92288
    buffer_load_dwordx4 v[220:223], v12, s[76:79], s9 offen
    s_add_u32 s9, s31, 110720
    buffer_load_dwordx4 v[232:235], v12, s[76:79], s9 offen
    s_add_u32 s9, s31, 129152
    buffer_load_dwordx4 v[236:239], v12, s[76:79], s9 offen
    s_waitcnt vmcnt(12)
    s_barrier
    ds_write_b128 v17, v[176:179] offset:0
    ds_write_b128 v17, v[180:183] offset:1024
    ds_write_b128 v17, v[192:195] offset:2048
    ds_write_b128 v17, v[196:199] offset:3072
    ds_read_b64_tr_b16 v[176:177], v15 offset:0
    ds_read_b64_tr_b16 v[178:179], v15 offset:128
    ds_read_b64_tr_b16 v[180:181], v15 offset:1024
    ds_read_b64_tr_b16 v[182:183], v15 offset:1152
    ds_read_b64_tr_b16 v[192:193], v15 offset:2048
    ds_read_b64_tr_b16 v[194:195], v15 offset:2176
    ds_read_b64_tr_b16 v[196:197], v15 offset:3072
    ds_read_b64_tr_b16 v[198:199], v15 offset:3200
    s_add_u32 s9, s31, 192
    buffer_load_dwordx4 v[240:243], v12, s[76:79], s9 offen
    s_add_u32 s9, s31, 18624
    buffer_load_dwordx4 v[244:247], v12, s[76:79], s9 offen
    s_add_u32 s9, s31, 37056
    buffer_load_dwordx4 v[248:251], v12, s[76:79], s9 offen
    s_add_u32 s9, s31, 55488
    buffer_load_dwordx4 v[252:255], v12, s[76:79], s9 offen
    s_waitcnt vmcnt(12)
    s_barrier
    v_mov_b32 v56, 40
    v_mov_b32 v57, 128
    global_load_dword v58, v56, s[28:29] sc1
    global_load_dword v59, v57, s[28:29] sc1
    s_getpc_b64 s[8:9]
wm_1:
    s_add_u32 s8, s8, M_F_entry-wm_1
    s_addc_u32 s9, s9, 0
    v_lshlrev_b32 v62, 3, v2
    v_add_u32 v62, 0, v62
    v_min_u32 v62, M_S_entry-M_F_entry, v62
    global_load_dword v63, v62, s[8:9]
    s_lshl_b32 s9, s4, 2
    s_add_u32 s9, s9, s5
    s_mul_i32 s9, s9, 576
    s_add_u32 s9, s9, 208666624
    buffer_load_dwordx4 v[64:67], v2, s[20:23], s9 offen sc1
    ds_write_b128 v17, v[184:187] offset:0
    ds_write_b128 v17, v[188:191] offset:1024
    ds_write_b128 v17, v[200:203] offset:2048
    ds_write_b128 v17, v[204:207] offset:3072
    ds_read_b64_tr_b16 v[184:185], v15 offset:0
    ds_read_b64_tr_b16 v[186:187], v15 offset:128
    ds_read_b64_tr_b16 v[188:189], v15 offset:1024
    ds_read_b64_tr_b16 v[190:191], v15 offset:1152
    ds_read_b64_tr_b16 v[200:201], v15 offset:2048
    ds_read_b64_tr_b16 v[202:203], v15 offset:2176
    ds_read_b64_tr_b16 v[204:205], v15 offset:3072
    ds_read_b64_tr_b16 v[206:207], v15 offset:3200
    s_waitcnt vmcnt(12)
    s_barrier
    ds_write_b128 v17, v[208:211] offset:0
    ds_write_b128 v17, v[212:215] offset:1024
    ds_write_b128 v17, v[224:227] offset:2048
    ds_write_b128 v17, v[228:231] offset:3072
    ds_read_b64_tr_b16 v[208:209], v15 offset:0
    ds_read_b64_tr_b16 v[210:211], v15 offset:128
    ds_read_b64_tr_b16 v[212:213], v15 offset:1024
    ds_read_b64_tr_b16 v[214:215], v15 offset:1152
    ds_read_b64_tr_b16 v[224:225], v15 offset:2048
    ds_read_b64_tr_b16 v[226:227], v15 offset:2176
    ds_read_b64_tr_b16 v[228:229], v15 offset:3072
    ds_read_b64_tr_b16 v[230:231], v15 offset:3200
    s_add_u32 s9, s31, 73920
    buffer_load_dwordx4 v[40:43], v12, s[76:79], s9 offen
    s_add_u32 s9, s31, 92352
    buffer_load_dwordx4 v[44:47], v12, s[76:79], s9 offen
    s_add_u32 s9, s31, 110784
    buffer_load_dwordx4 v[48:51], v12, s[76:79], s9 offen
    s_add_u32 s9, s31, 129216
    buffer_load_dwordx4 v[52:55], v12, s[76:79], s9 offen
    s_waitcnt vmcnt(12)
    s_barrier
    ds_write_b128 v17, v[216:219] offset:0
    ds_write_b128 v17, v[220:223] offset:1024
    ds_write_b128 v17, v[232:235] offset:2048
    ds_write_b128 v17, v[236:239] offset:3072
    ds_read_b64_tr_b16 v[216:217], v15 offset:0
    ds_read_b64_tr_b16 v[218:219], v15 offset:128
    ds_read_b64_tr_b16 v[220:221], v15 offset:1024
    ds_read_b64_tr_b16 v[222:223], v15 offset:1152
    ds_read_b64_tr_b16 v[232:233], v15 offset:2048
    ds_read_b64_tr_b16 v[234:235], v15 offset:2176
    ds_read_b64_tr_b16 v[236:237], v15 offset:3072
    ds_read_b64_tr_b16 v[238:239], v15 offset:3200
    s_waitcnt vmcnt(8)
    s_barrier
    ds_write_b128 v17, v[240:243] offset:0
    ds_write_b128 v17, v[244:247] offset:1024
    ds_write_b128 v17, v[248:251] offset:2048
    ds_write_b128 v17, v[252:255] offset:3072
    ds_read_b64_tr_b16 v[240:241], v15 offset:0
    ds_read_b64_tr_b16 v[242:243], v15 offset:128
    ds_read_b64_tr_b16 v[244:245], v15 offset:1024
    ds_read_b64_tr_b16 v[246:247], v15 offset:1152
    ds_read_b64_tr_b16 v[248:249], v15 offset:2048
    ds_read_b64_tr_b16 v[250:251], v15 offset:2176
    ds_read_b64_tr_b16 v[252:253], v15 offset:3072
    ds_read_b64_tr_b16 v[254:255], v15 offset:3200
    s_waitcnt vmcnt(0)
    s_barrier
    ds_write_b128 v17, v[40:43] offset:0
    ds_write_b128 v17, v[44:47] offset:1024
    ds_write_b128 v17, v[48:51] offset:2048
    ds_write_b128 v17, v[52:55] offset:3072
    ds_read_b64_tr_b16 v[40:41], v15 offset:0
    ds_read_b64_tr_b16 v[42:43], v15 offset:128
    ds_read_b64_tr_b16 v[44:45], v15 offset:1024
    ds_read_b64_tr_b16 v[46:47], v15 offset:1152
    ds_read_b64_tr_b16 v[48:49], v15 offset:2048
    ds_read_b64_tr_b16 v[50:51], v15 offset:2176
    ds_read_b64_tr_b16 v[52:53], v15 offset:3072
    ds_read_b64_tr_b16 v[54:55], v15 offset:3200
    s_waitcnt lgkmcnt(0)
    v_mov_b32 v0, v2
    buffer_store_dwordx4 v[40:43], v0, s[20:23], s47 offen offset:0
    buffer_store_dwordx4 v[44:47], v0, s[20:23], s47 offen offset:1024
    buffer_store_dwordx4 v[48:51], v0, s[20:23], s47 offen offset:2048
    buffer_store_dwordx4 v[52:55], v0, s[20:23], s47 offen offset:3072
    v_readfirstlane_b32 s8, v58
    v_readfirstlane_b32 s9, v59
    s_mov_b32 s10, 0
    s_cmp_ge_u32 s8, 96
    s_cselect_b32 s9, s9, 0
    s_cmp_ge_u32 s9, 32
    s_cbranch_scc1 M_A_bd
    v_mov_b32 v8, 40
wd_2:
    global_load_dword v9, v8, s[28:29] sc1
    s_waitcnt vmcnt(0)
    v_readfirstlane_b32 s9, v9
    s_cmp_ge_u32 s9, 96
    s_cbranch_scc1 wd_2d
    s_sleep 1
    s_sub_u32 s94, s94, 1
    s_cbranch_scc0 wd_2
    s_mov_b32 s94, 0
wd_2d:
    v_bfe_u32 v8, v0, 2, 5
    v_mov_b32 v9, 128
    v_cmp_eq_u32 vcc, 0, v8
    s_nop 1
    v_cndmask_b32 v8, v8, v9, vcc
M_A_bw:
    global_load_dword v9, v8, s[28:29] sc1
    s_waitcnt vmcnt(0)
    v_readlane_b32 s9, v9, 0
    s_mov_b32 s10, 0
    s_cmp_ge_u32 s9, 32
    s_cbranch_scc1 M_A_bd
    s_mov_b32 s10, 1
    v_readlane_b32 s8, v9, 1
    s_add_u32 s9, s9, s8
    v_readlane_b32 s8, v9, 2
    s_add_u32 s9, s9, s8
    v_readlane_b32 s8, v9, 3
    s_add_u32 s9, s9, s8
    v_readlane_b32 s8, v9, 4
    s_add_u32 s9, s9, s8
    v_readlane_b32 s8, v9, 5
    s_add_u32 s9, s9, s8
    v_readlane_b32 s8, v9, 6
    s_add_u32 s9, s9, s8
    v_readlane_b32 s8, v9, 7
    s_add_u32 s9, s9, s8
    s_cmp_ge_u32 s9, 256
    s_cbranch_scc1 M_A_bd
    s_sleep 1
    s_sub_u32 s94, s94, 1
    s_cbranch_scc0 M_A_bw
    s_mov_b32 s94, 0
M_A_bd:
    s_mov_b32 s6, 0
    s_mov_b32 s36, 63
    s_mov_b32 s14, 208666624
    s_mov_b32 s44, 0
    s_lshl_b32 s46, s5, 11
    s_and_b32 s52, s5, 1
    s_lshl_b32 s52, s52, 12
    s_add_u32 s58, s52, 2048
    s_cmp_eq_u32 s5, 0
    s_cselect_b32 s52, 8192, s52
    s_cselect_b32 s58, 8192, s58
    s_cmp_eq_u32 s5, 1
    s_cselect_b32 s40, 1, 0
    s_cmp_eq_u32 s41, 0
    s_cselect_b32 s40, 2, s40
M_A_layer:
    s_lshl_b32 s37, s4, 13
    s_add_u32 s37, s37, 93323264
    s_add_u32 s37, s37, s44
    s_lshl_b32 s38, s4, 21
    s_add_u32 s38, s38, s44
    s_lshl_b32 s9, s5, 10
    s_add_u32 s57, s38, s9
    s_add_u32 s57, s57, 1048576
    s_add_u32 s38, s38, s46
    s_add_u32 s39, s46, 16384
    v_add_u32 v2, 16384, v0
    s_waitcnt vmcnt(0) lgkmcnt(0)
    s_barrier
    s_add_u32 s9, s46, 208740352
    s_add_u32 m0, s46, 0
    s_mov_b32 s8, 208748544
    buffer_load_dwordx4 v0, s[20:23], s9 offen sc1 lds
    s_mov_b32 m0, 8192
    v_and_b32 v8, 16, v0
    buffer_load_dwordx4 v0, s[20:23], s8 offen sc1 lds
    v_lshlrev_b32 v8, 3, v8
    v_mov_b64 v[24:25], 0
    v_mov_b64 v[26:27], 0
    v_mov_b64 v[28:29], 0
    v_mov_b64 v[30:31], 0
    v_mov_b64 v[32:33], 0
    v_mov_b64 v[34:35], 0
    v_mov_b64 v[36:37], 0
    v_mov_b64 v[38:39], 0
    v_mov_b64 v[40:41], 0
    v_mov_b64 v[42:43], 0
    v_mov_b64 v[44:45], 0
    v_mov_b64 v[46:47], 0
M_A_f0:
    buffer_load_dword v9, v8, s[20:23], s37 offen sc1
    s_waitcnt vmcnt(0)
    v_readlane_b32 s9, v9, 0
    v_readlane_b32 s56, v9, 1
    s_cmp_eq_u32 s9, 1
    s_cbranch_scc1 M_A_f0d
    s_sleep 1
    s_sub_u32 s94, s94, 1
    s_cbranch_scc0 M_A_f0
    s_mov_b32 s94, 0
M_A_f0d:
    s_mov_b32 m0, s39
    s_nop 0
    buffer_load_dwordx4 v0, s[20:23], s38 offen offset:0 sc1 lds
    buffer_load_dwordx4 v0, s[20:23], s38 offen offset:1024 sc1 lds
    s_add_u32 s37, s37, 128
    s_xor_b32 s39, s39, 8192
    s_add_u32 s53, s38, 8192
    s_add_u32 s38, s38, 16384
    s_mov_b32 s59, 208740352
    s_add_u32 s34, s46, 208741376
    s_cmp_eq_u32 s10, 0
    s_cbranch_scc0 M_S_entry
    s_branch M_F_entry
M_F_entry:
    s_mov_b32 s42, 0xff00ff00
    s_mov_b32 s43, 0xff00ff00
    s_branch M_F_ent
M_F_g0:
M_F_g:
    v_add_u32 v49, s52, v0
    v_add_u32 v50, s58, v0
    v_mov_b32 v51, 0
    s_nop 2
    v_mov_b32 v51, 0
    s_nop 2
    v_mov_b32 v51, 0
    s_nop 2
    v_mov_b32 v51, 0
    s_nop 2
    v_mov_b32 v51, 0
    s_nop 2
    v_mov_b32 v51, 0
    s_nop 2
    buffer_load_dwordx4 v[56:59], v49, s[20:23], s59 offen sc1
    buffer_load_dwordx4 v[60:63], v50, s[20:23], s59 offen sc1
    s_waitcnt vmcnt(4)
    v_mov_b64 v[24:25], 0
    v_mov_b64 v[26:27], 0
    v_mov_b64 v[28:29], 0
    v_mov_b64 v[30:31], 0
    v_mov_b64 v[32:33], 0
    v_mov_b64 v[34:35], 0
    v_mov_b64 v[36:37], 0
    v_mov_b64 v[38:39], 0
    v_mov_b32 v51, 0
    s_nop 2
    v_mov_b32 v51, 0
    s_nop 2
    v_mov_b32 v51, 0
    s_nop 2
    v_mov_b32 v51, 0
    s_nop 2
    v_mov_b32 v51, 0
    s_nop 2
    v_mov_b32 v51, 0
    s_nop 2
    buffer_load_dwordx4 v[64:67], v49, s[20:23], s59 offen sc1
    buffer_load_dwordx4 v[68:71], v50, s[20:23], s59 offen sc1
    s_waitcnt vmcnt(3)
    ds_write_b128 v49, v[56:59] offset:0
    v_max3_u32 v51, v56, v57, v58
    s_waitcnt vmcnt(2)
    ds_write_b128 v50, v[60:63] offset:0
    v_max3_u32 v51, v51, v59, v60
    v_max3_u32 v51, v51, v61, v62
    v_max_u32 v51, v51, v63
    v_cmpx_eq_u32 vcc, -1, v51
    s_cbranch_execnz M_F_gr
M_F_gd:
    s_mov_b64 exec, -1
    s_waitcnt lgkmcnt(0)
M_F_top:
    s_barrier
    ds_read_b128 v[8:11], v0 offset:0
    ds_read_b128 v[48:51], v3 offset:2048
    ds_read_b128 v[52:55], v3 offset:3072
    ds_read_b128 v[12:15], v0 offset:2048
    ds_read_b128 v[16:19], v0 offset:4096
    s_add_u32 m0, s46, 1024
    s_waitcnt lgkmcnt(4)
    v_smfmac_f32_16x16x64_bf16 v[24:27], v[8:11], a[0:7], v1
    ds_read_b128 v[56:59], v3 offset:4096
    ds_read_b128 v[60:63], v3 offset:5120
    v_smfmac_f32_16x16x64_bf16 v[32:35], v[8:11], a[8:15], v1
    v_smfmac_f32_16x16x64_bf16 v[40:43], v[8:11], a[16:23], v1
    v_add_u32 v7, s46, v0
    v_smfmac_f32_16x16x64_bf16 v[28:31], v[8:11], a[24:31], v1
    s_cmp_eq_u32 s56, 1
    s_cbranch_scc0 M_F_fw
M_F_fd:
    v_smfmac_f32_16x16x64_bf16 v[36:39], v[8:11], a[32:39], v1
    s_waitcnt lgkmcnt(2)
    buffer_load_dwordx4 v0, s[20:23], s34 offen sc1 lds
    v_smfmac_f32_16x16x64_bf16 v[44:47], v[8:11], v[48:55], v1
    s_waitcnt vmcnt(1)
    ds_read_b128 v[64:67], v3 offset:6144
    ds_read_b128 v[68:71], v3 offset:7168
    v_smfmac_f32_16x16x64_bf16 v[24:27], v[12:15], a[40:47], v1
    s_mov_b32 m0, s45
    ds_read_b128 v[48:51], v3 offset:8192
    v_smfmac_f32_16x16x64_bf16 v[32:35], v[12:15], a[48:55], v1
    s_waitcnt lgkmcnt(3)
    ds_read_b128 v[52:55], v3 offset:9216
    v_smfmac_f32_16x16x64_bf16 v[40:43], v[12:15], v[56:63], v1
    buffer_load_dwordx4 v0, s[20:23], s53 offen sc1 lds
    v_smfmac_f32_16x16x64_bf16 v[28:31], v[12:15], a[56:63], v1
    ds_read_b128 v[56:59], v3 offset:10240
    ds_read_b128 v[60:63], v3 offset:11264
    v_smfmac_f32_16x16x64_bf16 v[36:39], v[12:15], a[64:71], v1
    s_waitcnt lgkmcnt(4)
    buffer_load_dwordx4 v0, s[20:23], s53 offen offset:1024 sc1 lds
    s_mov_b32 m0, s39
    v_smfmac_f32_16x16x64_bf16 v[44:47], v[12:15], v[64:71], v1
    ds_read_b128 v[64:67], v3 offset:12288
    ds_read_b128 v[68:71], v3 offset:13312
    v_smfmac_f32_16x16x64_bf16 v[24:27], v[16:19], a[72:79], v1
    buffer_store_dwordx4 v[20:23], v0, s[20:23], s57 offen sc1
    v_smfmac_f32_16x16x64_bf16 v[32:35], v[16:19], a[80:87], v1
    s_waitcnt lgkmcnt(4)
    ds_read_b128 v[20:23], v0 offset:6144
    buffer_load_dwordx4 v0, s[20:23], s38 offen sc1 lds
    v_smfmac_f32_16x16x64_bf16 v[40:43], v[16:19], v[48:55], v1
    ds_read_b128 v[48:51], v3 offset:14336
    ds_read_b128 v[8:11], v0 offset:8192
    v_smfmac_f32_16x16x64_bf16 v[28:31], v[16:19], a[88:95], v1
    buffer_load_dwordx4 v0, s[20:23], s38 offen offset:1024 sc1 lds
    v_smfmac_f32_16x16x64_bf16 v[36:39], v[16:19], a[96:103], v1
    s_waitcnt lgkmcnt(3)
    ds_read_b128 v[52:55], v3 offset:15360
    v_smfmac_f32_16x16x64_bf16 v[44:47], v[16:19], v[56:63], v1
    s_waitcnt lgkmcnt(3)
    ds_read_b128 v[56:59], v3 offset:16384
    v_smfmac_f32_16x16x64_bf16 v[24:27], v[20:23], a[104:111], v1
    s_waitcnt vmcnt(5)
    ds_read_b128 v[12:15], v7 offset:1024
    v_smfmac_f32_16x16x64_bf16 v[32:35], v[20:23], a[112:119], v1
    ds_read_b128 v[60:63], v3 offset:17408
    v_smfmac_f32_16x16x64_bf16 v[40:43], v[20:23], v[64:71], v1
    ds_read_b128 v[64:67], v3 offset:18432
    ds_read_b128 v[68:71], v3 offset:19456
    v_smfmac_f32_16x16x64_bf16 v[28:31], v[20:23], a[120:127], v1
    v_smfmac_f32_16x16x64_bf16 v[36:39], v[20:23], a[128:135], v1
    s_waitcnt lgkmcnt(4)
    s_waitcnt lgkmcnt(3)
    v_cmp_u_f32 vcc, v12, v13
    v_smfmac_f32_16x16x64_bf16 v[44:47], v[20:23], v[48:55], v1
    ds_read_b128 v[48:51], v3 offset:20480
    v_cmp_u_f32 s[8:9], v14, v15
    v_smfmac_f32_16x16x64_bf16 v[24:27], v[8:11], a[136:143], v1
    ds_read_b128 v[52:55], v3 offset:21504
    v_smfmac_f32_16x16x64_bf16 v[32:35], v[8:11], a[144:151], v1
    s_waitcnt lgkmcnt(2)
    s_or_b64 vcc, vcc, s[8:9]
    s_cbranch_scc1 M_F_lr
M_F_ld:
    s_barrier
    ds_read_b128 v[12:15], v0 offset:1024
    v_smfmac_f32_16x16x64_bf16 v[40:43], v[8:11], v[56:63], v1
    ds_read_b128 v[16:19], v0 offset:3072
    ds_read_b128 v[56:59], v3 offset:22528
    v_smfmac_f32_16x16x64_bf16 v[28:31], v[8:11], a[152:159], v1
    ds_read_b128 v[20:23], v0 offset:5120
    ds_read_b128 v[60:63], v3 offset:23552
    v_smfmac_f32_16x16x64_bf16 v[36:39], v[8:11], a[160:167], v1
    v_and_b32 v7, 0xffff, v4
    v_smfmac_f32_16x16x64_bf16 v[44:47], v[8:11], v[64:71], v1
    s_waitcnt lgkmcnt(4)
    ds_read_b128 v[8:11], v0 offset:7168
    v_smfmac_f32_16x16x64_bf16 v[24:27], v[12:15], a[168:175], v1
    s_waitcnt lgkmcnt(4)
    ds_read_b128 v[64:67], v3 offset:24576
    v_smfmac_f32_16x16x64_bf16 v[24:27], v[16:19], v[48:55], v1
    s_waitcnt lgkmcnt(3)
    ds_read_b128 v[68:71], v3 offset:25600
    v_smfmac_f32_16x16x64_bf16 v[24:27], v[20:23], a[176:183], v1
    ds_read_b128 v[48:51], v3 offset:26624
    ds_read_b128 v[52:55], v3 offset:27648
    v_smfmac_f32_16x16x64_bf16 v[28:31], v[12:15], a[184:191], v1
    s_waitcnt lgkmcnt(5)
    v_smfmac_f32_16x16x64_bf16 v[28:31], v[16:19], v[56:63], v1
    s_waitcnt lgkmcnt(4)
    ds_read_b128 v[56:59], v3 offset:28672
    v_smfmac_f32_16x16x64_bf16 v[24:27], v[8:11], a[192:199], v1
    ds_read_b128 v[60:63], v3 offset:29696
    v_smfmac_f32_16x16x64_bf16 v[28:31], v[20:23], a[200:207], v1
    v_smfmac_f32_16x16x64_bf16 v[28:31], v[8:11], a[208:215], v1
    s_waitcnt lgkmcnt(2)
    v_add_f32 v24, v24, v26
    v_smfmac_f32_16x16x64_bf16 v[32:35], v[12:15], v[64:71], v1
    ds_read_b128 v[64:67], v3 offset:30720
    ds_read_b128 v[68:71], v3 offset:31744
    v_add_f32 v25, v25, v27
    v_smfmac_f32_16x16x64_bf16 v[32:35], v[16:19], a[216:223], v1
    v_cvt_pk_bf16_f32 v24, v24, v25
    v_add_f32 v28, v28, v30
    v_smfmac_f32_16x16x64_bf16 v[36:39], v[12:15], v[48:55], v1
    s_waitcnt lgkmcnt(2)
    v_add_f32 v29, v29, v31
    v_smfmac_f32_16x16x64_bf16 v[32:35], v[20:23], v[56:63], v1
    ds_read_b128 v[48:51], v2 offset:0
    v_cvt_pk_bf16_f32 v25, v28, v29
    v_smfmac_f32_16x16x64_bf16 v[32:35], v[8:11], a[224:231], v1
    s_waitcnt lgkmcnt(1)
    ds_write2_b32 v7, v24, v25 offset0:0 offset1:32
    v_and_b32 v54, 0xffff, v5
    v_smfmac_f32_16x16x64_bf16 v[36:39], v[20:23], v[64:71], v1
    ds_read_b128 v[56:59], v2 offset:1024
    v_lshrrev_b32 v53, 16, v4
    v_smfmac_f32_16x16x64_bf16 v[36:39], v[16:19], a[232:239], v1
    ds_read_b128 v[60:63], v2 offset:4096
    v_add_f32 v32, v32, v34
    v_smfmac_f32_16x16x64_bf16 v[36:39], v[8:11], a[240:247], v1
    ds_read_b128 v[64:67], v2 offset:5120
    v_add_f32 v33, v33, v35
    v_smfmac_f32_16x16x64_bf16 v[40:43], v[12:15], a[248:255], v1
    ds_read_b128 v[68:71], v2 offset:2048
    v_cvt_pk_bf16_f32 v32, v32, v33
    v_smfmac_f32_16x16x64_bf16 v[44:47], v[12:15], v[72:79], v1
    s_waitcnt lgkmcnt(4)
    s_barrier
    v_add_f32 v36, v36, v38
    v_add_f32 v37, v37, v39
    v_smfmac_f32_16x16x64_bf16 v[40:43], v[16:19], v[80:87], v1
    ds_read_b64_tr_b16 v[24:25], v54 offset:0
    v_cvt_pk_bf16_f32 v33, v36, v37
    v_smfmac_f32_16x16x64_bf16 v[44:47], v[16:19], v[88:95], v1
    ds_write_b64 v53, v[32:33]
    ds_read_b64_tr_b16 v[26:27], v54 offset:32
    v_smfmac_f32_16x16x64_bf16 v[40:43], v[20:23], v[96:103], v1
    ds_read_b64_tr_b16 v[28:29], v54 offset:512
    ds_read_b64_tr_b16 v[30:31], v54 offset:544
    v_smfmac_f32_16x16x64_bf16 v[44:47], v[20:23], v[104:111], v1
    ds_read_b64_tr_b16 v[32:33], v54 offset:1024
    ds_read_b64_tr_b16 v[34:35], v54 offset:1056
    v_smfmac_f32_16x16x64_bf16 v[40:43], v[8:11], v[112:119], v1
    ds_read_b64_tr_b16 v[36:37], v54 offset:1536
    ds_read_b64_tr_b16 v[38:39], v54 offset:1568
    v_smfmac_f32_16x16x64_bf16 v[44:47], v[8:11], v[120:127], v1
    s_waitcnt lgkmcnt(6)
    v_lshrrev_b32 v55, 16, v5
    v_mfma_f32_16x16x32_bf16 v[20:23], v[48:51], v[24:27], 0
    s_waitcnt lgkmcnt(4)
    ds_read_b128 v[48:51], v2 offset:3072
    v_mfma_f32_16x16x32_bf16 v[20:23], v[56:59], v[28:31], v[20:23]
    ds_read_b128 v[56:59], v2 offset:6144
    v_mov_b64 v[52:53], 0
    v_mfma_f32_16x16x32_bf16 v[8:11], v[60:63], v[24:27], 0
    ds_read_b128 v[60:63], v2 offset:7168
    s_barrier
    ds_read_b64_tr_b16 v[12:13], v55 offset:0
    v_mfma_f32_16x16x32_bf16 v[8:11], v[64:67], v[28:31], v[8:11]
    s_waitcnt lgkmcnt(4)
    ds_read_b64_tr_b16 v[14:15], v55 offset:32
    ds_read_b64_tr_b16 v[16:17], v55 offset:1024
    ds_read_b64_tr_b16 v[18:19], v55 offset:1056
    v_mfma_f32_16x16x32_bf16 v[20:23], v[68:71], v[32:35], v[20:23]
    s_waitcnt lgkmcnt(6)
    s_cmp_eq_u32 s6, s36
    v_mov_b64 v[54:55], 0
    v_mfma_f32_16x16x32_bf16 v[20:23], v[48:51], v[36:39], v[20:23]
    s_waitcnt lgkmcnt(5)
    v_add_f32 v40, v40, v42
    v_add_f32 v41, v41, v43
    v_mfma_f32_16x16x32_bf16 v[8:11], v[56:59], v[32:35], v[8:11]
    s_waitcnt lgkmcnt(4)
    v_add_f32 v44, v44, v46
    v_add_f32 v45, v45, v47
    v_mfma_f32_16x16x32_bf16 v[8:11], v[60:63], v[36:39], v[8:11]
    s_waitcnt lgkmcnt(2)
    v_cvt_pk_bf16_f32 v40, v40, v41
    v_cvt_pk_bf16_f32 v41, v44, v45
    v_smfmac_f32_16x16x64_bf16 v[52:55], v[12:15], v[24:31], v1
    s_waitcnt lgkmcnt(0)
    v_max3_f32 v50, v20, v21, v22
    v_smfmac_f32_16x16x64_bf16 v[52:55], v[16:19], v[32:39], v1
    v_mov_b32 v42, v41
    v_mov_b32 v43, 0
    v_mov_b32 v44, 0x3f803f80
    s_cbranch_scc1 M_F_fin
    v_max3_f32 v50, v50, v23, v8
    v_max3_f32 v50, v50, v9, v10
    v_max_f32 v50, v50, v11
    s_nop 0
    v_add_f32 v52, v52, v54
    v_add_f32 v53, v53, v55
    v_max3_f32 v50, v50, v52, v53
    v_mov_b32 v51, v50
    v_mov_b32 v45, v44
    v_mov_b64 v[54:55], 0
    v_permlane16_swap_b32 v50, v51
    v_max_f32 v50, v50, v51
    v_mov_b32 v51, v50
    v_mov_b64 v[46:47], v[44:45]
    v_and_b32 v48, 0xffff, v6
    v_permlane32_swap_b32 v50, v51
    v_max_f32 v50, v50, v51
    v_mul_f32 v50, s35, v50
    v_pk_fma_f32 v[20:21], v[20:21], s[48:49], v[50:51] op_sel_hi:[1,1,0] neg_lo:[0,0,1] neg_hi:[0,0,1]
    v_pk_fma_f32 v[22:23], v[22:23], s[48:49], v[50:51] op_sel_hi:[1,1,0] neg_lo:[0,0,1] neg_hi:[0,0,1]
    v_pk_fma_f32 v[8:9], v[8:9], s[48:49], v[50:51] op_sel_hi:[1,1,0] neg_lo:[0,0,1] neg_hi:[0,0,1]
    v_pk_fma_f32 v[10:11], v[10:11], s[48:49], v[50:51] op_sel_hi:[1,1,0] neg_lo:[0,0,1] neg_hi:[0,0,1]
    v_pk_fma_f32 v[52:53], v[52:53], s[48:49], v[50:51] op_sel_hi:[1,1,0] neg_lo:[0,0,1] neg_hi:[0,0,1]
    s_waitcnt vmcnt(3)
    ds_read_b128 v[64:67], v3
    ds_read_b128 v[68:71], v3 offset:1024
    v_exp_f32 v20, v20
    v_exp_f32 v21, v21
    v_exp_f32 v22, v22
    v_exp_f32 v23, v23
    v_exp_f32 v8, v8
    v_exp_f32 v9, v9
    v_exp_f32 v10, v10
    v_exp_f32 v11, v11
    v_cvt_pk_bf16_f32 v20, v20, v21
    v_cvt_pk_bf16_f32 v21, v22, v23
    v_cvt_pk_bf16_f32 v22, v8, v9
    v_cvt_pk_bf16_f32 v23, v10, v11
    v_exp_f32 v52, v52
    s_waitcnt lgkmcnt(0)
    v_mfma_f32_16x16x32_bf16 v[12:15], v[64:67], v[20:23], 0
    v_exp_f32 v53, v53
    v_mfma_f32_16x16x32_bf16 v[16:19], v[68:71], v[20:23], 0
    v_cvt_pk_bf16_f32 v52, v52, v53
    v_mov_b32 v53, 0
    v_mfma_f32_16x16x32_bf16 v[8:11], v[44:47], v[20:23], 0
    buffer_load_dwordx4 v[24:27], v0, s[20:23], s47 offen offset:0
    v_mfma_f32_16x16x32_bf16 v[8:11], v[44:47], v[52:55], v[8:11]
    ds_write_b64 v3, v[40:41]
    v_mfma_f32_16x16x32_bf16 v[12:15], v[40:43], v[52:55], v[12:15]
    buffer_load_dwordx4 v[28:31], v0, s[20:23], s47 offen offset:1024
    v_mfma_f32_16x16x32_bf16 v[16:19], v[42:45], v[52:55], v[16:19]
    s_and_b32 s7, s6, 1
    v_rcp_f32 v8, v8
    v_mov_b64 v[64:65], 0
    s_nop 0
    v_mul_f32 v12, v12, v8
    v_mul_f32 v13, v13, v8
    v_mul_f32 v14, v14, v8
    v_mul_f32 v15, v15, v8
    v_cvt_pk_bf16_f32 v12, v12, v13
    v_cvt_pk_bf16_f32 v13, v14, v15
    v_pk_mul_f32 v[16:17], v[16:17], v[8:9] op_sel_hi:[1,0]
    v_pk_mul_f32 v[18:19], v[18:19], v[8:9] op_sel_hi:[1,0]
    s_mov_b64 exec, s[42:43]
    v_cvt_pk_bf16_f32 v12, v16, v17
    v_cvt_pk_bf16_f32 v13, v18, v19
    s_mov_b64 exec, -1
    ds_write_b64 v48, v[12:13]
    v_lshrrev_b32 v63, 1, v0
    v_and_b32 v63, 0x1e0, v63
    v_bfi_b32 v63, 16, v0, v63
    v_mov_b64 v[66:67], 0
    v_mov_b64 v[68:69], 0
    v_mov_b64 v[70:71], 0
    v_mov_b64 v[40:41], 0
    v_mov_b64 v[42:43], 0
    v_mov_b64 v[44:45], 0
    v_mov_b64 v[46:47], 0
    v_bfe_u32 v61, v0, 2, 7
    v_lshrrev_b32 v62, 9, v0
    v_lshrrev_b32 v7, 7, v0
    v_and_b32 v60, 0x70, v0
    s_add_u32 s6, s6, 1
    s_waitcnt lgkmcnt(0)
    s_barrier
    ds_read_b128 v[8:11], v63 offset:13312
    ds_read_b128 v[12:15], v63 offset:13824
    ds_read_b128 v[16:19], v63 offset:14336
    ds_read_b128 v[20:23], v63 offset:14848
    v_mad_u32_u24 v62, v62, s54, v61
    v_mad_u32_u24 v7, v7, s54, v60
    s_waitcnt lgkmcnt(3)
    v_mfma_f32_16x16x32_bf16 v[48:51], v[8:11], v[128:131], 0
    s_waitcnt lgkmcnt(2)
    v_mfma_f32_16x16x32_bf16 v[48:51], v[12:15], v[132:135], v[48:51]
    v_xor_b32 v2, 8192, v2
    s_waitcnt lgkmcnt(1)
    v_mfma_f32_16x16x32_bf16 v[48:51], v[16:19], v[136:139], v[48:51]
    s_waitcnt lgkmcnt(0)
    v_mfma_f32_16x16x32_bf16 v[48:51], v[20:23], v[140:143], v[48:51]
    buffer_load_dwordx4 v[32:35], v0, s[20:23], s47 offen offset:2048
    v_smfmac_f32_16x16x64_bf16 v[64:67], v[8:11], v[144:151], v1
    buffer_load_dwordx4 v[36:39], v0, s[20:23], s47 offen offset:3072
    v_smfmac_f32_16x16x64_bf16 v[64:67], v[12:15], v[160:167], v1
    s_mov_b32 s13, s14
    s_and_b32 s14, s6, 3
    v_cvt_pk_bf16_f32 v48, v48, v49
    v_bfi_b32 v48, 1, s7, v48
    v_smfmac_f32_16x16x64_bf16 v[64:67], v[16:19], v[152:159], v1
    buffer_store_dword v48, v62, s[20:23], s12 offen
    v_smfmac_f32_16x16x64_bf16 v[64:67], v[20:23], v[168:175], v1
    s_mul_i32 s14, s14, 18432
    s_add_u32 s14, s14, 208666624
    v_lshrrev_b32 v62, 16, v6
    v_smfmac_f32_16x16x64_bf16 v[68:71], v[8:11], v[176:183], v1
    s_add_u32 s59, s14, s15
    s_add_u32 s34, s46, s59
    v_smfmac_f32_16x16x64_bf16 v[68:71], v[12:15], v[192:199], v1
    s_add_u32 s34, s34, 1024
    s_add_u32 s37, s37, 128
    v_cvt_pk_bf16_f32 v64, v64, v65
    v_smfmac_f32_16x16x64_bf16 v[68:71], v[16:19], v[184:191], v1
    s_xor_b32 s39, s39, 8192
    s_add_u32 s53, s38, 8192
    v_cvt_pk_bf16_f32 v65, v66, v67
    v_smfmac_f32_16x16x64_bf16 v[68:71], v[20:23], v[200:207], v1
    s_add_u32 s38, s38, 16384
    s_add_u32 s57, s57, 4096
    v_bfi_b32 v64, 1, s7, v64
    v_smfmac_f32_16x16x64_bf16 v[40:43], v[8:11], v[208:215], v1
    ds_read_b128 v[52:55], v0 offset:15360
    v_smfmac_f32_16x16x64_bf16 v[40:43], v[12:15], v[224:231], v1
    v_cvt_pk_bf16_f32 v66, v68, v69
    v_cvt_pk_bf16_f32 v67, v70, v71
    v_smfmac_f32_16x16x64_bf16 v[40:43], v[16:19], v[216:223], v1
    buffer_store_dwordx4 v[64:67], v7, s[20:23], s32 offen
    v_smfmac_f32_16x16x64_bf16 v[40:43], v[20:23], v[232:239], v1
    v_smfmac_f32_16x16x64_bf16 v[44:47], v[8:11], v[240:247], v1
    s_cmp_eq_u32 s40, 0
    v_mov_b32 v63, -1
    v_smfmac_f32_16x16x64_bf16 v[44:47], v[12:15], v[248:255], v1
    s_waitcnt vmcnt(2)
    v_cvt_pk_bf16_f32 v40, v40, v41
    v_smfmac_f32_16x16x64_bf16 v[44:47], v[16:19], v[24:31], v1
    v_cvt_pk_bf16_f32 v41, v42, v43
    v_smfmac_f32_16x16x64_bf16 v[44:47], v[20:23], v[32:39], v1
    v_bfi_b32 v40, 1, s7, v40
M_F_hd:
    s_cbranch_scc0 M_F_ne
    v_mov_b32 v56, 0
    s_nop 2
    v_mov_b32 v56, 0
    s_nop 2
    buffer_load_dwordx4 v[24:27], v0, s[20:23], s33 offen offset:0 sc1
    buffer_load_dwordx4 v[28:31], v0, s[20:23], s33 offen offset:1024 sc1
    buffer_load_dwordx4 v[32:35], v0, s[20:23], s33 offen offset:2048 sc1
    buffer_load_dwordx4 v[36:39], v0, s[20:23], s33 offen offset:3072 sc1
    v_cvt_pk_bf16_f32 v42, v44, v45
    v_cvt_pk_bf16_f32 v43, v46, v47
    buffer_store_dwordx4 v[40:43], v7, s[20:23], s11 offen
    s_waitcnt lgkmcnt(0)
    v_lshrrev_b32 v48, 16, v4
    ds_read_b64 v[20:21], v48
    ds_read_b64 v[22:23], v3
    s_load_dword s56, s[16:17], s37 glc
    v_mov_b64 v[40:41], 0
    v_mov_b64 v[42:43], 0
    v_mov_b64 v[44:45], 0
    v_mov_b64 v[46:47], 0
    v_mov_b32 v56, 0
    s_nop 2
    v_mov_b32 v56, 0
    s_nop 2
    v_mov_b32 v56, 0
    s_nop 2
    buffer_load_dwordx4 v[8:11], v0, s[20:23], s33 offen offset:0 sc1
    buffer_load_dwordx4 v[12:15], v0, s[20:23], s33 offen offset:1024 sc1
    buffer_load_dwordx4 v[16:19], v0, s[20:23], s33 offen offset:2048 sc1
    buffer_load_dwordx4 v[64:67], v0, s[20:23], s33 offen offset:3072 sc1
    s_waitcnt vmcnt(8)
    v_mfma_f32_16x16x32_bf16 v[56:59], v[52:55], v[24:27], 0
    v_xor_b32 v60, s7, v24
    s_waitcnt vmcnt(7)
    v_mfma_f32_16x16x32_bf16 v[56:59], v[52:55], v[28:31], v[56:59]
    v_bitop3_b32 v60, v60, v28, s7 bitop3:0xf6
    s_waitcnt vmcnt(6)
    v_mfma_f32_16x16x32_bf16 v[56:59], v[52:55], v[32:35], v[56:59]
    v_bitop3_b32 v60, v60, v32, s7 bitop3:0xf6
    s_waitcnt vmcnt(5)
    v_mfma_f32_16x16x32_bf16 v[56:59], v[52:55], v[36:39], v[56:59]
    v_bitop3_b32 v60, v60, v36, s7 bitop3:0xf6
    v_and_b32 v60, 1, v60
    v_cmp_ne_u32 vcc, 0, v60
    s_nop 4
    v_add_f32_dpp v56, v56, v56 row_ror:8 row_mask:0xf bank_mask:0xf
    v_add_f32_dpp v57, v57, v57 row_ror:8 row_mask:0xf bank_mask:0xf
    v_cvt_pk_bf16_f32 v58, v56, v57
    s_cbranch_vccnz M_F_rre
M_F_rde:
    buffer_store_dword v58, v62, s[20:23], s14 offen
    s_barrier
    buffer_store_dword v63, v62, s[20:23], s13 offen
    s_branch M_F_g
M_F_ne:
    v_mov_b32 v56, 0
    s_nop 2
    v_mov_b32 v56, 0
    s_nop 2
    v_mov_b32 v56, 0
    s_nop 2
    v_mov_b32 v56, 0
    s_nop 2
    v_cvt_pk_bf16_f32 v42, v44, v45
    v_cvt_pk_bf16_f32 v43, v46, v47
    buffer_store_dwordx4 v[40:43], v7, s[20:23], s11 offen
    s_waitcnt lgkmcnt(0)
    v_lshrrev_b32 v48, 16, v4
    ds_read_b64 v[20:21], v48
    ds_read_b64 v[22:23], v3
    s_load_dword s56, s[16:17], s37 glc
    v_mov_b64 v[40:41], 0
    v_mov_b64 v[42:43], 0
    v_mov_b64 v[44:45], 0
    v_mov_b64 v[46:47], 0
    s_cmp_eq_u32 s40, 1
    s_cbranch_scc1 M_F_lt
    s_barrier
    s_branch M_F_g0
M_F_lt:
    s_barrier
    buffer_load_dwordx4 v[24:27], v0, s[20:23], s33 offen offset:0 sc1
    buffer_load_dwordx4 v[28:31], v0, s[20:23], s33 offen offset:1024 sc1
    buffer_load_dwordx4 v[32:35], v0, s[20:23], s33 offen offset:2048 sc1
    buffer_load_dwordx4 v[36:39], v0, s[20:23], s33 offen offset:3072 sc1
    s_waitcnt vmcnt(3)
    v_mfma_f32_16x16x32_bf16 v[56:59], v[52:55], v[24:27], 0
    v_xor_b32 v60, s7, v24
    s_waitcnt vmcnt(2)
    v_mfma_f32_16x16x32_bf16 v[56:59], v[52:55], v[28:31], v[56:59]
    v_bitop3_b32 v60, v60, v28, s7 bitop3:0xf6
    s_waitcnt vmcnt(1)
    v_mfma_f32_16x16x32_bf16 v[56:59], v[52:55], v[32:35], v[56:59]
    v_bitop3_b32 v60, v60, v32, s7 bitop3:0xf6
    s_waitcnt vmcnt(0)
    v_mfma_f32_16x16x32_bf16 v[56:59], v[52:55], v[36:39], v[56:59]
    v_bitop3_b32 v60, v60, v36, s7 bitop3:0xf6
    v_and_b32 v60, 1, v60
    v_cmp_ne_u32 vcc, 0, v60
    s_nop 4
    v_add_f32_dpp v56, v56, v56 row_ror:8 row_mask:0xf bank_mask:0xf
    v_add_f32_dpp v57, v57, v57 row_ror:8 row_mask:0xf bank_mask:0xf
    v_cvt_pk_bf16_f32 v58, v56, v57
    s_cbranch_vccnz M_F_rrl
M_F_rdl:
    buffer_store_dword v58, v62, s[20:23], s14 offen
    buffer_store_dword v63, v62, s[20:23], s13 offen
    v_mov_b64 v[24:25], 0
    v_mov_b64 v[26:27], 0
    v_mov_b64 v[28:29], 0
    v_mov_b64 v[30:31], 0
    v_mov_b64 v[32:33], 0
    v_mov_b64 v[34:35], 0
    v_mov_b64 v[36:37], 0
    v_mov_b64 v[38:39], 0
    s_waitcnt lgkmcnt(0)
    s_branch M_F_top
M_F_ent:
    s_branch M_F_top
M_F_gr:
    s_waitcnt vmcnt(1)
    ds_write_b128 v49, v[64:67] offset:0
    v_max3_u32 v51, v64, v65, v66
    s_waitcnt vmcnt(0)
    ds_write_b128 v50, v[68:71] offset:0
    v_max3_u32 v51, v51, v67, v68
    v_max3_u32 v51, v51, v69, v70
    v_max_u32 v51, v51, v71
    v_cmpx_eq_u32 vcc, -1, v51
    s_cbranch_execz M_F_gd
    buffer_load_dwordx4 v[64:67], v49, s[20:23], s59 offen sc1
    buffer_load_dwordx4 v[68:71], v50, s[20:23], s59 offen sc1
    s_nop 15
M_F_gl:
    buffer_load_dwordx4 v[56:59], v49, s[20:23], s59 offen sc1
    buffer_load_dwordx4 v[60:63], v50, s[20:23], s59 offen sc1
    s_waitcnt vmcnt(3)
    ds_write_b128 v49, v[64:67] offset:0
    v_max3_u32 v51, v64, v65, v66
    s_waitcnt vmcnt(2)
    ds_write_b128 v50, v[68:71] offset:0
    v_max3_u32 v51, v51, v67, v68
    v_max3_u32 v51, v51, v69, v70
    v_max_u32 v51, v51, v71
    v_cmpx_eq_u32 vcc, -1, v51
    s_cbranch_execz M_F_gx
    buffer_load_dwordx4 v[64:67], v49, s[20:23], s59 offen sc1
    buffer_load_dwordx4 v[68:71], v50, s[20:23], s59 offen sc1
    s_waitcnt vmcnt(3)
    ds_write_b128 v49, v[56:59] offset:0
    v_max3_u32 v51, v56, v57, v58
    s_waitcnt vmcnt(2)
    ds_write_b128 v50, v[60:63] offset:0
    v_max3_u32 v51, v51, v59, v60
    v_max3_u32 v51, v51, v61, v62
    v_max_u32 v51, v51, v63
    v_cmpx_eq_u32 vcc, -1, v51
    s_cbranch_execz M_F_gd
    s_sub_u32 s94, s94, 1
    s_cbranch_scc0 M_F_gl
    s_mov_b32 s94, 0
M_F_gx:
    s_waitcnt vmcnt(0)
    s_branch M_F_gd
M_F_lr:
    v_cmp_eq_u32 vcc, -1, v12
    v_cmp_eq_u32 s[8:9], -1, v13
    s_or_b64 vcc, vcc, s[8:9]
    v_cmp_eq_u32 s[8:9], -1, v14
    s_or_b64 vcc, vcc, s[8:9]
    v_cmp_eq_u32 s[8:9], -1, v15
    s_or_b64 vcc, vcc, s[8:9]
    s_cbranch_scc0 M_F_ld
    s_sub_u32 s94, s94, 1
    s_cbranch_scc1 M_F_lx
    s_add_u32 m0, s46, 1024
    s_nop 0
    buffer_load_dwordx4 v0, s[20:23], s34 offen sc1 lds
    s_waitcnt vmcnt(0)
    ds_read_b128 v[12:15], v7 offset:1024
    s_waitcnt lgkmcnt(0)
    s_branch M_F_lr
M_F_lx:
    s_mov_b32 s94, 0
    s_branch M_F_ld
M_F_rre:
    s_mov_b64 exec, vcc
    buffer_load_dwordx4 v[24:27], v0, s[20:23], s33 offen offset:0 sc1
    buffer_load_dwordx4 v[28:31], v0, s[20:23], s33 offen offset:1024 sc1
    buffer_load_dwordx4 v[32:35], v0, s[20:23], s33 offen offset:2048 sc1
    buffer_load_dwordx4 v[36:39], v0, s[20:23], s33 offen offset:3072 sc1
    s_mov_b64 exec, -1
    s_waitcnt vmcnt(7)
    v_mfma_f32_16x16x32_bf16 v[56:59], v[52:55], v[8:11], 0
    v_xor_b32 v60, s7, v8
    s_waitcnt vmcnt(6)
    v_mfma_f32_16x16x32_bf16 v[56:59], v[52:55], v[12:15], v[56:59]
    v_bitop3_b32 v60, v60, v12, s7 bitop3:0xf6
    s_waitcnt vmcnt(5)
    v_mfma_f32_16x16x32_bf16 v[56:59], v[52:55], v[16:19], v[56:59]
    v_bitop3_b32 v60, v60, v16, s7 bitop3:0xf6
    s_waitcnt vmcnt(4)
    v_mfma_f32_16x16x32_bf16 v[56:59], v[52:55], v[64:67], v[56:59]
    v_bitop3_b32 v60, v60, v64, s7 bitop3:0xf6
    v_and_b32 v60, 1, v60
    v_cmp_ne_u32 vcc, 0, v60
    s_nop 4
    v_add_f32_dpp v56, v56, v56 row_ror:8 row_mask:0xf bank_mask:0xf
    v_add_f32_dpp v57, v57, v57 row_ror:8 row_mask:0xf bank_mask:0xf
    v_cvt_pk_bf16_f32 v58, v56, v57
    s_cbranch_vccz M_F_rde
M_F_rle:
    s_mov_b64 exec, vcc
    buffer_load_dwordx4 v[8:11], v0, s[20:23], s33 offen offset:0 sc1
    buffer_load_dwordx4 v[12:15], v0, s[20:23], s33 offen offset:1024 sc1
    buffer_load_dwordx4 v[16:19], v0, s[20:23], s33 offen offset:2048 sc1
    buffer_load_dwordx4 v[64:67], v0, s[20:23], s33 offen offset:3072 sc1
    s_mov_b64 exec, -1
    s_waitcnt vmcnt(7)
    v_mfma_f32_16x16x32_bf16 v[56:59], v[52:55], v[24:27], 0
    v_xor_b32 v60, s7, v24
    s_waitcnt vmcnt(6)
    v_mfma_f32_16x16x32_bf16 v[56:59], v[52:55], v[28:31], v[56:59]
    v_bitop3_b32 v60, v60, v28, s7 bitop3:0xf6
    s_waitcnt vmcnt(5)
    v_mfma_f32_16x16x32_bf16 v[56:59], v[52:55], v[32:35], v[56:59]
    v_bitop3_b32 v60, v60, v32, s7 bitop3:0xf6
    s_waitcnt vmcnt(4)
    v_mfma_f32_16x16x32_bf16 v[56:59], v[52:55], v[36:39], v[56:59]
    v_bitop3_b32 v60, v60, v36, s7 bitop3:0xf6
    v_and_b32 v60, 1, v60
    v_cmp_ne_u32 vcc, 0, v60
    s_nop 4
    v_add_f32_dpp v56, v56, v56 row_ror:8 row_mask:0xf bank_mask:0xf
    v_add_f32_dpp v57, v57, v57 row_ror:8 row_mask:0xf bank_mask:0xf
    v_cvt_pk_bf16_f32 v58, v56, v57
    s_cbranch_vccz M_F_rde
    s_mov_b64 exec, vcc
    buffer_load_dwordx4 v[24:27], v0, s[20:23], s33 offen offset:0 sc1
    buffer_load_dwordx4 v[28:31], v0, s[20:23], s33 offen offset:1024 sc1
    buffer_load_dwordx4 v[32:35], v0, s[20:23], s33 offen offset:2048 sc1
    buffer_load_dwordx4 v[36:39], v0, s[20:23], s33 offen offset:3072 sc1
    s_mov_b64 exec, -1
    s_waitcnt vmcnt(7)
    v_mfma_f32_16x16x32_bf16 v[56:59], v[52:55], v[8:11], 0
    v_xor_b32 v60, s7, v8
    s_waitcnt vmcnt(6)
    v_mfma_f32_16x16x32_bf16 v[56:59], v[52:55], v[12:15], v[56:59]
    v_bitop3_b32 v60, v60, v12, s7 bitop3:0xf6
    s_waitcnt vmcnt(5)
    v_mfma_f32_16x16x32_bf16 v[56:59], v[52:55], v[16:19], v[56:59]
    v_bitop3_b32 v60, v60, v16, s7 bitop3:0xf6
    s_waitcnt vmcnt(4)
    v_mfma_f32_16x16x32_bf16 v[56:59], v[52:55], v[64:67], v[56:59]
    v_bitop3_b32 v60, v60, v64, s7 bitop3:0xf6
    v_and_b32 v60, 1, v60
    v_cmp_ne_u32 vcc, 0, v60
    s_nop 4
    v_add_f32_dpp v56, v56, v56 row_ror:8 row_mask:0xf bank_mask:0xf
    v_add_f32_dpp v57, v57, v57 row_ror:8 row_mask:0xf bank_mask:0xf
    v_cvt_pk_bf16_f32 v58, v56, v57
    s_cbranch_vccz M_F_rde
    s_sub_u32 s94, s94, 1
    s_cbranch_scc0 M_F_rle
    s_mov_b32 s94, 0
    s_nop 7
    s_branch M_F_rde
M_F_rrl:
    s_mov_b64 exec, vcc
    buffer_load_dwordx4 v[24:27], v0, s[20:23], s33 offen offset:0 sc1
    buffer_load_dwordx4 v[28:31], v0, s[20:23], s33 offen offset:1024 sc1
    buffer_load_dwordx4 v[32:35], v0, s[20:23], s33 offen offset:2048 sc1
    buffer_load_dwordx4 v[36:39], v0, s[20:23], s33 offen offset:3072 sc1
    s_mov_b64 exec, -1
    s_waitcnt vmcnt(3)
    v_mfma_f32_16x16x32_bf16 v[56:59], v[52:55], v[24:27], 0
    v_xor_b32 v60, s7, v24
    s_waitcnt vmcnt(2)
    v_mfma_f32_16x16x32_bf16 v[56:59], v[52:55], v[28:31], v[56:59]
    v_bitop3_b32 v60, v60, v28, s7 bitop3:0xf6
    s_waitcnt vmcnt(1)
    v_mfma_f32_16x16x32_bf16 v[56:59], v[52:55], v[32:35], v[56:59]
    v_bitop3_b32 v60, v60, v32, s7 bitop3:0xf6
    s_waitcnt vmcnt(0)
    v_mfma_f32_16x16x32_bf16 v[56:59], v[52:55], v[36:39], v[56:59]
    v_bitop3_b32 v60, v60, v36, s7 bitop3:0xf6
    v_and_b32 v60, 1, v60
    v_cmp_ne_u32 vcc, 0, v60
    s_nop 4
    v_add_f32_dpp v56, v56, v56 row_ror:8 row_mask:0xf bank_mask:0xf
    v_add_f32_dpp v57, v57, v57 row_ror:8 row_mask:0xf bank_mask:0xf
    v_cvt_pk_bf16_f32 v58, v56, v57
    s_cbranch_vccz M_F_rdl
    s_sub_u32 s94, s94, 1
    s_cbranch_scc0 M_F_rrl
    s_mov_b32 s94, 0
    s_nop 7
    s_branch M_F_rdl
M_F_hw:
    buffer_load_dword v60, v61, s[20:23], s55 offen sc1
    v_cmp_ne_u32 vcc, s6, v60
    s_cbranch_vccz M_F_hd
    s_sub_u32 s94, s94, 1
    s_cbranch_scc0 M_F_hw
    s_mov_b32 s94, 0
    s_branch M_F_hd
M_F_fw:
    s_cmp_ge_u32 s6, s36
    s_cbranch_scc1 M_F_fd
M_F_fw2:
    buffer_load_dword v0, off, s[20:23], s37 sc1
    s_waitcnt vmcnt(0)
    v_readfirstlane_b32 s56, v0
    v_mbcnt_lo_u32_b32 v0, -1, 0
    v_mbcnt_hi_u32_b32 v0, -1, v0
    v_lshlrev_b32 v0, 4, v0
    s_cmp_eq_u32 s56, 1
    s_cbranch_scc1 M_F_fd
    s_sleep 1
    s_sub_u32 s94, s94, 1
    s_cbranch_scc0 M_F_fw2
    s_mov_b32 s94, 0
    s_branch M_F_fd
M_F_fin:
    v_lshrrev_b32 v28, 16, v4
    ds_read_b64 v[24:25], v28
    v_mov_b64 v[26:27], v[40:41]
    s_waitcnt lgkmcnt(0)
    s_add_u32 s57, s57, 4096
    buffer_store_dwordx4 v[24:27], v0, s[20:23], s57 offen sc1
    s_mov_b32 s95, 1
    s_cmp_lg_u32 s44, 0
    s_cbranch_scc1 M_Efin
    s_mov_b64 exec, -1
    s_add_u32 s36, s36, 63
    s_mov_b32 s44, 100663296
    s_branch M_A_layer
M_S_entry:
    s_mov_b32 s42, 0xff00ff00
    s_mov_b32 s43, 0xff00ff00
    s_branch M_S_ent
M_S_g0:
M_S_g:
    v_add_u32 v49, s52, v0
    v_add_u32 v50, s58, v0
    v_mov_b32 v51, 0
    s_nop 2
    v_mov_b32 v51, 0
    s_nop 2
    v_mov_b32 v51, 0
    s_nop 2
    v_mov_b32 v51, 0
    s_nop 2
    v_mov_b32 v51, 0
    s_nop 2
    v_mov_b32 v51, 0
    s_nop 2
    buffer_load_dwordx4 v[56:59], v49, s[20:23], s59 offen sc1
    buffer_load_dwordx4 v[60:63], v50, s[20:23], s59 offen sc1
    s_waitcnt vmcnt(4)
    v_mov_b64 v[24:25], 0
    v_mov_b64 v[26:27], 0
    v_mov_b64 v[28:29], 0
    v_mov_b64 v[30:31], 0
    v_mov_b64 v[32:33], 0
    v_mov_b64 v[34:35], 0
    v_mov_b64 v[36:37], 0
    v_mov_b64 v[38:39], 0
    v_mov_b32 v51, 0
    s_nop 2
    v_mov_b32 v51, 0
    s_nop 2
    v_mov_b32 v51, 0
    s_nop 2
    v_mov_b32 v51, 0
    s_nop 2
    v_mov_b32 v51, 0
    s_nop 2
    v_mov_b32 v51, 0
    s_nop 2
    buffer_load_dwordx4 v[64:67], v49, s[20:23], s59 offen sc1
    buffer_load_dwordx4 v[68:71], v50, s[20:23], s59 offen sc1
    s_waitcnt vmcnt(3)
    ds_write_b128 v49, v[56:59] offset:0
    v_max3_u32 v51, v56, v57, v58
    s_waitcnt vmcnt(2)
    ds_write_b128 v50, v[60:63] offset:0
    v_max3_u32 v51, v51, v59, v60
    v_max3_u32 v51, v51, v61, v62
    v_max_u32 v51, v51, v63
    v_cmpx_eq_u32 vcc, -1, v51
    s_cbranch_execnz M_S_gr
M_S_gd:
    s_mov_b64 exec, -1
    s_waitcnt lgkmcnt(0)
M_S_top:
    s_barrier
    ds_read_b128 v[8:11], v0 offset:0
    ds_read_b128 v[48:51], v3 offset:2048
    ds_read_b128 v[52:55], v3 offset:3072
    ds_read_b128 v[12:15], v0 offset:2048
    ds_read_b128 v[16:19], v0 offset:4096
    s_add_u32 m0, s46, 1024
    s_waitcnt lgkmcnt(4)
    v_smfmac_f32_16x16x64_bf16 v[24:27], v[8:11], a[0:7], v1
    ds_read_b128 v[56:59], v3 offset:4096
    ds_read_b128 v[60:63], v3 offset:5120
    v_smfmac_f32_16x16x64_bf16 v[32:35], v[8:11], a[8:15], v1
    v_smfmac_f32_16x16x64_bf16 v[40:43], v[8:11], a[16:23], v1
    v_add_u32 v7, s46, v0
    v_smfmac_f32_16x16x64_bf16 v[28:31], v[8:11], a[24:31], v1
    s_cmp_eq_u32 s56, 1
    s_cbranch_scc0 M_S_fw
M_S_fd:
    v_smfmac_f32_16x16x64_bf16 v[36:39], v[8:11], a[32:39], v1
    s_waitcnt lgkmcnt(2)
    buffer_load_dwordx4 v0, s[20:23], s34 offen sc1 lds
    v_smfmac_f32_16x16x64_bf16 v[44:47], v[8:11], v[48:55], v1
    s_waitcnt vmcnt(1)
    ds_read_b128 v[64:67], v3 offset:6144
    ds_read_b128 v[68:71], v3 offset:7168
    v_smfmac_f32_16x16x64_bf16 v[24:27], v[12:15], a[40:47], v1
    s_mov_b32 m0, s45
    ds_read_b128 v[48:51], v3 offset:8192
    v_smfmac_f32_16x16x64_bf16 v[32:35], v[12:15], a[48:55], v1
    s_waitcnt lgkmcnt(3)
    ds_read_b128 v[52:55], v3 offset:9216
    v_smfmac_f32_16x16x64_bf16 v[40:43], v[12:15], v[56:63], v1
    buffer_load_dwordx4 v0, s[20:23], s53 offen sc1 lds
    v_smfmac_f32_16x16x64_bf16 v[28:31], v[12:15], a[56:63], v1
    ds_read_b128 v[56:59], v3 offset:10240
    ds_read_b128 v[60:63], v3 offset:11264
    v_smfmac_f32_16x16x64_bf16 v[36:39], v[12:15], a[64:71], v1
    s_waitcnt lgkmcnt(4)
    buffer_load_dwordx4 v0, s[20:23], s53 offen offset:1024 sc1 lds
    s_mov_b32 m0, s39
    v_smfmac_f32_16x16x64_bf16 v[44:47], v[12:15], v[64:71], v1
    ds_read_b128 v[64:67], v3 offset:12288
    ds_read_b128 v[68:71], v3 offset:13312
    v_smfmac_f32_16x16x64_bf16 v[24:27], v[16:19], a[72:79], v1
    buffer_store_dwordx4 v[20:23], v0, s[20:23], s57 offen sc1
    v_smfmac_f32_16x16x64_bf16 v[32:35], v[16:19], a[80:87], v1
    s_waitcnt lgkmcnt(4)
    ds_read_b128 v[20:23], v0 offset:6144
    buffer_load_dwordx4 v0, s[20:23], s38 offen sc1 lds
    v_smfmac_f32_16x16x64_bf16 v[40:43], v[16:19], v[48:55], v1
    ds_read_b128 v[48:51], v3 offset:14336
    ds_read_b128 v[8:11], v0 offset:8192
    v_smfmac_f32_16x16x64_bf16 v[28:31], v[16:19], a[88:95], v1
    buffer_load_dwordx4 v0, s[20:23], s38 offen offset:1024 sc1 lds
    v_smfmac_f32_16x16x64_bf16 v[36:39], v[16:19], a[96:103], v1
    s_waitcnt lgkmcnt(3)
    ds_read_b128 v[52:55], v3 offset:15360
    v_smfmac_f32_16x16x64_bf16 v[44:47], v[16:19], v[56:63], v1
    s_waitcnt lgkmcnt(3)
    ds_read_b128 v[56:59], v3 offset:16384
    v_smfmac_f32_16x16x64_bf16 v[24:27], v[20:23], a[104:111], v1
    s_waitcnt vmcnt(5)
    ds_read_b128 v[12:15], v7 offset:1024
    v_smfmac_f32_16x16x64_bf16 v[32:35], v[20:23], a[112:119], v1
    ds_read_b128 v[60:63], v3 offset:17408
    v_smfmac_f32_16x16x64_bf16 v[40:43], v[20:23], v[64:71], v1
    ds_read_b128 v[64:67], v3 offset:18432
    ds_read_b128 v[68:71], v3 offset:19456
    v_smfmac_f32_16x16x64_bf16 v[28:31], v[20:23], a[120:127], v1
    v_smfmac_f32_16x16x64_bf16 v[36:39], v[20:23], a[128:135], v1
    s_waitcnt lgkmcnt(4)
    s_waitcnt lgkmcnt(3)
    v_cmp_u_f32 vcc, v12, v13
    v_smfmac_f32_16x16x64_bf16 v[44:47], v[20:23], v[48:55], v1
    ds_read_b128 v[48:51], v3 offset:20480
    v_cmp_u_f32 s[8:9], v14, v15
    v_smfmac_f32_16x16x64_bf16 v[24:27], v[8:11], a[136:143], v1
    ds_read_b128 v[52:55], v3 offset:21504
    v_smfmac_f32_16x16x64_bf16 v[32:35], v[8:11], a[144:151], v1
    s_waitcnt lgkmcnt(2)
    s_or_b64 vcc, vcc, s[8:9]
    s_cbranch_scc1 M_S_lr
M_S_ld:
    s_barrier
    ds_read_b128 v[12:15], v0 offset:1024
    v_smfmac_f32_16x16x64_bf16 v[40:43], v[8:11], v[56:63], v1
    ds_read_b128 v[16:19], v0 offset:3072
    ds_read_b128 v[56:59], v3 offset:22528
    v_smfmac_f32_16x16x64_bf16 v[28:31], v[8:11], a[152:159], v1
    ds_read_b128 v[20:23], v0 offset:5120
    ds_read_b128 v[60:63], v3 offset:23552
    v_smfmac_f32_16x16x64_bf16 v[36:39], v[8:11], a[160:167], v1
    v_and_b32 v7, 0xffff, v4
    v_smfmac_f32_16x16x64_bf16 v[44:47], v[8:11], v[64:71], v1
    s_waitcnt lgkmcnt(4)
    ds_read_b128 v[8:11], v0 offset:7168
    v_smfmac_f32_16x16x64_bf16 v[24:27], v[12:15], a[168:175], v1
    s_waitcnt lgkmcnt(4)
    ds_read_b128 v[64:67], v3 offset:24576
    v_smfmac_f32_16x16x64_bf16 v[24:27], v[16:19], v[48:55], v1
    s_waitcnt lgkmcnt(3)
    ds_read_b128 v[68:71], v3 offset:25600
    v_smfmac_f32_16x16x64_bf16 v[24:27], v[20:23], a[176:183], v1
    ds_read_b128 v[48:51], v3 offset:26624
    ds_read_b128 v[52:55], v3 offset:27648
    v_smfmac_f32_16x16x64_bf16 v[28:31], v[12:15], a[184:191], v1
    s_waitcnt lgkmcnt(5)
    v_smfmac_f32_16x16x64_bf16 v[28:31], v[16:19], v[56:63], v1
    s_waitcnt lgkmcnt(4)
    ds_read_b128 v[56:59], v3 offset:28672
    v_smfmac_f32_16x16x64_bf16 v[24:27], v[8:11], a[192:199], v1
    ds_read_b128 v[60:63], v3 offset:29696
    v_smfmac_f32_16x16x64_bf16 v[28:31], v[20:23], a[200:207], v1
    v_smfmac_f32_16x16x64_bf16 v[28:31], v[8:11], a[208:215], v1
    s_waitcnt lgkmcnt(2)
    v_add_f32 v24, v24, v26
    v_smfmac_f32_16x16x64_bf16 v[32:35], v[12:15], v[64:71], v1
    ds_read_b128 v[64:67], v3 offset:30720
    ds_read_b128 v[68:71], v3 offset:31744
    v_add_f32 v25, v25, v27
    v_smfmac_f32_16x16x64_bf16 v[32:35], v[16:19], a[216:223], v1
    v_cvt_pk_bf16_f32 v24, v24, v25
    v_add_f32 v28, v28, v30
    v_smfmac_f32_16x16x64_bf16 v[36:39], v[12:15], v[48:55], v1
    s_waitcnt lgkmcnt(2)
    v_add_f32 v29, v29, v31
    v_smfmac_f32_16x16x64_bf16 v[32:35], v[20:23], v[56:63], v1
    ds_read_b128 v[48:51], v2 offset:0
    v_cvt_pk_bf16_f32 v25, v28, v29
    v_smfmac_f32_16x16x64_bf16 v[32:35], v[8:11], a[224:231], v1
    s_waitcnt lgkmcnt(1)
    ds_write2_b32 v7, v24, v25 offset0:0 offset1:32
    v_and_b32 v54, 0xffff, v5
    v_smfmac_f32_16x16x64_bf16 v[36:39], v[20:23], v[64:71], v1
    ds_read_b128 v[56:59], v2 offset:1024
    v_lshrrev_b32 v53, 16, v4
    v_smfmac_f32_16x16x64_bf16 v[36:39], v[16:19], a[232:239], v1
    ds_read_b128 v[60:63], v2 offset:4096
    v_add_f32 v32, v32, v34
    v_smfmac_f32_16x16x64_bf16 v[36:39], v[8:11], a[240:247], v1
    ds_read_b128 v[64:67], v2 offset:5120
    v_add_f32 v33, v33, v35
    v_smfmac_f32_16x16x64_bf16 v[40:43], v[12:15], a[248:255], v1
    ds_read_b128 v[68:71], v2 offset:2048
    v_cvt_pk_bf16_f32 v32, v32, v33
    v_smfmac_f32_16x16x64_bf16 v[44:47], v[12:15], v[72:79], v1
    s_waitcnt lgkmcnt(4)
    s_barrier
    v_add_f32 v36, v36, v38
    v_add_f32 v37, v37, v39
    v_smfmac_f32_16x16x64_bf16 v[40:43], v[16:19], v[80:87], v1
    ds_read_b64_tr_b16 v[24:25], v54 offset:0
    v_cvt_pk_bf16_f32 v33, v36, v37
    v_smfmac_f32_16x16x64_bf16 v[44:47], v[16:19], v[88:95], v1
    ds_write_b64 v53, v[32:33]
    ds_read_b64_tr_b16 v[26:27], v54 offset:32
    v_smfmac_f32_16x16x64_bf16 v[40:43], v[20:23], v[96:103], v1
    ds_read_b64_tr_b16 v[28:29], v54 offset:512
    ds_read_b64_tr_b16 v[30:31], v54 offset:544
    v_smfmac_f32_16x16x64_bf16 v[44:47], v[20:23], v[104:111], v1
    ds_read_b64_tr_b16 v[32:33], v54 offset:1024
    ds_read_b64_tr_b16 v[34:35], v54 offset:1056
    v_smfmac_f32_16x16x64_bf16 v[40:43], v[8:11], v[112:119], v1
    ds_read_b64_tr_b16 v[36:37], v54 offset:1536
    ds_read_b64_tr_b16 v[38:39], v54 offset:1568
    v_smfmac_f32_16x16x64_bf16 v[44:47], v[8:11], v[120:127], v1
    s_waitcnt lgkmcnt(6)
    v_lshrrev_b32 v55, 16, v5
    v_mfma_f32_16x16x32_bf16 v[20:23], v[48:51], v[24:27], 0
    s_waitcnt lgkmcnt(4)
    ds_read_b128 v[48:51], v2 offset:3072
    v_mfma_f32_16x16x32_bf16 v[20:23], v[56:59], v[28:31], v[20:23]
    ds_read_b128 v[56:59], v2 offset:6144
    v_mov_b64 v[52:53], 0
    v_mfma_f32_16x16x32_bf16 v[8:11], v[60:63], v[24:27], 0
    ds_read_b128 v[60:63], v2 offset:7168
    s_barrier
    ds_read_b64_tr_b16 v[12:13], v55 offset:0
    v_mfma_f32_16x16x32_bf16 v[8:11], v[64:67], v[28:31], v[8:11]
    s_waitcnt lgkmcnt(4)
    ds_read_b64_tr_b16 v[14:15], v55 offset:32
    ds_read_b64_tr_b16 v[16:17], v55 offset:1024
    ds_read_b64_tr_b16 v[18:19], v55 offset:1056
    v_mfma_f32_16x16x32_bf16 v[20:23], v[68:71], v[32:35], v[20:23]
    s_waitcnt lgkmcnt(6)
    s_cmp_eq_u32 s6, s36
    v_mov_b64 v[54:55], 0
    v_mfma_f32_16x16x32_bf16 v[20:23], v[48:51], v[36:39], v[20:23]
    s_waitcnt lgkmcnt(5)
    v_add_f32 v40, v40, v42
    v_add_f32 v41, v41, v43
    v_mfma_f32_16x16x32_bf16 v[8:11], v[56:59], v[32:35], v[8:11]
    s_waitcnt lgkmcnt(4)
    v_add_f32 v44, v44, v46
    v_add_f32 v45, v45, v47
    v_mfma_f32_16x16x32_bf16 v[8:11], v[60:63], v[36:39], v[8:11]
    s_waitcnt lgkmcnt(2)
    v_cvt_pk_bf16_f32 v40, v40, v41
    v_cvt_pk_bf16_f32 v41, v44, v45
    v_smfmac_f32_16x16x64_bf16 v[52:55], v[12:15], v[24:31], v1
    s_waitcnt lgkmcnt(0)
    v_max3_f32 v50, v20, v21, v22
    v_smfmac_f32_16x16x64_bf16 v[52:55], v[16:19], v[32:39], v1
    v_mov_b32 v42, v41
    v_mov_b32 v43, 0
    v_mov_b32 v44, 0x3f803f80
    s_cbranch_scc1 M_S_fin
    v_max3_f32 v50, v50, v23, v8
    v_max3_f32 v50, v50, v9, v10
    v_max_f32 v50, v50, v11
    s_nop 0
    v_add_f32 v52, v52, v54
    v_add_f32 v53, v53, v55
    v_max3_f32 v50, v50, v52, v53
    v_mov_b32 v51, v50
    v_mov_b32 v45, v44
    v_mov_b64 v[54:55], 0
    v_permlane16_swap_b32 v50, v51
    v_max_f32 v50, v50, v51
    v_mov_b32 v51, v50
    v_mov_b64 v[46:47], v[44:45]
    v_and_b32 v48, 0xffff, v6
    v_permlane32_swap_b32 v50, v51
    v_max_f32 v50, v50, v51
    v_mul_f32 v50, s35, v50
    v_pk_fma_f32 v[20:21], v[20:21], s[48:49], v[50:51] op_sel_hi:[1,1,0] neg_lo:[0,0,1] neg_hi:[0,0,1]
    v_pk_fma_f32 v[22:23], v[22:23], s[48:49], v[50:51] op_sel_hi:[1,1,0] neg_lo:[0,0,1] neg_hi:[0,0,1]
    v_pk_fma_f32 v[8:9], v[8:9], s[48:49], v[50:51] op_sel_hi:[1,1,0] neg_lo:[0,0,1] neg_hi:[0,0,1]
    v_pk_fma_f32 v[10:11], v[10:11], s[48:49], v[50:51] op_sel_hi:[1,1,0] neg_lo:[0,0,1] neg_hi:[0,0,1]
    v_pk_fma_f32 v[52:53], v[52:53], s[48:49], v[50:51] op_sel_hi:[1,1,0] neg_lo:[0,0,1] neg_hi:[0,0,1]
    s_waitcnt vmcnt(3)
    ds_read_b128 v[64:67], v3
    ds_read_b128 v[68:71], v3 offset:1024
    v_exp_f32 v20, v20
    v_exp_f32 v21, v21
    v_exp_f32 v22, v22
    v_exp_f32 v23, v23
    v_exp_f32 v8, v8
    v_exp_f32 v9, v9
    v_exp_f32 v10, v10
    v_exp_f32 v11, v11
    v_cvt_pk_bf16_f32 v20, v20, v21
    v_cvt_pk_bf16_f32 v21, v22, v23
    v_cvt_pk_bf16_f32 v22, v8, v9
    v_cvt_pk_bf16_f32 v23, v10, v11
    v_exp_f32 v52, v52
    s_waitcnt lgkmcnt(0)
    v_mfma_f32_16x16x32_bf16 v[12:15], v[64:67], v[20:23], 0
    v_exp_f32 v53, v53
    v_mfma_f32_16x16x32_bf16 v[16:19], v[68:71], v[20:23], 0
    v_cvt_pk_bf16_f32 v52, v52, v53
    v_mov_b32 v53, 0
    v_mfma_f32_16x16x32_bf16 v[8:11], v[44:47], v[20:23], 0
    buffer_load_dwordx4 v[24:27], v0, s[20:23], s47 offen offset:0
    v_mfma_f32_16x16x32_bf16 v[8:11], v[44:47], v[52:55], v[8:11]
    ds_write_b64 v3, v[40:41]
    v_mfma_f32_16x16x32_bf16 v[12:15], v[40:43], v[52:55], v[12:15]
    buffer_load_dwordx4 v[28:31], v0, s[20:23], s47 offen offset:1024
    v_mfma_f32_16x16x32_bf16 v[16:19], v[42:45], v[52:55], v[16:19]
    s_and_b32 s7, s6, 1
    v_rcp_f32 v8, v8
    v_mov_b64 v[64:65], 0
    s_nop 0
    v_mul_f32 v12, v12, v8
    v_mul_f32 v13, v13, v8
    v_mul_f32 v14, v14, v8
    v_mul_f32 v15, v15, v8
    v_cvt_pk_bf16_f32 v12, v12, v13
    v_cvt_pk_bf16_f32 v13, v14, v15
    v_pk_mul_f32 v[16:17], v[16:17], v[8:9] op_sel_hi:[1,0]
    v_pk_mul_f32 v[18:19], v[18:19], v[8:9] op_sel_hi:[1,0]
    s_mov_b64 exec, s[42:43]
    v_cvt_pk_bf16_f32 v12, v16, v17
    v_cvt_pk_bf16_f32 v13, v18, v19
    s_mov_b64 exec, -1
    ds_write_b64 v48, v[12:13]
    v_lshrrev_b32 v63, 1, v0
    v_and_b32 v63, 0x1e0, v63
    v_bfi_b32 v63, 16, v0, v63
    v_mov_b64 v[66:67], 0
    v_mov_b64 v[68:69], 0
    v_mov_b64 v[70:71], 0
    v_mov_b64 v[40:41], 0
    v_mov_b64 v[42:43], 0
    v_mov_b64 v[44:45], 0
    v_mov_b64 v[46:47], 0
    v_bfe_u32 v61, v0, 2, 7
    v_lshrrev_b32 v62, 9, v0
    v_lshrrev_b32 v7, 7, v0
    v_and_b32 v60, 0x70, v0
    s_add_u32 s6, s6, 1
    s_waitcnt lgkmcnt(0)
    s_barrier
    ds_read_b128 v[8:11], v63 offset:13312
    ds_read_b128 v[12:15], v63 offset:13824
    ds_read_b128 v[16:19], v63 offset:14336
    ds_read_b128 v[20:23], v63 offset:14848
    v_mad_u32_u24 v62, v62, s54, v61
    v_mad_u32_u24 v7, v7, s54, v60
    s_waitcnt lgkmcnt(3)
    v_mfma_f32_16x16x32_bf16 v[48:51], v[8:11], v[128:131], 0
    s_waitcnt lgkmcnt(2)
    v_mfma_f32_16x16x32_bf16 v[48:51], v[12:15], v[132:135], v[48:51]
    v_xor_b32 v2, 8192, v2
    s_waitcnt lgkmcnt(1)
    v_mfma_f32_16x16x32_bf16 v[48:51], v[16:19], v[136:139], v[48:51]
    s_waitcnt lgkmcnt(0)
    v_mfma_f32_16x16x32_bf16 v[48:51], v[20:23], v[140:143], v[48:51]
    buffer_load_dwordx4 v[32:35], v0, s[20:23], s47 offen offset:2048
    v_smfmac_f32_16x16x64_bf16 v[64:67], v[8:11], v[144:151], v1
    buffer_load_dwordx4 v[36:39], v0, s[20:23], s47 offen offset:3072
    v_smfmac_f32_16x16x64_bf16 v[64:67], v[12:15], v[160:167], v1
    s_mov_b32 s13, s14
    s_and_b32 s14, s6, 3
    v_cvt_pk_bf16_f32 v48, v48, v49
    v_bfi_b32 v48, 1, s7, v48
    v_smfmac_f32_16x16x64_bf16 v[64:67], v[16:19], v[152:159], v1
    buffer_store_dword v48, v62, s[20:23], s12 offen sc1
    v_smfmac_f32_16x16x64_bf16 v[64:67], v[20:23], v[168:175], v1
    s_mul_i32 s14, s14, 18432
    s_add_u32 s14, s14, 208666624
    v_lshrrev_b32 v62, 16, v6
    v_smfmac_f32_16x16x64_bf16 v[68:71], v[8:11], v[176:183], v1
    s_add_u32 s59, s14, s15
    s_add_u32 s34, s46, s59
    v_smfmac_f32_16x16x64_bf16 v[68:71], v[12:15], v[192:199], v1
    s_add_u32 s34, s34, 1024
    s_add_u32 s37, s37, 128
    v_cvt_pk_bf16_f32 v64, v64, v65
    v_smfmac_f32_16x16x64_bf16 v[68:71], v[16:19], v[184:191], v1
    s_xor_b32 s39, s39, 8192
    s_add_u32 s53, s38, 8192
    v_cvt_pk_bf16_f32 v65, v66, v67
    v_smfmac_f32_16x16x64_bf16 v[68:71], v[20:23], v[200:207], v1
    s_add_u32 s38, s38, 16384
    s_add_u32 s57, s57, 4096
    v_bfi_b32 v64, 1, s7, v64
    v_smfmac_f32_16x16x64_bf16 v[40:43], v[8:11], v[208:215], v1
    ds_read_b128 v[52:55], v0 offset:15360
    v_smfmac_f32_16x16x64_bf16 v[40:43], v[12:15], v[224:231], v1
    v_cvt_pk_bf16_f32 v66, v68, v69
    v_cvt_pk_bf16_f32 v67, v70, v71
    v_smfmac_f32_16x16x64_bf16 v[40:43], v[16:19], v[216:223], v1
    buffer_store_dwordx4 v[64:67], v7, s[20:23], s32 offen sc1
    v_smfmac_f32_16x16x64_bf16 v[40:43], v[20:23], v[232:239], v1
    v_smfmac_f32_16x16x64_bf16 v[44:47], v[8:11], v[240:247], v1
    s_cmp_eq_u32 s40, 0
    v_mov_b32 v63, -1
    v_smfmac_f32_16x16x64_bf16 v[44:47], v[12:15], v[248:255], v1
    s_waitcnt vmcnt(2)
    v_cvt_pk_bf16_f32 v40, v40, v41
    v_smfmac_f32_16x16x64_bf16 v[44:47], v[16:19], v[24:31], v1
    v_cvt_pk_bf16_f32 v41, v42, v43
    v_smfmac_f32_16x16x64_bf16 v[44:47], v[20:23], v[32:39], v1
    v_bfi_b32 v40, 1, s7, v40
M_S_hd:
    s_cbranch_scc0 M_S_ne
    v_mov_b32 v56, 0
    s_nop 2
    v_mov_b32 v56, 0
    s_nop 2
    buffer_load_dwordx4 v[24:27], v0, s[20:23], s33 offen offset:0 sc1
    buffer_load_dwordx4 v[28:31], v0, s[20:23], s33 offen offset:1024 sc1
    buffer_load_dwordx4 v[32:35], v0, s[20:23], s33 offen offset:2048 sc1
    buffer_load_dwordx4 v[36:39], v0, s[20:23], s33 offen offset:3072 sc1
    v_cvt_pk_bf16_f32 v42, v44, v45
    v_cvt_pk_bf16_f32 v43, v46, v47
    buffer_store_dwordx4 v[40:43], v7, s[20:23], s11 offen sc1
    s_waitcnt lgkmcnt(0)
    v_lshrrev_b32 v48, 16, v4
    ds_read_b64 v[20:21], v48
    ds_read_b64 v[22:23], v3
    s_load_dword s56, s[16:17], s37 glc
    v_mov_b64 v[40:41], 0
    v_mov_b64 v[42:43], 0
    v_mov_b64 v[44:45], 0
    v_mov_b64 v[46:47], 0
    v_mov_b32 v56, 0
    s_nop 2
    v_mov_b32 v56, 0
    s_nop 2
    v_mov_b32 v56, 0
    s_nop 2
    buffer_load_dwordx4 v[8:11], v0, s[20:23], s33 offen offset:0 sc1
    buffer_load_dwordx4 v[12:15], v0, s[20:23], s33 offen offset:1024 sc1
    buffer_load_dwordx4 v[16:19], v0, s[20:23], s33 offen offset:2048 sc1
    buffer_load_dwordx4 v[64:67], v0, s[20:23], s33 offen offset:3072 sc1
    s_waitcnt vmcnt(8)
    v_mfma_f32_16x16x32_bf16 v[56:59], v[52:55], v[24:27], 0
    v_xor_b32 v60, s7, v24
    s_waitcnt vmcnt(7)
    v_mfma_f32_16x16x32_bf16 v[56:59], v[52:55], v[28:31], v[56:59]
    v_bitop3_b32 v60, v60, v28, s7 bitop3:0xf6
    s_waitcnt vmcnt(6)
    v_mfma_f32_16x16x32_bf16 v[56:59], v[52:55], v[32:35], v[56:59]
    v_bitop3_b32 v60, v60, v32, s7 bitop3:0xf6
    s_waitcnt vmcnt(5)
    v_mfma_f32_16x16x32_bf16 v[56:59], v[52:55], v[36:39], v[56:59]
    v_bitop3_b32 v60, v60, v36, s7 bitop3:0xf6
    v_and_b32 v60, 1, v60
    v_cmp_ne_u32 vcc, 0, v60
    s_nop 4
    v_add_f32_dpp v56, v56, v56 row_ror:8 row_mask:0xf bank_mask:0xf
    v_add_f32_dpp v57, v57, v57 row_ror:8 row_mask:0xf bank_mask:0xf
    v_cvt_pk_bf16_f32 v58, v56, v57
    s_cbranch_vccnz M_S_rre
M_S_rde:
    buffer_store_dword v58, v62, s[20:23], s14 offen sc1
    s_barrier
    buffer_store_dword v63, v62, s[20:23], s13 offen sc1
    s_branch M_S_g
M_S_ne:
    v_mov_b32 v56, 0
    s_nop 2
    v_mov_b32 v56, 0
    s_nop 2
    v_mov_b32 v56, 0
    s_nop 2
    v_mov_b32 v56, 0
    s_nop 2
    v_cvt_pk_bf16_f32 v42, v44, v45
    v_cvt_pk_bf16_f32 v43, v46, v47
    buffer_store_dwordx4 v[40:43], v7, s[20:23], s11 offen sc1
    s_waitcnt lgkmcnt(0)
    v_lshrrev_b32 v48, 16, v4
    ds_read_b64 v[20:21], v48
    ds_read_b64 v[22:23], v3
    s_load_dword s56, s[16:17], s37 glc
    v_mov_b64 v[40:41], 0
    v_mov_b64 v[42:43], 0
    v_mov_b64 v[44:45], 0
    v_mov_b64 v[46:47], 0
    s_cmp_eq_u32 s40, 1
    s_cbranch_scc1 M_S_lt
    s_barrier
    s_branch M_S_g0
M_S_lt:
    s_barrier
    buffer_load_dwordx4 v[24:27], v0, s[20:23], s33 offen offset:0 sc1
    buffer_load_dwordx4 v[28:31], v0, s[20:23], s33 offen offset:1024 sc1
    buffer_load_dwordx4 v[32:35], v0, s[20:23], s33 offen offset:2048 sc1
    buffer_load_dwordx4 v[36:39], v0, s[20:23], s33 offen offset:3072 sc1
    s_waitcnt vmcnt(3)
    v_mfma_f32_16x16x32_bf16 v[56:59], v[52:55], v[24:27], 0
    v_xor_b32 v60, s7, v24
    s_waitcnt vmcnt(2)
    v_mfma_f32_16x16x32_bf16 v[56:59], v[52:55], v[28:31], v[56:59]
    v_bitop3_b32 v60, v60, v28, s7 bitop3:0xf6
    s_waitcnt vmcnt(1)
    v_mfma_f32_16x16x32_bf16 v[56:59], v[52:55], v[32:35], v[56:59]
    v_bitop3_b32 v60, v60, v32, s7 bitop3:0xf6
    s_waitcnt vmcnt(0)
    v_mfma_f32_16x16x32_bf16 v[56:59], v[52:55], v[36:39], v[56:59]
    v_bitop3_b32 v60, v60, v36, s7 bitop3:0xf6
    v_and_b32 v60, 1, v60
    v_cmp_ne_u32 vcc, 0, v60
    s_nop 4
    v_add_f32_dpp v56, v56, v56 row_ror:8 row_mask:0xf bank_mask:0xf
    v_add_f32_dpp v57, v57, v57 row_ror:8 row_mask:0xf bank_mask:0xf
    v_cvt_pk_bf16_f32 v58, v56, v57
    s_cbranch_vccnz M_S_rrl
M_S_rdl:
    buffer_store_dword v58, v62, s[20:23], s14 offen sc1
    buffer_store_dword v63, v62, s[20:23], s13 offen sc1
    v_mov_b64 v[24:25], 0
    v_mov_b64 v[26:27], 0
    v_mov_b64 v[28:29], 0
    v_mov_b64 v[30:31], 0
    v_mov_b64 v[32:33], 0
    v_mov_b64 v[34:35], 0
    v_mov_b64 v[36:37], 0
    v_mov_b64 v[38:39], 0
    s_waitcnt lgkmcnt(0)
    s_branch M_S_top
M_S_ent:
    s_branch M_S_top
M_S_gr:
    s_waitcnt vmcnt(1)
    ds_write_b128 v49, v[64:67] offset:0
    v_max3_u32 v51, v64, v65, v66
    s_waitcnt vmcnt(0)
    ds_write_b128 v50, v[68:71] offset:0
    v_max3_u32 v51, v51, v67, v68
    v_max3_u32 v51, v51, v69, v70
    v_max_u32 v51, v51, v71
    v_cmpx_eq_u32 vcc, -1, v51
    s_cbranch_execz M_S_gd
    buffer_load_dwordx4 v[64:67], v49, s[20:23], s59 offen sc1
    buffer_load_dwordx4 v[68:71], v50, s[20:23], s59 offen sc1
    s_nop 15
M_S_gl:
    buffer_load_dwordx4 v[56:59], v49, s[20:23], s59 offen sc1
    buffer_load_dwordx4 v[60:63], v50, s[20:23], s59 offen sc1
    s_waitcnt vmcnt(3)
    ds_write_b128 v49, v[64:67] offset:0
    v_max3_u32 v51, v64, v65, v66
    s_waitcnt vmcnt(2)
    ds_write_b128 v50, v[68:71] offset:0
    v_max3_u32 v51, v51, v67, v68
    v_max3_u32 v51, v51, v69, v70
    v_max_u32 v51, v51, v71
    v_cmpx_eq_u32 vcc, -1, v51
    s_cbranch_execz M_S_gx
    buffer_load_dwordx4 v[64:67], v49, s[20:23], s59 offen sc1
    buffer_load_dwordx4 v[68:71], v50, s[20:23], s59 offen sc1
    s_waitcnt vmcnt(3)
    ds_write_b128 v49, v[56:59] offset:0
    v_max3_u32 v51, v56, v57, v58
    s_waitcnt vmcnt(2)
    ds_write_b128 v50, v[60:63] offset:0
    v_max3_u32 v51, v51, v59, v60
    v_max3_u32 v51, v51, v61, v62
    v_max_u32 v51, v51, v63
    v_cmpx_eq_u32 vcc, -1, v51
    s_cbranch_execz M_S_gd
    s_sub_u32 s94, s94, 1
    s_cbranch_scc0 M_S_gl
    s_mov_b32 s94, 0
M_S_gx:
    s_waitcnt vmcnt(0)
    s_branch M_S_gd
M_S_lr:
    v_cmp_eq_u32 vcc, -1, v12
    v_cmp_eq_u32 s[8:9], -1, v13
    s_or_b64 vcc, vcc, s[8:9]
    v_cmp_eq_u32 s[8:9], -1, v14
    s_or_b64 vcc, vcc, s[8:9]
    v_cmp_eq_u32 s[8:9], -1, v15
    s_or_b64 vcc, vcc, s[8:9]
    s_cbranch_scc0 M_S_ld
    s_sub_u32 s94, s94, 1
    s_cbranch_scc1 M_S_lx
    s_add_u32 m0, s46, 1024
    s_nop 0
    buffer_load_dwordx4 v0, s[20:23], s34 offen sc1 lds
    s_waitcnt vmcnt(0)
    ds_read_b128 v[12:15], v7 offset:1024
    s_waitcnt lgkmcnt(0)
    s_branch M_S_lr
M_S_lx:
    s_mov_b32 s94, 0
    s_branch M_S_ld
M_S_rre:
    s_mov_b64 exec, vcc
    buffer_load_dwordx4 v[24:27], v0, s[20:23], s33 offen offset:0 sc1
    buffer_load_dwordx4 v[28:31], v0, s[20:23], s33 offen offset:1024 sc1
    buffer_load_dwordx4 v[32:35], v0, s[20:23], s33 offen offset:2048 sc1
    buffer_load_dwordx4 v[36:39], v0, s[20:23], s33 offen offset:3072 sc1
    s_mov_b64 exec, -1
    s_waitcnt vmcnt(7)
    v_mfma_f32_16x16x32_bf16 v[56:59], v[52:55], v[8:11], 0
    v_xor_b32 v60, s7, v8
    s_waitcnt vmcnt(6)
    v_mfma_f32_16x16x32_bf16 v[56:59], v[52:55], v[12:15], v[56:59]
    v_bitop3_b32 v60, v60, v12, s7 bitop3:0xf6
    s_waitcnt vmcnt(5)
    v_mfma_f32_16x16x32_bf16 v[56:59], v[52:55], v[16:19], v[56:59]
    v_bitop3_b32 v60, v60, v16, s7 bitop3:0xf6
    s_waitcnt vmcnt(4)
    v_mfma_f32_16x16x32_bf16 v[56:59], v[52:55], v[64:67], v[56:59]
    v_bitop3_b32 v60, v60, v64, s7 bitop3:0xf6
    v_and_b32 v60, 1, v60
    v_cmp_ne_u32 vcc, 0, v60
    s_nop 4
    v_add_f32_dpp v56, v56, v56 row_ror:8 row_mask:0xf bank_mask:0xf
    v_add_f32_dpp v57, v57, v57 row_ror:8 row_mask:0xf bank_mask:0xf
    v_cvt_pk_bf16_f32 v58, v56, v57
    s_cbranch_vccz M_S_rde
M_S_rle:
    s_mov_b64 exec, vcc
    buffer_load_dwordx4 v[8:11], v0, s[20:23], s33 offen offset:0 sc1
    buffer_load_dwordx4 v[12:15], v0, s[20:23], s33 offen offset:1024 sc1
    buffer_load_dwordx4 v[16:19], v0, s[20:23], s33 offen offset:2048 sc1
    buffer_load_dwordx4 v[64:67], v0, s[20:23], s33 offen offset:3072 sc1
    s_mov_b64 exec, -1
    s_waitcnt vmcnt(7)
    v_mfma_f32_16x16x32_bf16 v[56:59], v[52:55], v[24:27], 0
    v_xor_b32 v60, s7, v24
    s_waitcnt vmcnt(6)
    v_mfma_f32_16x16x32_bf16 v[56:59], v[52:55], v[28:31], v[56:59]
    v_bitop3_b32 v60, v60, v28, s7 bitop3:0xf6
    s_waitcnt vmcnt(5)
    v_mfma_f32_16x16x32_bf16 v[56:59], v[52:55], v[32:35], v[56:59]
    v_bitop3_b32 v60, v60, v32, s7 bitop3:0xf6
    s_waitcnt vmcnt(4)
    v_mfma_f32_16x16x32_bf16 v[56:59], v[52:55], v[36:39], v[56:59]
    v_bitop3_b32 v60, v60, v36, s7 bitop3:0xf6
    v_and_b32 v60, 1, v60
    v_cmp_ne_u32 vcc, 0, v60
    s_nop 4
    v_add_f32_dpp v56, v56, v56 row_ror:8 row_mask:0xf bank_mask:0xf
    v_add_f32_dpp v57, v57, v57 row_ror:8 row_mask:0xf bank_mask:0xf
    v_cvt_pk_bf16_f32 v58, v56, v57
    s_cbranch_vccz M_S_rde
    s_mov_b64 exec, vcc
    buffer_load_dwordx4 v[24:27], v0, s[20:23], s33 offen offset:0 sc1
    buffer_load_dwordx4 v[28:31], v0, s[20:23], s33 offen offset:1024 sc1
    buffer_load_dwordx4 v[32:35], v0, s[20:23], s33 offen offset:2048 sc1
    buffer_load_dwordx4 v[36:39], v0, s[20:23], s33 offen offset:3072 sc1
    s_mov_b64 exec, -1
    s_waitcnt vmcnt(7)
    v_mfma_f32_16x16x32_bf16 v[56:59], v[52:55], v[8:11], 0
    v_xor_b32 v60, s7, v8
    s_waitcnt vmcnt(6)
    v_mfma_f32_16x16x32_bf16 v[56:59], v[52:55], v[12:15], v[56:59]
    v_bitop3_b32 v60, v60, v12, s7 bitop3:0xf6
    s_waitcnt vmcnt(5)
    v_mfma_f32_16x16x32_bf16 v[56:59], v[52:55], v[16:19], v[56:59]
    v_bitop3_b32 v60, v60, v16, s7 bitop3:0xf6
    s_waitcnt vmcnt(4)
    v_mfma_f32_16x16x32_bf16 v[56:59], v[52:55], v[64:67], v[56:59]
    v_bitop3_b32 v60, v60, v64, s7 bitop3:0xf6
    v_and_b32 v60, 1, v60
    v_cmp_ne_u32 vcc, 0, v60
    s_nop 4
    v_add_f32_dpp v56, v56, v56 row_ror:8 row_mask:0xf bank_mask:0xf
    v_add_f32_dpp v57, v57, v57 row_ror:8 row_mask:0xf bank_mask:0xf
    v_cvt_pk_bf16_f32 v58, v56, v57
    s_cbranch_vccz M_S_rde
    s_sub_u32 s94, s94, 1
    s_cbranch_scc0 M_S_rle
    s_mov_b32 s94, 0
    s_nop 7
    s_branch M_S_rde
M_S_rrl:
    s_mov_b64 exec, vcc
    buffer_load_dwordx4 v[24:27], v0, s[20:23], s33 offen offset:0 sc1
    buffer_load_dwordx4 v[28:31], v0, s[20:23], s33 offen offset:1024 sc1
    buffer_load_dwordx4 v[32:35], v0, s[20:23], s33 offen offset:2048 sc1
    buffer_load_dwordx4 v[36:39], v0, s[20:23], s33 offen offset:3072 sc1
    s_mov_b64 exec, -1
    s_waitcnt vmcnt(3)
    v_mfma_f32_16x16x32_bf16 v[56:59], v[52:55], v[24:27], 0
    v_xor_b32 v60, s7, v24
    s_waitcnt vmcnt(2)
    v_mfma_f32_16x16x32_bf16 v[56:59], v[52:55], v[28:31], v[56:59]
    v_bitop3_b32 v60, v60, v28, s7 bitop3:0xf6
    s_waitcnt vmcnt(1)
    v_mfma_f32_16x16x32_bf16 v[56:59], v[52:55], v[32:35], v[56:59]
    v_bitop3_b32 v60, v60, v32, s7 bitop3:0xf6
    s_waitcnt vmcnt(0)
    v_mfma_f32_16x16x32_bf16 v[56:59], v[52:55], v[36:39], v[56:59]
    v_bitop3_b32 v60, v60, v36, s7 bitop3:0xf6
    v_and_b32 v60, 1, v60
    v_cmp_ne_u32 vcc, 0, v60
    s_nop 4
    v_add_f32_dpp v56, v56, v56 row_ror:8 row_mask:0xf bank_mask:0xf
    v_add_f32_dpp v57, v57, v57 row_ror:8 row_mask:0xf bank_mask:0xf
    v_cvt_pk_bf16_f32 v58, v56, v57
    s_cbranch_vccz M_S_rdl
    s_sub_u32 s94, s94, 1
    s_cbranch_scc0 M_S_rrl
    s_mov_b32 s94, 0
    s_nop 7
    s_branch M_S_rdl
M_S_hw:
    buffer_load_dword v60, v61, s[20:23], s55 offen sc1
    v_cmp_ne_u32 vcc, s6, v60
    s_cbranch_vccz M_S_hd
    s_sub_u32 s94, s94, 1
    s_cbranch_scc0 M_S_hw
    s_mov_b32 s94, 0
    s_branch M_S_hd
M_S_fw:
    s_cmp_ge_u32 s6, s36
    s_cbranch_scc1 M_S_fd
M_S_fw2:
    buffer_load_dword v0, off, s[20:23], s37 sc1
    s_waitcnt vmcnt(0)
    v_readfirstlane_b32 s56, v0
    v_mbcnt_lo_u32_b32 v0, -1, 0
    v_mbcnt_hi_u32_b32 v0, -1, v0
    v_lshlrev_b32 v0, 4, v0
    s_cmp_eq_u32 s56, 1
    s_cbranch_scc1 M_S_fd
    s_sleep 1
    s_sub_u32 s94, s94, 1
    s_cbranch_scc0 M_S_fw2
    s_mov_b32 s94, 0
    s_branch M_S_fd
M_S_fin:
    v_lshrrev_b32 v28, 16, v4
    ds_read_b64 v[24:25], v28
    v_mov_b64 v[26:27], v[40:41]
    s_waitcnt lgkmcnt(0)
    s_add_u32 s57, s57, 4096
    buffer_store_dwordx4 v[24:27], v0, s[20:23], s57 offen sc1
    s_mov_b32 s95, 1
    s_cmp_lg_u32 s44, 0
    s_cbranch_scc1 M_Efin
    s_mov_b64 exec, -1
    s_add_u32 s36, s36, 63
    s_mov_b32 s44, 100663296
    s_branch M_A_layer
M_B:
    s_sub_u32 s8, s4, 32
    s_mul_hi_u32 s6, s8, 1073741824
    s_mul_i32 s7, s6, 4
    s_sub_u32 s7, s8, s7
    v_mov_b32 v10, s5
    v_lshrrev_b32 v12, 3, v0
    v_lshl_add_u32 v1, v10, 3, v12
    v_mul_u32_u24 v1, 1152, v1
    v_and_b32 v13, 7, v0
    v_lshl_add_u32 v1, v13, 4, v1
    v_lshrrev_b32 v2, 2, v12
    v_mul_u32_u24 v2, 19584, v2
    v_mul_u32_u24 v13, 272, v13
    v_add_u32 v2, v2, v13
    v_and_b32 v12, 3, v12
    v_lshl_add_u32 v12, v10, 2, v12
    v_lshl_add_u32 v2, v12, 4, v2
    v_and_b32 v10, 15, v0
    v_lshrrev_b32 v11, 2, v10
    v_lshlrev_b32 v11, 3, v11
    v_and_b32 v12, 3, v10
    v_add_u32 v11, v11, v12
    v_lshrrev_b32 v12, 4, v0
    v_lshlrev_b32 v12, 3, v12
    v_sub_u32 v3, v11, v12
    v_mov_b32 v4, 0x4444
    v_mov_b32 v11, 0xeeee
    v_and_b32 v12, 2, v0
    v_cmp_eq_u32 vcc, 2, v12
    s_nop 1
    v_cndmask_b32 v4, v4, v11, vcc
    v_lshlrev_b32 v0, 4, v0
    v_lshrrev_b32 v20, 6, v0
    v_bfe_u32 v21, v0, 4, 2
    v_lshlrev_b32 v8, 13, v20
    v_lshl_add_u32 v8, v21, 4, v8
    v_and_b32 v22, 3, v20
    v_lshrrev_b32 v23, 8, v0
    v_lshl_add_u32 v22, v23, 3, v22
    v_lshlrev_b32 v22, 6, v22
    v_lshl_add_u32 v22, v21, 4, v22
    s_lshl_b32 s9, s5, 12
    v_add_u32 v9, s9, v22
    v_add_u32 v10, s9, v0
    s_lshl_b32 s30, s6, 8
    s_lshl_b32 s9, s5, 6
    s_add_u32 s30, s30, s9
    s_add_u32 s9, s30, 0
    buffer_load_dwordx4 a[0:3], v8, s[64:67], s9 offen
    s_add_u32 s9, s30, 131072
    buffer_load_dwordx4 a[24:27], v8, s[64:67], s9 offen
    s_add_u32 s9, s30, 262144
    buffer_load_dwordx4 a[4:7], v8, s[64:67], s9 offen
    s_add_u32 s9, s30, 393216
    buffer_load_dwordx4 a[28:31], v8, s[64:67], s9 offen
    s_add_u32 s9, s30, 0
    buffer_load_dwordx4 a[8:11], v8, s[68:71], s9 offen
    s_add_u32 s9, s30, 131072
    buffer_load_dwordx4 a[32:35], v8, s[68:71], s9 offen
    s_add_u32 s9, s30, 262144
    buffer_load_dwordx4 a[12:15], v8, s[68:71], s9 offen
    s_add_u32 s9, s30, 393216
    buffer_load_dwordx4 a[36:39], v8, s[68:71], s9 offen
    s_add_u32 s9, s30, 0
    buffer_load_dwordx4 a[16:19], v8, s[72:75], s9 offen
    s_add_u32 s9, s30, 131072
    buffer_load_dwordx4 a[40:43], v8, s[72:75], s9 offen
    s_add_u32 s9, s30, 262144
    buffer_load_dwordx4 a[20:23], v8, s[72:75], s9 offen
    s_add_u32 s9, s30, 393216
    buffer_load_dwordx4 a[44:47], v8, s[72:75], s9 offen
    s_add_u32 s9, s30, 524288
    buffer_load_dwordx4 a[48:51], v8, s[64:67], s9 offen
    s_add_u32 s9, s30, 655360
    buffer_load_dwordx4 a[72:75], v8, s[64:67], s9 offen
    s_add_u32 s9, s30, 786432
    buffer_load_dwordx4 a[52:55], v8, s[64:67], s9 offen
    s_add_u32 s9, s30, 917504
    buffer_load_dwordx4 a[76:79], v8, s[64:67], s9 offen
    s_add_u32 s9, s30, 524288
    buffer_load_dwordx4 a[56:59], v8, s[68:71], s9 offen
    s_add_u32 s9, s30, 655360
    buffer_load_dwordx4 a[80:83], v8, s[68:71], s9 offen
    s_add_u32 s9, s30, 786432
    buffer_load_dwordx4 a[60:63], v8, s[68:71], s9 offen
    s_add_u32 s9, s30, 917504
    buffer_load_dwordx4 a[84:87], v8, s[68:71], s9 offen
    s_add_u32 s9, s30, 524288
    buffer_load_dwordx4 a[64:67], v8, s[72:75], s9 offen
    s_add_u32 s9, s30, 655360
    buffer_load_dwordx4 a[88:91], v8, s[72:75], s9 offen
    s_add_u32 s9, s30, 786432
    buffer_load_dwordx4 a[68:71], v8, s[72:75], s9 offen
    s_add_u32 s9, s30, 917504
    buffer_load_dwordx4 a[92:95], v8, s[72:75], s9 offen
    s_waitcnt vmcnt(20)
    s_barrier
    ds_write_b128 v10, a[0:3] offset:0
    ds_write_b128 v10, a[24:27] offset:1024
    ds_write_b128 v10, a[4:7] offset:2048
    ds_write_b128 v10, a[28:31] offset:3072
    ds_read_b64_tr_b16 a[0:1], v9 offset:0
    ds_read_b64_tr_b16 a[2:3], v9 offset:256
    ds_read_b64_tr_b16 a[24:25], v9 offset:2048
    ds_read_b64_tr_b16 a[26:27], v9 offset:2304
    ds_read_b64_tr_b16 a[4:5], v9 offset:8
    ds_read_b64_tr_b16 a[6:7], v9 offset:264
    ds_read_b64_tr_b16 a[28:29], v9 offset:2056
    ds_read_b64_tr_b16 a[30:31], v9 offset:2312
    s_add_u32 s9, s30, 1048576
    buffer_load_dwordx4 a[96:99], v8, s[64:67], s9 offen
    s_add_u32 s9, s30, 1179648
    buffer_load_dwordx4 a[120:123], v8, s[64:67], s9 offen
    s_add_u32 s9, s30, 1310720
    buffer_load_dwordx4 a[100:103], v8, s[64:67], s9 offen
    s_add_u32 s9, s30, 1441792
    buffer_load_dwordx4 a[124:127], v8, s[64:67], s9 offen
    s_waitcnt vmcnt(20)
    s_barrier
    ds_write_b128 v10, a[8:11] offset:0
    ds_write_b128 v10, a[32:35] offset:1024
    ds_write_b128 v10, a[12:15] offset:2048
    ds_write_b128 v10, a[36:39] offset:3072
    ds_read_b64_tr_b16 a[8:9], v9 offset:0
    ds_read_b64_tr_b16 a[10:11], v9 offset:256
    ds_read_b64_tr_b16 a[32:33], v9 offset:2048
    ds_read_b64_tr_b16 a[34:35], v9 offset:2304
    ds_read_b64_tr_b16 a[12:13], v9 offset:8
    ds_read_b64_tr_b16 a[14:15], v9 offset:264
    ds_read_b64_tr_b16 a[36:37], v9 offset:2056
    ds_read_b64_tr_b16 a[38:39], v9 offset:2312
    s_add_u32 s9, s30, 1048576
    buffer_load_dwordx4 a[104:107], v8, s[68:71], s9 offen
    s_add_u32 s9, s30, 1179648
    buffer_load_dwordx4 a[128:131], v8, s[68:71], s9 offen
    s_add_u32 s9, s30, 1310720
    buffer_load_dwordx4 a[108:111], v8, s[68:71], s9 offen
    s_add_u32 s9, s30, 1441792
    buffer_load_dwordx4 a[132:135], v8, s[68:71], s9 offen
    s_waitcnt vmcnt(20)
    s_barrier
    ds_write_b128 v10, a[16:19] offset:0
    ds_write_b128 v10, a[40:43] offset:1024
    ds_write_b128 v10, a[20:23] offset:2048
    ds_write_b128 v10, a[44:47] offset:3072
    ds_read_b64_tr_b16 a[16:17], v9 offset:0
    ds_read_b64_tr_b16 a[18:19], v9 offset:256
    ds_read_b64_tr_b16 a[40:41], v9 offset:2048
    ds_read_b64_tr_b16 a[42:43], v9 offset:2304
    ds_read_b64_tr_b16 a[20:21], v9 offset:8
    ds_read_b64_tr_b16 a[22:23], v9 offset:264
    ds_read_b64_tr_b16 a[44:45], v9 offset:2056
    ds_read_b64_tr_b16 a[46:47], v9 offset:2312
    s_add_u32 s9, s30, 1048576
    buffer_load_dwordx4 a[112:115], v8, s[72:75], s9 offen
    s_add_u32 s9, s30, 1179648
    buffer_load_dwordx4 a[136:139], v8, s[72:75], s9 offen
    s_add_u32 s9, s30, 1310720
    buffer_load_dwordx4 a[116:119], v8, s[72:75], s9 offen
    s_add_u32 s9, s30, 1441792
    buffer_load_dwordx4 a[140:143], v8, s[72:75], s9 offen
    s_waitcnt vmcnt(20)
    s_barrier
    ds_write_b128 v10, a[48:51] offset:0
    ds_write_b128 v10, a[72:75] offset:1024
    ds_write_b128 v10, a[52:55] offset:2048
    ds_write_b128 v10, a[76:79] offset:3072
    ds_read_b64_tr_b16 a[48:49], v9 offset:0
    ds_read_b64_tr_b16 a[50:51], v9 offset:256
    ds_read_b64_tr_b16 a[72:73], v9 offset:2048
    ds_read_b64_tr_b16 a[74:75], v9 offset:2304
    ds_read_b64_tr_b16 a[52:53], v9 offset:8
    ds_read_b64_tr_b16 a[54:55], v9 offset:264
    ds_read_b64_tr_b16 a[76:77], v9 offset:2056
    ds_read_b64_tr_b16 a[78:79], v9 offset:2312
    s_add_u32 s9, s30, 1572864
    buffer_load_dwordx4 a[144:147], v8, s[64:67], s9 offen
    s_add_u32 s9, s30, 1703936
    buffer_load_dwordx4 a[168:171], v8, s[64:67], s9 offen
    s_add_u32 s9, s30, 1835008
    buffer_load_dwordx4 a[148:151], v8, s[64:67], s9 offen
    s_add_u32 s9, s30, 1966080
    buffer_load_dwordx4 a[172:175], v8, s[64:67], s9 offen
    s_waitcnt vmcnt(20)
    s_barrier
    ds_write_b128 v10, a[56:59] offset:0
    ds_write_b128 v10, a[80:83] offset:1024
    ds_write_b128 v10, a[60:63] offset:2048
    ds_write_b128 v10, a[84:87] offset:3072
    ds_read_b64_tr_b16 a[56:57], v9 offset:0
    ds_read_b64_tr_b16 a[58:59], v9 offset:256
    ds_read_b64_tr_b16 a[80:81], v9 offset:2048
    ds_read_b64_tr_b16 a[82:83], v9 offset:2304
    ds_read_b64_tr_b16 a[60:61], v9 offset:8
    ds_read_b64_tr_b16 a[62:63], v9 offset:264
    ds_read_b64_tr_b16 a[84:85], v9 offset:2056
    ds_read_b64_tr_b16 a[86:87], v9 offset:2312
    s_add_u32 s9, s30, 1572864
    buffer_load_dwordx4 a[152:155], v8, s[68:71], s9 offen
    s_add_u32 s9, s30, 1703936
    buffer_load_dwordx4 a[176:179], v8, s[68:71], s9 offen
    s_add_u32 s9, s30, 1835008
    buffer_load_dwordx4 a[156:159], v8, s[68:71], s9 offen
    s_add_u32 s9, s30, 1966080
    buffer_load_dwordx4 a[180:183], v8, s[68:71], s9 offen
    s_waitcnt vmcnt(20)
    s_barrier
    ds_write_b128 v10, a[64:67] offset:0
    ds_write_b128 v10, a[88:91] offset:1024
    ds_write_b128 v10, a[68:71] offset:2048
    ds_write_b128 v10, a[92:95] offset:3072
    ds_read_b64_tr_b16 a[64:65], v9 offset:0
    ds_read_b64_tr_b16 a[66:67], v9 offset:256
    ds_read_b64_tr_b16 a[88:89], v9 offset:2048
    ds_read_b64_tr_b16 a[90:91], v9 offset:2304
    ds_read_b64_tr_b16 a[68:69], v9 offset:8
    ds_read_b64_tr_b16 a[70:71], v9 offset:264
    ds_read_b64_tr_b16 a[92:93], v9 offset:2056
    ds_read_b64_tr_b16 a[94:95], v9 offset:2312
    s_add_u32 s9, s30, 1572864
    buffer_load_dwordx4 a[160:163], v8, s[72:75], s9 offen
    s_add_u32 s9, s30, 1703936
    buffer_load_dwordx4 a[184:187], v8, s[72:75], s9 offen
    s_add_u32 s9, s30, 1835008
    buffer_load_dwordx4 a[164:167], v8, s[72:75], s9 offen
    s_add_u32 s9, s30, 1966080
    buffer_load_dwordx4 a[188:191], v8, s[72:75], s9 offen
    s_waitcnt vmcnt(20)
    s_barrier
    ds_write_b128 v10, a[96:99] offset:0
    ds_write_b128 v10, a[120:123] offset:1024
    ds_write_b128 v10, a[100:103] offset:2048
    ds_write_b128 v10, a[124:127] offset:3072
    ds_read_b64_tr_b16 a[96:97], v9 offset:0
    ds_read_b64_tr_b16 a[98:99], v9 offset:256
    ds_read_b64_tr_b16 a[120:121], v9 offset:2048
    ds_read_b64_tr_b16 a[122:123], v9 offset:2304
    ds_read_b64_tr_b16 a[100:101], v9 offset:8
    ds_read_b64_tr_b16 a[102:103], v9 offset:264
    ds_read_b64_tr_b16 a[124:125], v9 offset:2056
    ds_read_b64_tr_b16 a[126:127], v9 offset:2312
    s_add_u32 s9, s30, 2097152
    buffer_load_dwordx4 a[192:195], v8, s[64:67], s9 offen
    s_add_u32 s9, s30, 2228224
    buffer_load_dwordx4 a[216:219], v8, s[64:67], s9 offen
    s_add_u32 s9, s30, 2359296
    buffer_load_dwordx4 a[196:199], v8, s[64:67], s9 offen
    s_add_u32 s9, s30, 2490368
    buffer_load_dwordx4 a[220:223], v8, s[64:67], s9 offen
    s_waitcnt vmcnt(20)
    s_barrier
    ds_write_b128 v10, a[104:107] offset:0
    ds_write_b128 v10, a[128:131] offset:1024
    ds_write_b128 v10, a[108:111] offset:2048
    ds_write_b128 v10, a[132:135] offset:3072
    ds_read_b64_tr_b16 a[104:105], v9 offset:0
    ds_read_b64_tr_b16 a[106:107], v9 offset:256
    ds_read_b64_tr_b16 a[128:129], v9 offset:2048
    ds_read_b64_tr_b16 a[130:131], v9 offset:2304
    ds_read_b64_tr_b16 a[108:109], v9 offset:8
    ds_read_b64_tr_b16 a[110:111], v9 offset:264
    ds_read_b64_tr_b16 a[132:133], v9 offset:2056
    ds_read_b64_tr_b16 a[134:135], v9 offset:2312
    s_add_u32 s9, s30, 2097152
    buffer_load_dwordx4 a[200:203], v8, s[68:71], s9 offen
    s_add_u32 s9, s30, 2228224
    buffer_load_dwordx4 a[224:227], v8, s[68:71], s9 offen
    s_add_u32 s9, s30, 2359296
    buffer_load_dwordx4 a[204:207], v8, s[68:71], s9 offen
    s_add_u32 s9, s30, 2490368
    buffer_load_dwordx4 a[228:231], v8, s[68:71], s9 offen
    s_waitcnt vmcnt(20)
    s_barrier
    ds_write_b128 v10, a[112:115] offset:0
    ds_write_b128 v10, a[136:139] offset:1024
    ds_write_b128 v10, a[116:119] offset:2048
    ds_write_b128 v10, a[140:143] offset:3072
    ds_read_b64_tr_b16 a[112:113], v9 offset:0
    ds_read_b64_tr_b16 a[114:115], v9 offset:256
    ds_read_b64_tr_b16 a[136:137], v9 offset:2048
    ds_read_b64_tr_b16 a[138:139], v9 offset:2304
    ds_read_b64_tr_b16 a[116:117], v9 offset:8
    ds_read_b64_tr_b16 a[118:119], v9 offset:264
    ds_read_b64_tr_b16 a[140:141], v9 offset:2056
    ds_read_b64_tr_b16 a[142:143], v9 offset:2312
    s_add_u32 s9, s30, 2097152
    buffer_load_dwordx4 a[208:211], v8, s[72:75], s9 offen
    s_add_u32 s9, s30, 2228224
    buffer_load_dwordx4 a[232:235], v8, s[72:75], s9 offen
    s_add_u32 s9, s30, 2359296
    buffer_load_dwordx4 a[212:215], v8, s[72:75], s9 offen
    s_add_u32 s9, s30, 2490368
    buffer_load_dwordx4 a[236:239], v8, s[72:75], s9 offen
    s_waitcnt vmcnt(20)
    s_barrier
    ds_write_b128 v10, a[144:147] offset:0
    ds_write_b128 v10, a[168:171] offset:1024
    ds_write_b128 v10, a[148:151] offset:2048
    ds_write_b128 v10, a[172:175] offset:3072
    ds_read_b64_tr_b16 a[144:145], v9 offset:0
    ds_read_b64_tr_b16 a[146:147], v9 offset:256
    ds_read_b64_tr_b16 a[168:169], v9 offset:2048
    ds_read_b64_tr_b16 a[170:171], v9 offset:2304
    ds_read_b64_tr_b16 a[148:149], v9 offset:8
    ds_read_b64_tr_b16 a[150:151], v9 offset:264
    ds_read_b64_tr_b16 a[172:173], v9 offset:2056
    ds_read_b64_tr_b16 a[174:175], v9 offset:2312
    s_add_u32 s9, s30, 2621440
    buffer_load_dwordx4 a[240:243], v8, s[64:67], s9 offen
    s_add_u32 s9, s30, 2752512
    buffer_load_dwordx4 v[88:91], v8, s[64:67], s9 offen
    s_add_u32 s9, s30, 2883584
    buffer_load_dwordx4 a[244:247], v8, s[64:67], s9 offen
    s_add_u32 s9, s30, 3014656
    buffer_load_dwordx4 v[92:95], v8, s[64:67], s9 offen
    s_waitcnt vmcnt(20)
    s_barrier
    ds_write_b128 v10, a[152:155] offset:0
    ds_write_b128 v10, a[176:179] offset:1024
    ds_write_b128 v10, a[156:159] offset:2048
    ds_write_b128 v10, a[180:183] offset:3072
    ds_read_b64_tr_b16 a[152:153], v9 offset:0
    ds_read_b64_tr_b16 a[154:155], v9 offset:256
    ds_read_b64_tr_b16 a[176:177], v9 offset:2048
    ds_read_b64_tr_b16 a[178:179], v9 offset:2304
    ds_read_b64_tr_b16 a[156:157], v9 offset:8
    ds_read_b64_tr_b16 a[158:159], v9 offset:264
    ds_read_b64_tr_b16 a[180:181], v9 offset:2056
    ds_read_b64_tr_b16 a[182:183], v9 offset:2312
    s_add_u32 s9, s30, 2621440
    buffer_load_dwordx4 a[248:251], v8, s[68:71], s9 offen
    s_add_u32 s9, s30, 2752512
    buffer_load_dwordx4 v[96:99], v8, s[68:71], s9 offen
    s_add_u32 s9, s30, 2883584
    buffer_load_dwordx4 a[252:255], v8, s[68:71], s9 offen
    s_add_u32 s9, s30, 3014656
    buffer_load_dwordx4 v[100:103], v8, s[68:71], s9 offen
    s_waitcnt vmcnt(20)
    s_barrier
    ds_write_b128 v10, a[160:163] offset:0
    ds_write_b128 v10, a[184:187] offset:1024
    ds_write_b128 v10, a[164:167] offset:2048
    ds_write_b128 v10, a[188:191] offset:3072
    ds_read_b64_tr_b16 a[160:161], v9 offset:0
    ds_read_b64_tr_b16 a[162:163], v9 offset:256
    ds_read_b64_tr_b16 a[184:185], v9 offset:2048
    ds_read_b64_tr_b16 a[186:187], v9 offset:2304
    ds_read_b64_tr_b16 a[164:165], v9 offset:8
    ds_read_b64_tr_b16 a[166:167], v9 offset:264
    ds_read_b64_tr_b16 a[188:189], v9 offset:2056
    ds_read_b64_tr_b16 a[190:191], v9 offset:2312
    s_add_u32 s9, s30, 2621440
    buffer_load_dwordx4 v[80:83], v8, s[72:75], s9 offen
    s_add_u32 s9, s30, 2752512
    buffer_load_dwordx4 v[104:107], v8, s[72:75], s9 offen
    s_add_u32 s9, s30, 2883584
    buffer_load_dwordx4 v[84:87], v8, s[72:75], s9 offen
    s_add_u32 s9, s30, 3014656
    buffer_load_dwordx4 v[108:111], v8, s[72:75], s9 offen
    s_waitcnt vmcnt(20)
    s_barrier
    ds_write_b128 v10, a[192:195] offset:0
    ds_write_b128 v10, a[216:219] offset:1024
    ds_write_b128 v10, a[196:199] offset:2048
    ds_write_b128 v10, a[220:223] offset:3072
    ds_read_b64_tr_b16 a[192:193], v9 offset:0
    ds_read_b64_tr_b16 a[194:195], v9 offset:256
    ds_read_b64_tr_b16 a[216:217], v9 offset:2048
    ds_read_b64_tr_b16 a[218:219], v9 offset:2304
    ds_read_b64_tr_b16 a[196:197], v9 offset:8
    ds_read_b64_tr_b16 a[198:199], v9 offset:264
    ds_read_b64_tr_b16 a[220:221], v9 offset:2056
    ds_read_b64_tr_b16 a[222:223], v9 offset:2312
    s_add_u32 s9, s30, 3145728
    buffer_load_dwordx4 v[112:115], v8, s[64:67], s9 offen
    s_add_u32 s9, s30, 3276800
    buffer_load_dwordx4 v[136:139], v8, s[64:67], s9 offen
    s_add_u32 s9, s30, 3407872
    buffer_load_dwordx4 v[116:119], v8, s[64:67], s9 offen
    s_add_u32 s9, s30, 3538944
    buffer_load_dwordx4 v[140:143], v8, s[64:67], s9 offen
    s_waitcnt vmcnt(20)
    s_barrier
    ds_write_b128 v10, a[200:203] offset:0
    ds_write_b128 v10, a[224:227] offset:1024
    ds_write_b128 v10, a[204:207] offset:2048
    ds_write_b128 v10, a[228:231] offset:3072
    ds_read_b64_tr_b16 a[200:201], v9 offset:0
    ds_read_b64_tr_b16 a[202:203], v9 offset:256
    ds_read_b64_tr_b16 a[224:225], v9 offset:2048
    ds_read_b64_tr_b16 a[226:227], v9 offset:2304
    ds_read_b64_tr_b16 a[204:205], v9 offset:8
    ds_read_b64_tr_b16 a[206:207], v9 offset:264
    ds_read_b64_tr_b16 a[228:229], v9 offset:2056
    ds_read_b64_tr_b16 a[230:231], v9 offset:2312
    s_add_u32 s9, s30, 3145728
    buffer_load_dwordx4 v[120:123], v8, s[68:71], s9 offen
    s_add_u32 s9, s30, 3276800
    buffer_load_dwordx4 v[144:147], v8, s[68:71], s9 offen
    s_add_u32 s9, s30, 3407872
    buffer_load_dwordx4 v[124:127], v8, s[68:71], s9 offen
    s_add_u32 s9, s30, 3538944
    buffer_load_dwordx4 v[148:151], v8, s[68:71], s9 offen
    s_waitcnt vmcnt(20)
    s_barrier
    ds_write_b128 v10, a[208:211] offset:0
    ds_write_b128 v10, a[232:235] offset:1024
    ds_write_b128 v10, a[212:215] offset:2048
    ds_write_b128 v10, a[236:239] offset:3072
    ds_read_b64_tr_b16 a[208:209], v9 offset:0
    ds_read_b64_tr_b16 a[210:211], v9 offset:256
    ds_read_b64_tr_b16 a[232:233], v9 offset:2048
    ds_read_b64_tr_b16 a[234:235], v9 offset:2304
    ds_read_b64_tr_b16 a[212:213], v9 offset:8
    ds_read_b64_tr_b16 a[214:215], v9 offset:264
    ds_read_b64_tr_b16 a[236:237], v9 offset:2056
    ds_read_b64_tr_b16 a[238:239], v9 offset:2312
    s_add_u32 s9, s30, 3145728
    buffer_load_dwordx4 v[128:131], v8, s[72:75], s9 offen
    s_add_u32 s9, s30, 3276800
    buffer_load_dwordx4 v[152:155], v8, s[72:75], s9 offen
    s_add_u32 s9, s30, 3407872
    buffer_load_dwordx4 v[132:135], v8, s[72:75], s9 offen
    s_add_u32 s9, s30, 3538944
    buffer_load_dwordx4 v[156:159], v8, s[72:75], s9 offen
    s_waitcnt vmcnt(20)
    s_barrier
    ds_write_b128 v10, a[240:243] offset:0
    ds_write_b128 v10, v[88:91] offset:1024
    ds_write_b128 v10, a[244:247] offset:2048
    ds_write_b128 v10, v[92:95] offset:3072
    ds_read_b64_tr_b16 a[240:241], v9 offset:0
    ds_read_b64_tr_b16 a[242:243], v9 offset:256
    ds_read_b64_tr_b16 v[88:89], v9 offset:2048
    ds_read_b64_tr_b16 v[90:91], v9 offset:2304
    ds_read_b64_tr_b16 a[244:245], v9 offset:8
    ds_read_b64_tr_b16 a[246:247], v9 offset:264
    ds_read_b64_tr_b16 v[92:93], v9 offset:2056
    ds_read_b64_tr_b16 v[94:95], v9 offset:2312
    s_add_u32 s9, s30, 3670016
    buffer_load_dwordx4 v[160:163], v8, s[64:67], s9 offen
    s_add_u32 s9, s30, 3801088
    buffer_load_dwordx4 v[184:187], v8, s[64:67], s9 offen
    s_add_u32 s9, s30, 3932160
    buffer_load_dwordx4 v[164:167], v8, s[64:67], s9 offen
    s_add_u32 s9, s30, 4063232
    buffer_load_dwordx4 v[188:191], v8, s[64:67], s9 offen
    s_waitcnt vmcnt(20)
    s_barrier
    ds_write_b128 v10, a[248:251] offset:0
    ds_write_b128 v10, v[96:99] offset:1024
    ds_write_b128 v10, a[252:255] offset:2048
    ds_write_b128 v10, v[100:103] offset:3072
    ds_read_b64_tr_b16 a[248:249], v9 offset:0
    ds_read_b64_tr_b16 a[250:251], v9 offset:256
    ds_read_b64_tr_b16 v[96:97], v9 offset:2048
    ds_read_b64_tr_b16 v[98:99], v9 offset:2304
    ds_read_b64_tr_b16 a[252:253], v9 offset:8
    ds_read_b64_tr_b16 a[254:255], v9 offset:264
    ds_read_b64_tr_b16 v[100:101], v9 offset:2056
    ds_read_b64_tr_b16 v[102:103], v9 offset:2312
    s_add_u32 s9, s30, 3670016
    buffer_load_dwordx4 v[168:171], v8, s[68:71], s9 offen
    s_add_u32 s9, s30, 3801088
    buffer_load_dwordx4 v[192:195], v8, s[68:71], s9 offen
    s_add_u32 s9, s30, 3932160
    buffer_load_dwordx4 v[172:175], v8, s[68:71], s9 offen
    s_add_u32 s9, s30, 4063232
    buffer_load_dwordx4 v[196:199], v8, s[68:71], s9 offen
    s_waitcnt vmcnt(20)
    s_barrier
    ds_write_b128 v10, v[80:83] offset:0
    ds_write_b128 v10, v[104:107] offset:1024
    ds_write_b128 v10, v[84:87] offset:2048
    ds_write_b128 v10, v[108:111] offset:3072
    ds_read_b64_tr_b16 v[80:81], v9 offset:0
    ds_read_b64_tr_b16 v[82:83], v9 offset:256
    ds_read_b64_tr_b16 v[104:105], v9 offset:2048
    ds_read_b64_tr_b16 v[106:107], v9 offset:2304
    ds_read_b64_tr_b16 v[84:85], v9 offset:8
    ds_read_b64_tr_b16 v[86:87], v9 offset:264
    ds_read_b64_tr_b16 v[108:109], v9 offset:2056
    ds_read_b64_tr_b16 v[110:111], v9 offset:2312
    s_add_u32 s9, s30, 3670016
    buffer_load_dwordx4 v[176:179], v8, s[72:75], s9 offen
    s_add_u32 s9, s30, 3801088
    buffer_load_dwordx4 v[200:203], v8, s[72:75], s9 offen
    s_add_u32 s9, s30, 3932160
    buffer_load_dwordx4 v[180:183], v8, s[72:75], s9 offen
    s_add_u32 s9, s30, 4063232
    buffer_load_dwordx4 v[204:207], v8, s[72:75], s9 offen
    s_waitcnt vmcnt(20)
    s_barrier
    ds_write_b128 v10, v[112:115] offset:0
    ds_write_b128 v10, v[136:139] offset:1024
    ds_write_b128 v10, v[116:119] offset:2048
    ds_write_b128 v10, v[140:143] offset:3072
    ds_read_b64_tr_b16 v[112:113], v9 offset:0
    ds_read_b64_tr_b16 v[114:115], v9 offset:256
    ds_read_b64_tr_b16 v[136:137], v9 offset:2048
    ds_read_b64_tr_b16 v[138:139], v9 offset:2304
    ds_read_b64_tr_b16 v[116:117], v9 offset:8
    ds_read_b64_tr_b16 v[118:119], v9 offset:264
    ds_read_b64_tr_b16 v[140:141], v9 offset:2056
    ds_read_b64_tr_b16 v[142:143], v9 offset:2312
    s_add_u32 s9, s30, 4194304
    buffer_load_dwordx4 v[208:211], v8, s[64:67], s9 offen
    s_add_u32 s9, s30, 4325376
    buffer_load_dwordx4 v[232:235], v8, s[64:67], s9 offen
    s_add_u32 s9, s30, 4456448
    buffer_load_dwordx4 v[212:215], v8, s[64:67], s9 offen
    s_add_u32 s9, s30, 4587520
    buffer_load_dwordx4 v[236:239], v8, s[64:67], s9 offen
    s_waitcnt vmcnt(20)
    s_barrier
    ds_write_b128 v10, v[120:123] offset:0
    ds_write_b128 v10, v[144:147] offset:1024
    ds_write_b128 v10, v[124:127] offset:2048
    ds_write_b128 v10, v[148:151] offset:3072
    ds_read_b64_tr_b16 v[120:121], v9 offset:0
    ds_read_b64_tr_b16 v[122:123], v9 offset:256
    ds_read_b64_tr_b16 v[144:145], v9 offset:2048
    ds_read_b64_tr_b16 v[146:147], v9 offset:2304
    ds_read_b64_tr_b16 v[124:125], v9 offset:8
    ds_read_b64_tr_b16 v[126:127], v9 offset:264
    ds_read_b64_tr_b16 v[148:149], v9 offset:2056
    ds_read_b64_tr_b16 v[150:151], v9 offset:2312
    s_add_u32 s9, s30, 4194304
    buffer_load_dwordx4 v[216:219], v8, s[68:71], s9 offen
    s_add_u32 s9, s30, 4325376
    buffer_load_dwordx4 v[240:243], v8, s[68:71], s9 offen
    s_add_u32 s9, s30, 4456448
    buffer_load_dwordx4 v[220:223], v8, s[68:71], s9 offen
    s_add_u32 s9, s30, 4587520
    buffer_load_dwordx4 v[244:247], v8, s[68:71], s9 offen
    s_waitcnt vmcnt(20)
    s_barrier
    ds_write_b128 v10, v[128:131] offset:0
    ds_write_b128 v10, v[152:155] offset:1024
    ds_write_b128 v10, v[132:135] offset:2048
    ds_write_b128 v10, v[156:159] offset:3072
    ds_read_b64_tr_b16 v[128:129], v9 offset:0
    ds_read_b64_tr_b16 v[130:131], v9 offset:256
    ds_read_b64_tr_b16 v[152:153], v9 offset:2048
    ds_read_b64_tr_b16 v[154:155], v9 offset:2304
    ds_read_b64_tr_b16 v[132:133], v9 offset:8
    ds_read_b64_tr_b16 v[134:135], v9 offset:264
    ds_read_b64_tr_b16 v[156:157], v9 offset:2056
    ds_read_b64_tr_b16 v[158:159], v9 offset:2312
    s_add_u32 s9, s30, 4194304
    buffer_load_dwordx4 v[224:227], v8, s[72:75], s9 offen
    s_add_u32 s9, s30, 4325376
    buffer_load_dwordx4 v[248:251], v8, s[72:75], s9 offen
    s_add_u32 s9, s30, 4456448
    buffer_load_dwordx4 v[228:231], v8, s[72:75], s9 offen
    s_add_u32 s9, s30, 4587520
    buffer_load_dwordx4 v[252:255], v8, s[72:75], s9 offen
    s_waitcnt vmcnt(20)
    s_barrier
    ds_write_b128 v10, v[160:163] offset:0
    ds_write_b128 v10, v[184:187] offset:1024
    ds_write_b128 v10, v[164:167] offset:2048
    ds_write_b128 v10, v[188:191] offset:3072
    ds_read_b64_tr_b16 v[160:161], v9 offset:0
    ds_read_b64_tr_b16 v[162:163], v9 offset:256
    ds_read_b64_tr_b16 v[184:185], v9 offset:2048
    ds_read_b64_tr_b16 v[186:187], v9 offset:2304
    ds_read_b64_tr_b16 v[164:165], v9 offset:8
    ds_read_b64_tr_b16 v[166:167], v9 offset:264
    ds_read_b64_tr_b16 v[188:189], v9 offset:2056
    ds_read_b64_tr_b16 v[190:191], v9 offset:2312
    s_waitcnt vmcnt(16)
    s_barrier
    ds_write_b128 v10, v[168:171] offset:0
    ds_write_b128 v10, v[192:195] offset:1024
    ds_write_b128 v10, v[172:175] offset:2048
    ds_write_b128 v10, v[196:199] offset:3072
    ds_read_b64_tr_b16 v[168:169], v9 offset:0
    ds_read_b64_tr_b16 v[170:171], v9 offset:256
    ds_read_b64_tr_b16 v[192:193], v9 offset:2048
    ds_read_b64_tr_b16 v[194:195], v9 offset:2304
    ds_read_b64_tr_b16 v[172:173], v9 offset:8
    ds_read_b64_tr_b16 v[174:175], v9 offset:264
    ds_read_b64_tr_b16 v[196:197], v9 offset:2056
    ds_read_b64_tr_b16 v[198:199], v9 offset:2312
    s_waitcnt vmcnt(12)
    s_barrier
    ds_write_b128 v10, v[176:179] offset:0
    ds_write_b128 v10, v[200:203] offset:1024
    ds_write_b128 v10, v[180:183] offset:2048
    ds_write_b128 v10, v[204:207] offset:3072
    ds_read_b64_tr_b16 v[176:177], v9 offset:0
    ds_read_b64_tr_b16 v[178:179], v9 offset:256
    ds_read_b64_tr_b16 v[200:201], v9 offset:2048
    ds_read_b64_tr_b16 v[202:203], v9 offset:2304
    ds_read_b64_tr_b16 v[180:181], v9 offset:8
    ds_read_b64_tr_b16 v[182:183], v9 offset:264
    ds_read_b64_tr_b16 v[204:205], v9 offset:2056
    ds_read_b64_tr_b16 v[206:207], v9 offset:2312
    s_waitcnt vmcnt(8)
    s_barrier
    ds_write_b128 v10, v[208:211] offset:0
    ds_write_b128 v10, v[232:235] offset:1024
    ds_write_b128 v10, v[212:215] offset:2048
    ds_write_b128 v10, v[236:239] offset:3072
    ds_read_b64_tr_b16 v[208:209], v9 offset:0
    ds_read_b64_tr_b16 v[210:211], v9 offset:256
    ds_read_b64_tr_b16 v[232:233], v9 offset:2048
    ds_read_b64_tr_b16 v[234:235], v9 offset:2304
    ds_read_b64_tr_b16 v[212:213], v9 offset:8
    ds_read_b64_tr_b16 v[214:215], v9 offset:264
    ds_read_b64_tr_b16 v[236:237], v9 offset:2056
    ds_read_b64_tr_b16 v[238:239], v9 offset:2312
    s_waitcnt vmcnt(4)
    s_barrier
    ds_write_b128 v10, v[216:219] offset:0
    ds_write_b128 v10, v[240:243] offset:1024
    ds_write_b128 v10, v[220:223] offset:2048
    ds_write_b128 v10, v[244:247] offset:3072
    ds_read_b64_tr_b16 v[216:217], v9 offset:0
    ds_read_b64_tr_b16 v[218:219], v9 offset:256
    ds_read_b64_tr_b16 v[240:241], v9 offset:2048
    ds_read_b64_tr_b16 v[242:243], v9 offset:2304
    ds_read_b64_tr_b16 v[220:221], v9 offset:8
    ds_read_b64_tr_b16 v[222:223], v9 offset:264
    ds_read_b64_tr_b16 v[244:245], v9 offset:2056
    ds_read_b64_tr_b16 v[246:247], v9 offset:2312
    s_waitcnt vmcnt(0)
    s_barrier
    ds_write_b128 v10, v[224:227] offset:0
    ds_write_b128 v10, v[248:251] offset:1024
    ds_write_b128 v10, v[228:231] offset:2048
    ds_write_b128 v10, v[252:255] offset:3072
    ds_read_b64_tr_b16 v[224:225], v9 offset:0
    ds_read_b64_tr_b16 v[226:227], v9 offset:256
    ds_read_b64_tr_b16 v[248:249], v9 offset:2048
    ds_read_b64_tr_b16 v[250:251], v9 offset:2304
    ds_read_b64_tr_b16 v[228:229], v9 offset:8
    ds_read_b64_tr_b16 v[230:231], v9 offset:264
    ds_read_b64_tr_b16 v[252:253], v9 offset:2056
    ds_read_b64_tr_b16 v[254:255], v9 offset:2312
    s_waitcnt lgkmcnt(0)
    s_barrier
    v_mov_b32 v8, 40
wd_3:
    global_load_dword v9, v8, s[28:29] sc1
    s_waitcnt vmcnt(0)
    v_readfirstlane_b32 s9, v9
    s_cmp_ge_u32 s9, 96
    s_cbranch_scc1 wd_3d
    s_sleep 4
    s_sub_u32 s94, s94, 1
    s_cbranch_scc0 wd_3
    s_mov_b32 s94, 0
wd_3d:
    s_getpc_b64 s[8:9]
wm_4:
    s_add_u32 s8, s8, M_B_loop-wm_4
    s_addc_u32 s9, s9, 0
    v_lshlrev_b32 v8, 3, v0
    v_add_u32 v8, 0, v8
    v_min_u32 v8, M_B_next-M_B_loop, v8
    global_load_dword v9, v8, s[8:9]
    s_waitcnt vmcnt(0)
M_B_layer:
    s_lshl_b32 s16, s6, 21
    s_mov_b32 s10, s7
    s_mov_b32 s11, -1
    s_mov_b32 s12, 43008
    s_mov_b32 s13, 67584
    s_mov_b32 s14, 1040356334
    s_waitcnt vmcnt(0)
M_B_loop:
    s_cmp_ge_u32 s10, 64
    s_cbranch_scc1 M_B_attn
    s_xor_b32 s41, s95, 1
    s_lshl_b32 s40, s10, 4
    s_add_u32 s40, s40, 93913088
    s_cmp_eq_u32 s95, 0
    s_cbranch_scc1 M_B_x
    s_cmp_lg_u32 s5, 1
    s_cbranch_scc1 wf_5d
    v_lshrrev_b32 v8, 2, v0
    v_min_u32 v8, 8, v8
wf_5:
    buffer_load_dword v9, v8, s[20:23], s40 offen sc1
    s_waitcnt vmcnt(0)
    v_cmp_gt_u32 vcc, 1, v9
    s_cbranch_vccz wf_5d
    s_sleep 2
    s_sub_u32 s94, s94, 1
    s_cbranch_scc0 wf_5
    s_mov_b32 s94, 0
wf_5d:
    s_barrier
M_B_x:
    s_mul_i32 s15, s10, 36864
    buffer_load_dwordx4 v[8:11], v1, s[24:27], s15 offen offset:0 sc1
    buffer_load_dwordx4 v[12:15], v1, s[24:27], s15 offen offset:128 sc1
    buffer_load_dwordx4 v[16:19], v1, s[24:27], s15 offen offset:256 sc1
    buffer_load_dwordx4 v[20:23], v1, s[24:27], s15 offen offset:384 sc1
    buffer_load_dwordx4 v[24:27], v1, s[24:27], s15 offen offset:512 sc1
    buffer_load_dwordx4 v[28:31], v1, s[24:27], s15 offen offset:640 sc1
    buffer_load_dwordx4 v[32:35], v1, s[24:27], s15 offen offset:768 sc1
    buffer_load_dwordx4 v[36:39], v1, s[24:27], s15 offen offset:896 sc1
    buffer_load_dwordx4 v[40:43], v1, s[24:27], s15 offen offset:1024 sc1
    s_lshl_b32 s16, s6, 21
    s_lshl_b32 s17, s10, 12
    s_add_u32 s17, s17, s16
    s_lshl_b32 s18, s5, 10
    s_add_u32 s17, s17, s18
    s_add_u32 s17, s17, 1052672
    v_mov_b32 v44, -1
    v_mov_b32 v45, -1
    v_mov_b32 v46, -1
    v_mov_b32 v47, -1
    buffer_store_dwordx4 v[44:47], v0, s[20:23], s17 offen sc1
    s_waitcnt vmcnt(1)
ln_6:
    s_mov_b32 s36, 0x3f803f80
    s_mov_b32 s37, 0x3ae38e39
    v_mov_b32 v44, 0
    v_mov_b32 v45, 0
    v_dot2_f32_bf16 v44, v8, s36, v44
    v_dot2_f32_bf16 v45, v9, s36, v45
    v_dot2_f32_bf16 v44, v10, s36, v44
    v_dot2_f32_bf16 v45, v11, s36, v45
    v_dot2_f32_bf16 v44, v12, s36, v44
    v_dot2_f32_bf16 v45, v13, s36, v45
    v_dot2_f32_bf16 v44, v14, s36, v44
    v_dot2_f32_bf16 v45, v15, s36, v45
    v_dot2_f32_bf16 v44, v16, s36, v44
    v_dot2_f32_bf16 v45, v17, s36, v45
    v_dot2_f32_bf16 v44, v18, s36, v44
    v_dot2_f32_bf16 v45, v19, s36, v45
    v_dot2_f32_bf16 v44, v20, s36, v44
    v_dot2_f32_bf16 v45, v21, s36, v45
    v_dot2_f32_bf16 v44, v22, s36, v44
    v_dot2_f32_bf16 v45, v23, s36, v45
    v_dot2_f32_bf16 v44, v24, s36, v44
    v_dot2_f32_bf16 v45, v25, s36, v45
    v_dot2_f32_bf16 v44, v26, s36, v44
    v_dot2_f32_bf16 v45, v27, s36, v45
    v_dot2_f32_bf16 v44, v28, s36, v44
    v_dot2_f32_bf16 v45, v29, s36, v45
    v_dot2_f32_bf16 v44, v30, s36, v44
    v_dot2_f32_bf16 v45, v31, s36, v45
    v_dot2_f32_bf16 v44, v32, s36, v44
    v_dot2_f32_bf16 v45, v33, s36, v45
    v_dot2_f32_bf16 v44, v34, s36, v44
    v_dot2_f32_bf16 v45, v35, s36, v45
    v_dot2_f32_bf16 v44, v36, s36, v44
    v_dot2_f32_bf16 v45, v37, s36, v45
    v_dot2_f32_bf16 v44, v38, s36, v44
    v_dot2_f32_bf16 v45, v39, s36, v45
    v_dot2_f32_bf16 v44, v40, s36, v44
    v_dot2_f32_bf16 v45, v41, s36, v45
    v_dot2_f32_bf16 v44, v42, s36, v44
    v_dot2_f32_bf16 v45, v43, s36, v45
    s_nop 2
    v_add_f32 v44, v44, v45
    s_nop 1
    v_add_f32_dpp v44, v44, v44 quad_perm:[1,0,3,2] row_mask:0xf bank_mask:0xf
    s_nop 1
    v_add_f32_dpp v44, v44, v44 quad_perm:[2,3,0,1] row_mask:0xf bank_mask:0xf
    s_nop 1
    v_add_f32_dpp v44, v44, v44 row_half_mirror row_mask:0xf bank_mask:0xf
    v_mul_f32 v44, s37, v44
    v_mov_b32 v46, v44
    v_cvt_pk_bf16_f32 v46, v46, v46
    v_and_b32 v46, 0xffff0000, v46
    v_mov_b32 v47, v46
    v_sub_f32 v44, v44, v46
    v_mov_b32 v48, 0
    v_mov_b32 v49, 0
    v_lshlrev_b32 v50, 16, v8
    v_and_b32 v51, 0xffff0000, v8
    v_pk_add_f32 v[50:51], v[50:51], v[46:47] neg_lo:[0,1] neg_hi:[0,1]
    v_pk_fma_f32 v[48:49], v[50:51], v[50:51], v[48:49]
    v_cvt_pk_bf16_f32 v8, v50, v51
    v_lshlrev_b32 v52, 16, v9
    v_and_b32 v53, 0xffff0000, v9
    v_pk_add_f32 v[52:53], v[52:53], v[46:47] neg_lo:[0,1] neg_hi:[0,1]
    v_pk_fma_f32 v[48:49], v[52:53], v[52:53], v[48:49]
    v_cvt_pk_bf16_f32 v9, v52, v53
    v_lshlrev_b32 v50, 16, v10
    v_and_b32 v51, 0xffff0000, v10
    v_pk_add_f32 v[50:51], v[50:51], v[46:47] neg_lo:[0,1] neg_hi:[0,1]
    v_pk_fma_f32 v[48:49], v[50:51], v[50:51], v[48:49]
    v_cvt_pk_bf16_f32 v10, v50, v51
    v_lshlrev_b32 v52, 16, v11
    v_and_b32 v53, 0xffff0000, v11
    v_pk_add_f32 v[52:53], v[52:53], v[46:47] neg_lo:[0,1] neg_hi:[0,1]
    v_pk_fma_f32 v[48:49], v[52:53], v[52:53], v[48:49]
    v_cvt_pk_bf16_f32 v11, v52, v53
    v_lshlrev_b32 v50, 16, v12
    v_and_b32 v51, 0xffff0000, v12
    v_pk_add_f32 v[50:51], v[50:51], v[46:47] neg_lo:[0,1] neg_hi:[0,1]
    v_pk_fma_f32 v[48:49], v[50:51], v[50:51], v[48:49]
    v_cvt_pk_bf16_f32 v12, v50, v51
    v_lshlrev_b32 v52, 16, v13
    v_and_b32 v53, 0xffff0000, v13
    v_pk_add_f32 v[52:53], v[52:53], v[46:47] neg_lo:[0,1] neg_hi:[0,1]
    v_pk_fma_f32 v[48:49], v[52:53], v[52:53], v[48:49]
    v_cvt_pk_bf16_f32 v13, v52, v53
    v_lshlrev_b32 v50, 16, v14
    v_and_b32 v51, 0xffff0000, v14
    v_pk_add_f32 v[50:51], v[50:51], v[46:47] neg_lo:[0,1] neg_hi:[0,1]
    v_pk_fma_f32 v[48:49], v[50:51], v[50:51], v[48:49]
    v_cvt_pk_bf16_f32 v14, v50, v51
    v_lshlrev_b32 v52, 16, v15
    v_and_b32 v53, 0xffff0000, v15
    v_pk_add_f32 v[52:53], v[52:53], v[46:47] neg_lo:[0,1] neg_hi:[0,1]
    v_pk_fma_f32 v[48:49], v[52:53], v[52:53], v[48:49]
    v_cvt_pk_bf16_f32 v15, v52, v53
    v_lshlrev_b32 v50, 16, v16
    v_and_b32 v51, 0xffff0000, v16
    v_pk_add_f32 v[50:51], v[50:51], v[46:47] neg_lo:[0,1] neg_hi:[0,1]
    v_pk_fma_f32 v[48:49], v[50:51], v[50:51], v[48:49]
    v_cvt_pk_bf16_f32 v16, v50, v51
    v_lshlrev_b32 v52, 16, v17
    v_and_b32 v53, 0xffff0000, v17
    v_pk_add_f32 v[52:53], v[52:53], v[46:47] neg_lo:[0,1] neg_hi:[0,1]
    v_pk_fma_f32 v[48:49], v[52:53], v[52:53], v[48:49]
    v_cvt_pk_bf16_f32 v17, v52, v53
    v_lshlrev_b32 v50, 16, v18
    v_and_b32 v51, 0xffff0000, v18
    v_pk_add_f32 v[50:51], v[50:51], v[46:47] neg_lo:[0,1] neg_hi:[0,1]
    v_pk_fma_f32 v[48:49], v[50:51], v[50:51], v[48:49]
    v_cvt_pk_bf16_f32 v18, v50, v51
    v_lshlrev_b32 v52, 16, v19
    v_and_b32 v53, 0xffff0000, v19
    v_pk_add_f32 v[52:53], v[52:53], v[46:47] neg_lo:[0,1] neg_hi:[0,1]
    v_pk_fma_f32 v[48:49], v[52:53], v[52:53], v[48:49]
    v_cvt_pk_bf16_f32 v19, v52, v53
    v_lshlrev_b32 v50, 16, v20
    v_and_b32 v51, 0xffff0000, v20
    v_pk_add_f32 v[50:51], v[50:51], v[46:47] neg_lo:[0,1] neg_hi:[0,1]
    v_pk_fma_f32 v[48:49], v[50:51], v[50:51], v[48:49]
    v_cvt_pk_bf16_f32 v20, v50, v51
    v_lshlrev_b32 v52, 16, v21
    v_and_b32 v53, 0xffff0000, v21
    v_pk_add_f32 v[52:53], v[52:53], v[46:47] neg_lo:[0,1] neg_hi:[0,1]
    v_pk_fma_f32 v[48:49], v[52:53], v[52:53], v[48:49]
    v_cvt_pk_bf16_f32 v21, v52, v53
    v_lshlrev_b32 v50, 16, v22
    v_and_b32 v51, 0xffff0000, v22
    v_pk_add_f32 v[50:51], v[50:51], v[46:47] neg_lo:[0,1] neg_hi:[0,1]
    v_pk_fma_f32 v[48:49], v[50:51], v[50:51], v[48:49]
    v_cvt_pk_bf16_f32 v22, v50, v51
    v_lshlrev_b32 v52, 16, v23
    v_and_b32 v53, 0xffff0000, v23
    v_pk_add_f32 v[52:53], v[52:53], v[46:47] neg_lo:[0,1] neg_hi:[0,1]
    v_pk_fma_f32 v[48:49], v[52:53], v[52:53], v[48:49]
    v_cvt_pk_bf16_f32 v23, v52, v53
    v_lshlrev_b32 v50, 16, v24
    v_and_b32 v51, 0xffff0000, v24
    v_pk_add_f32 v[50:51], v[50:51], v[46:47] neg_lo:[0,1] neg_hi:[0,1]
    v_pk_fma_f32 v[48:49], v[50:51], v[50:51], v[48:49]
    v_cvt_pk_bf16_f32 v24, v50, v51
    v_lshlrev_b32 v52, 16, v25
    v_and_b32 v53, 0xffff0000, v25
    v_pk_add_f32 v[52:53], v[52:53], v[46:47] neg_lo:[0,1] neg_hi:[0,1]
    v_pk_fma_f32 v[48:49], v[52:53], v[52:53], v[48:49]
    v_cvt_pk_bf16_f32 v25, v52, v53
    v_lshlrev_b32 v50, 16, v26
    v_and_b32 v51, 0xffff0000, v26
    v_pk_add_f32 v[50:51], v[50:51], v[46:47] neg_lo:[0,1] neg_hi:[0,1]
    v_pk_fma_f32 v[48:49], v[50:51], v[50:51], v[48:49]
    v_cvt_pk_bf16_f32 v26, v50, v51
    v_lshlrev_b32 v52, 16, v27
    v_and_b32 v53, 0xffff0000, v27
    v_pk_add_f32 v[52:53], v[52:53], v[46:47] neg_lo:[0,1] neg_hi:[0,1]
    v_pk_fma_f32 v[48:49], v[52:53], v[52:53], v[48:49]
    v_cvt_pk_bf16_f32 v27, v52, v53
    v_lshlrev_b32 v50, 16, v28
    v_and_b32 v51, 0xffff0000, v28
    v_pk_add_f32 v[50:51], v[50:51], v[46:47] neg_lo:[0,1] neg_hi:[0,1]
    v_pk_fma_f32 v[48:49], v[50:51], v[50:51], v[48:49]
    v_cvt_pk_bf16_f32 v28, v50, v51
    v_lshlrev_b32 v52, 16, v29
    v_and_b32 v53, 0xffff0000, v29
    v_pk_add_f32 v[52:53], v[52:53], v[46:47] neg_lo:[0,1] neg_hi:[0,1]
    v_pk_fma_f32 v[48:49], v[52:53], v[52:53], v[48:49]
    v_cvt_pk_bf16_f32 v29, v52, v53
    v_lshlrev_b32 v50, 16, v30
    v_and_b32 v51, 0xffff0000, v30
    v_pk_add_f32 v[50:51], v[50:51], v[46:47] neg_lo:[0,1] neg_hi:[0,1]
    v_pk_fma_f32 v[48:49], v[50:51], v[50:51], v[48:49]
    v_cvt_pk_bf16_f32 v30, v50, v51
    v_lshlrev_b32 v52, 16, v31
    v_and_b32 v53, 0xffff0000, v31
    v_pk_add_f32 v[52:53], v[52:53], v[46:47] neg_lo:[0,1] neg_hi:[0,1]
    v_pk_fma_f32 v[48:49], v[52:53], v[52:53], v[48:49]
    v_cvt_pk_bf16_f32 v31, v52, v53
    v_lshlrev_b32 v50, 16, v32
    v_and_b32 v51, 0xffff0000, v32
    v_pk_add_f32 v[50:51], v[50:51], v[46:47] neg_lo:[0,1] neg_hi:[0,1]
    v_pk_fma_f32 v[48:49], v[50:51], v[50:51], v[48:49]
    v_cvt_pk_bf16_f32 v32, v50, v51
    v_lshlrev_b32 v52, 16, v33
    v_and_b32 v53, 0xffff0000, v33
    v_pk_add_f32 v[52:53], v[52:53], v[46:47] neg_lo:[0,1] neg_hi:[0,1]
    v_pk_fma_f32 v[48:49], v[52:53], v[52:53], v[48:49]
    v_cvt_pk_bf16_f32 v33, v52, v53
    v_lshlrev_b32 v50, 16, v34
    v_and_b32 v51, 0xffff0000, v34
    v_pk_add_f32 v[50:51], v[50:51], v[46:47] neg_lo:[0,1] neg_hi:[0,1]
    v_pk_fma_f32 v[48:49], v[50:51], v[50:51], v[48:49]
    v_cvt_pk_bf16_f32 v34, v50, v51
    v_lshlrev_b32 v52, 16, v35
    v_and_b32 v53, 0xffff0000, v35
    v_pk_add_f32 v[52:53], v[52:53], v[46:47] neg_lo:[0,1] neg_hi:[0,1]
    v_pk_fma_f32 v[48:49], v[52:53], v[52:53], v[48:49]
    v_cvt_pk_bf16_f32 v35, v52, v53
    v_lshlrev_b32 v50, 16, v36
    v_and_b32 v51, 0xffff0000, v36
    v_pk_add_f32 v[50:51], v[50:51], v[46:47] neg_lo:[0,1] neg_hi:[0,1]
    v_pk_fma_f32 v[48:49], v[50:51], v[50:51], v[48:49]
    v_cvt_pk_bf16_f32 v36, v50, v51
    v_lshlrev_b32 v52, 16, v37
    v_and_b32 v53, 0xffff0000, v37
    v_pk_add_f32 v[52:53], v[52:53], v[46:47] neg_lo:[0,1] neg_hi:[0,1]
    v_pk_fma_f32 v[48:49], v[52:53], v[52:53], v[48:49]
    v_cvt_pk_bf16_f32 v37, v52, v53
    v_lshlrev_b32 v50, 16, v38
    v_and_b32 v51, 0xffff0000, v38
    v_pk_add_f32 v[50:51], v[50:51], v[46:47] neg_lo:[0,1] neg_hi:[0,1]
    v_pk_fma_f32 v[48:49], v[50:51], v[50:51], v[48:49]
    v_cvt_pk_bf16_f32 v38, v50, v51
    v_lshlrev_b32 v52, 16, v39
    v_and_b32 v53, 0xffff0000, v39
    v_pk_add_f32 v[52:53], v[52:53], v[46:47] neg_lo:[0,1] neg_hi:[0,1]
    v_pk_fma_f32 v[48:49], v[52:53], v[52:53], v[48:49]
    v_cvt_pk_bf16_f32 v39, v52, v53
    v_lshlrev_b32 v50, 16, v40
    v_and_b32 v51, 0xffff0000, v40
    v_pk_add_f32 v[50:51], v[50:51], v[46:47] neg_lo:[0,1] neg_hi:[0,1]
    v_pk_fma_f32 v[48:49], v[50:51], v[50:51], v[48:49]
    v_cvt_pk_bf16_f32 v40, v50, v51
    v_lshlrev_b32 v52, 16, v41
    v_and_b32 v53, 0xffff0000, v41
    v_pk_add_f32 v[52:53], v[52:53], v[46:47] neg_lo:[0,1] neg_hi:[0,1]
    v_pk_fma_f32 v[48:49], v[52:53], v[52:53], v[48:49]
    v_cvt_pk_bf16_f32 v41, v52, v53
    v_lshlrev_b32 v50, 16, v42
    v_and_b32 v51, 0xffff0000, v42
    v_pk_add_f32 v[50:51], v[50:51], v[46:47] neg_lo:[0,1] neg_hi:[0,1]
    v_pk_fma_f32 v[48:49], v[50:51], v[50:51], v[48:49]
    v_cvt_pk_bf16_f32 v42, v50, v51
    v_lshlrev_b32 v52, 16, v43
    v_and_b32 v53, 0xffff0000, v43
    v_pk_add_f32 v[52:53], v[52:53], v[46:47] neg_lo:[0,1] neg_hi:[0,1]
    v_pk_fma_f32 v[48:49], v[52:53], v[52:53], v[48:49]
    v_cvt_pk_bf16_f32 v43, v52, v53
    v_add_f32 v48, v48, v49
    s_nop 1
    v_add_f32_dpp v48, v48, v48 quad_perm:[1,0,3,2] row_mask:0xf bank_mask:0xf
    s_nop 1
    v_add_f32_dpp v48, v48, v48 quad_perm:[2,3,0,1] row_mask:0xf bank_mask:0xf
    s_nop 1
    v_add_f32_dpp v48, v48, v48 row_half_mirror row_mask:0xf bank_mask:0xf
    v_mul_f32 v48, s37, v48
    v_fma_f32 v48, -v44, v44, v48
    v_max_f32 v48, 0, v48
    v_cvt_pk_bf16_f32 v48, v48, v48
    v_and_b32 v48, 0xffff0000, v48
    v_add_f32 v48, 0x3727c5ac, v48
    v_cvt_pk_bf16_f32 v48, v48, v48
    v_and_b32 v48, 0xffff0000, v48
    v_sqrt_f32 v48, v48
    s_nop 0
    v_cvt_pk_bf16_f32 v48, v48, v48
    v_and_b32 v48, 0xffff0000, v48
    v_rcp_f32 v48, v48
    s_nop 0
    v_mov_b32 v49, v48
    v_lshlrev_b32 v50, 16, v8
    v_and_b32 v51, 0xffff0000, v8
    v_pk_mul_f32 v[50:51], v[50:51], v[48:49]
    v_cvt_pk_bf16_f32 v8, v50, v51
    v_lshlrev_b32 v52, 16, v9
    v_and_b32 v53, 0xffff0000, v9
    v_pk_mul_f32 v[52:53], v[52:53], v[48:49]
    v_cvt_pk_bf16_f32 v9, v52, v53
    v_lshlrev_b32 v50, 16, v10
    v_and_b32 v51, 0xffff0000, v10
    v_pk_mul_f32 v[50:51], v[50:51], v[48:49]
    v_cvt_pk_bf16_f32 v10, v50, v51
    v_lshlrev_b32 v52, 16, v11
    v_and_b32 v53, 0xffff0000, v11
    v_pk_mul_f32 v[52:53], v[52:53], v[48:49]
    v_cvt_pk_bf16_f32 v11, v52, v53
    ds_write_b128 v2, v[8:11] offset:0
    v_lshlrev_b32 v50, 16, v12
    v_and_b32 v51, 0xffff0000, v12
    v_pk_mul_f32 v[50:51], v[50:51], v[48:49]
    v_cvt_pk_bf16_f32 v12, v50, v51
    v_lshlrev_b32 v52, 16, v13
    v_and_b32 v53, 0xffff0000, v13
    v_pk_mul_f32 v[52:53], v[52:53], v[48:49]
    v_cvt_pk_bf16_f32 v13, v52, v53
    v_lshlrev_b32 v50, 16, v14
    v_and_b32 v51, 0xffff0000, v14
    v_pk_mul_f32 v[50:51], v[50:51], v[48:49]
    v_cvt_pk_bf16_f32 v14, v50, v51
    v_lshlrev_b32 v52, 16, v15
    v_and_b32 v53, 0xffff0000, v15
    v_pk_mul_f32 v[52:53], v[52:53], v[48:49]
    v_cvt_pk_bf16_f32 v15, v52, v53
    ds_write_b128 v2, v[12:15] offset:2176
    v_lshlrev_b32 v50, 16, v16
    v_and_b32 v51, 0xffff0000, v16
    v_pk_mul_f32 v[50:51], v[50:51], v[48:49]
    v_cvt_pk_bf16_f32 v16, v50, v51
    v_lshlrev_b32 v52, 16, v17
    v_and_b32 v53, 0xffff0000, v17
    v_pk_mul_f32 v[52:53], v[52:53], v[48:49]
    v_cvt_pk_bf16_f32 v17, v52, v53
    v_lshlrev_b32 v50, 16, v18
    v_and_b32 v51, 0xffff0000, v18
    v_pk_mul_f32 v[50:51], v[50:51], v[48:49]
    v_cvt_pk_bf16_f32 v18, v50, v51
    v_lshlrev_b32 v52, 16, v19
    v_and_b32 v53, 0xffff0000, v19
    v_pk_mul_f32 v[52:53], v[52:53], v[48:49]
    v_cvt_pk_bf16_f32 v19, v52, v53
    ds_write_b128 v2, v[16:19] offset:4352
    v_lshlrev_b32 v50, 16, v20
    v_and_b32 v51, 0xffff0000, v20
    v_pk_mul_f32 v[50:51], v[50:51], v[48:49]
    v_cvt_pk_bf16_f32 v20, v50, v51
    v_lshlrev_b32 v52, 16, v21
    v_and_b32 v53, 0xffff0000, v21
    v_pk_mul_f32 v[52:53], v[52:53], v[48:49]
    v_cvt_pk_bf16_f32 v21, v52, v53
    v_lshlrev_b32 v50, 16, v22
    v_and_b32 v51, 0xffff0000, v22
    v_pk_mul_f32 v[50:51], v[50:51], v[48:49]
    v_cvt_pk_bf16_f32 v22, v50, v51
    v_lshlrev_b32 v52, 16, v23
    v_and_b32 v53, 0xffff0000, v23
    v_pk_mul_f32 v[52:53], v[52:53], v[48:49]
    v_cvt_pk_bf16_f32 v23, v52, v53
    ds_write_b128 v2, v[20:23] offset:6528
    v_lshlrev_b32 v50, 16, v24
    v_and_b32 v51, 0xffff0000, v24
    v_pk_mul_f32 v[50:51], v[50:51], v[48:49]
    v_cvt_pk_bf16_f32 v24, v50, v51
    v_lshlrev_b32 v52, 16, v25
    v_and_b32 v53, 0xffff0000, v25
    v_pk_mul_f32 v[52:53], v[52:53], v[48:49]
    v_cvt_pk_bf16_f32 v25, v52, v53
    v_lshlrev_b32 v50, 16, v26
    v_and_b32 v51, 0xffff0000, v26
    v_pk_mul_f32 v[50:51], v[50:51], v[48:49]
    v_cvt_pk_bf16_f32 v26, v50, v51
    v_lshlrev_b32 v52, 16, v27
    v_and_b32 v53, 0xffff0000, v27
    v_pk_mul_f32 v[52:53], v[52:53], v[48:49]
    v_cvt_pk_bf16_f32 v27, v52, v53
    ds_write_b128 v2, v[24:27] offset:8704
    v_lshlrev_b32 v50, 16, v28
    v_and_b32 v51, 0xffff0000, v28
    v_pk_mul_f32 v[50:51], v[50:51], v[48:49]
    v_cvt_pk_bf16_f32 v28, v50, v51
    v_lshlrev_b32 v52, 16, v29
    v_and_b32 v53, 0xffff0000, v29
    v_pk_mul_f32 v[52:53], v[52:53], v[48:49]
    v_cvt_pk_bf16_f32 v29, v52, v53
    v_lshlrev_b32 v50, 16, v30
    v_and_b32 v51, 0xffff0000, v30
    v_pk_mul_f32 v[50:51], v[50:51], v[48:49]
    v_cvt_pk_bf16_f32 v30, v50, v51
    v_lshlrev_b32 v52, 16, v31
    v_and_b32 v53, 0xffff0000, v31
    v_pk_mul_f32 v[52:53], v[52:53], v[48:49]
    v_cvt_pk_bf16_f32 v31, v52, v53
    ds_write_b128 v2, v[28:31] offset:10880
    v_lshlrev_b32 v50, 16, v32
    v_and_b32 v51, 0xffff0000, v32
    v_pk_mul_f32 v[50:51], v[50:51], v[48:49]
    v_cvt_pk_bf16_f32 v32, v50, v51
    v_lshlrev_b32 v52, 16, v33
    v_and_b32 v53, 0xffff0000, v33
    v_pk_mul_f32 v[52:53], v[52:53], v[48:49]
    v_cvt_pk_bf16_f32 v33, v52, v53
    v_lshlrev_b32 v50, 16, v34
    v_and_b32 v51, 0xffff0000, v34
    v_pk_mul_f32 v[50:51], v[50:51], v[48:49]
    v_cvt_pk_bf16_f32 v34, v50, v51
    v_lshlrev_b32 v52, 16, v35
    v_and_b32 v53, 0xffff0000, v35
    v_pk_mul_f32 v[52:53], v[52:53], v[48:49]
    v_cvt_pk_bf16_f32 v35, v52, v53
    ds_write_b128 v2, v[32:35] offset:13056
    v_lshlrev_b32 v50, 16, v36
    v_and_b32 v51, 0xffff0000, v36
    v_pk_mul_f32 v[50:51], v[50:51], v[48:49]
    v_cvt_pk_bf16_f32 v36, v50, v51
    v_lshlrev_b32 v52, 16, v37
    v_and_b32 v53, 0xffff0000, v37
    v_pk_mul_f32 v[52:53], v[52:53], v[48:49]
    v_cvt_pk_bf16_f32 v37, v52, v53
    v_lshlrev_b32 v50, 16, v38
    v_and_b32 v51, 0xffff0000, v38
    v_pk_mul_f32 v[50:51], v[50:51], v[48:49]
    v_cvt_pk_bf16_f32 v38, v50, v51
    v_lshlrev_b32 v52, 16, v39
    v_and_b32 v53, 0xffff0000, v39
    v_pk_mul_f32 v[52:53], v[52:53], v[48:49]
    v_cvt_pk_bf16_f32 v39, v52, v53
    ds_write_b128 v2, v[36:39] offset:15232
    v_lshlrev_b32 v50, 16, v40
    v_and_b32 v51, 0xffff0000, v40
    v_pk_mul_f32 v[50:51], v[50:51], v[48:49]
    v_cvt_pk_bf16_f32 v40, v50, v51
    v_lshlrev_b32 v52, 16, v41
    v_and_b32 v53, 0xffff0000, v41
    v_pk_mul_f32 v[52:53], v[52:53], v[48:49]
    v_cvt_pk_bf16_f32 v41, v52, v53
    v_lshlrev_b32 v50, 16, v42
    v_and_b32 v51, 0xffff0000, v42
    v_pk_mul_f32 v[50:51], v[50:51], v[48:49]
    v_cvt_pk_bf16_f32 v42, v50, v51
    v_lshlrev_b32 v52, 16, v43
    v_and_b32 v53, 0xffff0000, v43
    v_pk_mul_f32 v[52:53], v[52:53], v[48:49]
    v_cvt_pk_bf16_f32 v43, v52, v53
    ds_write_b128 v2, v[40:43] offset:17408
    s_waitcnt lgkmcnt(0)
    s_barrier
    s_lshl_b32 s17, s10, 14
    s_add_u32 s17, s17, s16
    s_add_u32 s17, s17, 0
    s_add_u32 s18, s18, s17
    s_lshl_b32 s19, s5, 11
    s_add_u32 s19, s19, s17
    s_add_u32 s19, s19, 8192
    s_lshl_b32 s38, s5, 10
    s_add_u32 s38, s38, s12
    v_add_u32 v5, s38, v0
    s_lshl_b32 s38, s5, 11
    s_add_u32 s38, s38, s12
    v_add_u32 v6, s38, v0
    s_add_u32 s39, s18, 4096
    v_lshrrev_b32 v7, 8, v0
    v_lshl_add_u32 v7, v7, 4, v0
    ds_read_b128 v[8:11], v7 offset:0
    ds_read_b128 v[12:15], v7 offset:19584
    ds_read_b128 v[16:19], v7 offset:1088
    ds_read_b128 v[20:23], v7 offset:20672
    ds_read_b128 v[24:27], v7 offset:2176
    ds_read_b128 v[28:31], v7 offset:21760
    s_waitcnt lgkmcnt(4)
    v_mfma_f32_16x16x32_bf16 v[48:51], a[8:11], v[8:11], 0
    v_mfma_f32_16x16x32_bf16 v[52:55], a[8:11], v[12:15], 0
    v_mfma_f32_16x16x32_bf16 v[56:59], a[12:15], v[8:11], 0
    v_mfma_f32_16x16x32_bf16 v[60:63], a[12:15], v[12:15], 0
    v_mfma_f32_16x16x32_bf16 v[64:67], v[8:11], a[16:19], 0
    v_mfma_f32_16x16x32_bf16 v[68:71], v[12:15], a[16:19], 0
    v_mfma_f32_16x16x32_bf16 v[72:75], v[8:11], a[20:23], 0
    v_mfma_f32_16x16x32_bf16 v[76:79], v[12:15], a[20:23], 0
    ds_read_b128 v[8:11], v7 offset:3264
    ds_read_b128 v[12:15], v7 offset:22848
    s_waitcnt lgkmcnt(4)
    v_mfma_f32_16x16x32_bf16 v[48:51], a[32:35], v[16:19], v[48:51]
    v_mfma_f32_16x16x32_bf16 v[52:55], a[32:35], v[20:23], v[52:55]
    v_mfma_f32_16x16x32_bf16 v[56:59], a[36:39], v[16:19], v[56:59]
    v_mfma_f32_16x16x32_bf16 v[60:63], a[36:39], v[20:23], v[60:63]
    v_mfma_f32_16x16x32_bf16 v[64:67], v[16:19], a[40:43], v[64:67]
    v_mfma_f32_16x16x32_bf16 v[68:71], v[20:23], a[40:43], v[68:71]
    v_mfma_f32_16x16x32_bf16 v[72:75], v[16:19], a[44:47], v[72:75]
    v_mfma_f32_16x16x32_bf16 v[76:79], v[20:23], a[44:47], v[76:79]
    ds_read_b128 v[16:19], v7 offset:4352
    ds_read_b128 v[20:23], v7 offset:23936
    s_waitcnt lgkmcnt(4)
    v_mfma_f32_16x16x32_bf16 v[48:51], a[56:59], v[24:27], v[48:51]
    v_mfma_f32_16x16x32_bf16 v[52:55], a[56:59], v[28:31], v[52:55]
    v_mfma_f32_16x16x32_bf16 v[56:59], a[60:63], v[24:27], v[56:59]
    v_mfma_f32_16x16x32_bf16 v[60:63], a[60:63], v[28:31], v[60:63]
    v_mfma_f32_16x16x32_bf16 v[64:67], v[24:27], a[64:67], v[64:67]
    v_mfma_f32_16x16x32_bf16 v[68:71], v[28:31], a[64:67], v[68:71]
    v_mfma_f32_16x16x32_bf16 v[72:75], v[24:27], a[68:71], v[72:75]
    v_mfma_f32_16x16x32_bf16 v[76:79], v[28:31], a[68:71], v[76:79]
    ds_read_b128 v[24:27], v7 offset:5440
    ds_read_b128 v[28:31], v7 offset:25024
    s_waitcnt lgkmcnt(4)
    v_mfma_f32_16x16x32_bf16 v[48:51], a[80:83], v[8:11], v[48:51]
    v_mfma_f32_16x16x32_bf16 v[52:55], a[80:83], v[12:15], v[52:55]
    v_mfma_f32_16x16x32_bf16 v[56:59], a[84:87], v[8:11], v[56:59]
    v_mfma_f32_16x16x32_bf16 v[60:63], a[84:87], v[12:15], v[60:63]
    v_mfma_f32_16x16x32_bf16 v[64:67], v[8:11], a[88:91], v[64:67]
    v_mfma_f32_16x16x32_bf16 v[68:71], v[12:15], a[88:91], v[68:71]
    v_mfma_f32_16x16x32_bf16 v[72:75], v[8:11], a[92:95], v[72:75]
    v_mfma_f32_16x16x32_bf16 v[76:79], v[12:15], a[92:95], v[76:79]
    ds_read_b128 v[8:11], v7 offset:6528
    ds_read_b128 v[12:15], v7 offset:26112
    s_waitcnt lgkmcnt(4)
    v_mfma_f32_16x16x32_bf16 v[48:51], a[104:107], v[16:19], v[48:51]
    v_mfma_f32_16x16x32_bf16 v[52:55], a[104:107], v[20:23], v[52:55]
    v_mfma_f32_16x16x32_bf16 v[56:59], a[108:111], v[16:19], v[56:59]
    v_mfma_f32_16x16x32_bf16 v[60:63], a[108:111], v[20:23], v[60:63]
    v_mfma_f32_16x16x32_bf16 v[64:67], v[16:19], a[112:115], v[64:67]
    v_mfma_f32_16x16x32_bf16 v[68:71], v[20:23], a[112:115], v[68:71]
    v_mfma_f32_16x16x32_bf16 v[72:75], v[16:19], a[116:119], v[72:75]
    v_mfma_f32_16x16x32_bf16 v[76:79], v[20:23], a[116:119], v[76:79]
    ds_read_b128 v[16:19], v7 offset:7616
    ds_read_b128 v[20:23], v7 offset:27200
    s_waitcnt lgkmcnt(4)
    v_mfma_f32_16x16x32_bf16 v[48:51], a[128:131], v[24:27], v[48:51]
    v_mfma_f32_16x16x32_bf16 v[52:55], a[128:131], v[28:31], v[52:55]
    v_mfma_f32_16x16x32_bf16 v[56:59], a[132:135], v[24:27], v[56:59]
    v_mfma_f32_16x16x32_bf16 v[60:63], a[132:135], v[28:31], v[60:63]
    v_mfma_f32_16x16x32_bf16 v[64:67], v[24:27], a[136:139], v[64:67]
    v_mfma_f32_16x16x32_bf16 v[68:71], v[28:31], a[136:139], v[68:71]
    v_mfma_f32_16x16x32_bf16 v[72:75], v[24:27], a[140:143], v[72:75]
    v_mfma_f32_16x16x32_bf16 v[76:79], v[28:31], a[140:143], v[76:79]
    ds_read_b128 v[24:27], v7 offset:8704
    ds_read_b128 v[28:31], v7 offset:28288
    s_waitcnt lgkmcnt(4)
    v_mfma_f32_16x16x32_bf16 v[48:51], a[152:155], v[8:11], v[48:51]
    v_mfma_f32_16x16x32_bf16 v[52:55], a[152:155], v[12:15], v[52:55]
    v_mfma_f32_16x16x32_bf16 v[56:59], a[156:159], v[8:11], v[56:59]
    v_mfma_f32_16x16x32_bf16 v[60:63], a[156:159], v[12:15], v[60:63]
    v_mfma_f32_16x16x32_bf16 v[64:67], v[8:11], a[160:163], v[64:67]
    v_mfma_f32_16x16x32_bf16 v[68:71], v[12:15], a[160:163], v[68:71]
    v_mfma_f32_16x16x32_bf16 v[72:75], v[8:11], a[164:167], v[72:75]
    v_mfma_f32_16x16x32_bf16 v[76:79], v[12:15], a[164:167], v[76:79]
    ds_read_b128 v[8:11], v7 offset:9792
    ds_read_b128 v[12:15], v7 offset:29376
    s_waitcnt lgkmcnt(4)
    v_mfma_f32_16x16x32_bf16 v[48:51], a[176:179], v[16:19], v[48:51]
    v_mfma_f32_16x16x32_bf16 v[52:55], a[176:179], v[20:23], v[52:55]
    v_mfma_f32_16x16x32_bf16 v[56:59], a[180:183], v[16:19], v[56:59]
    v_mfma_f32_16x16x32_bf16 v[60:63], a[180:183], v[20:23], v[60:63]
    v_mfma_f32_16x16x32_bf16 v[64:67], v[16:19], a[184:187], v[64:67]
    v_mfma_f32_16x16x32_bf16 v[68:71], v[20:23], a[184:187], v[68:71]
    v_mfma_f32_16x16x32_bf16 v[72:75], v[16:19], a[188:191], v[72:75]
    v_mfma_f32_16x16x32_bf16 v[76:79], v[20:23], a[188:191], v[76:79]
    ds_read_b128 v[16:19], v7 offset:10880
    ds_read_b128 v[20:23], v7 offset:30464
    s_waitcnt lgkmcnt(4)
    v_mfma_f32_16x16x32_bf16 v[48:51], a[200:203], v[24:27], v[48:51]
    v_mfma_f32_16x16x32_bf16 v[52:55], a[200:203], v[28:31], v[52:55]
    v_mfma_f32_16x16x32_bf16 v[56:59], a[204:207], v[24:27], v[56:59]
    v_mfma_f32_16x16x32_bf16 v[60:63], a[204:207], v[28:31], v[60:63]
    v_mfma_f32_16x16x32_bf16 v[64:67], v[24:27], a[208:211], v[64:67]
    v_mfma_f32_16x16x32_bf16 v[68:71], v[28:31], a[208:211], v[68:71]
    v_mfma_f32_16x16x32_bf16 v[72:75], v[24:27], a[212:215], v[72:75]
    v_mfma_f32_16x16x32_bf16 v[76:79], v[28:31], a[212:215], v[76:79]
    ds_read_b128 v[24:27], v7 offset:11968
    ds_read_b128 v[28:31], v7 offset:31552
    s_waitcnt lgkmcnt(4)
    v_mfma_f32_16x16x32_bf16 v[48:51], a[224:227], v[8:11], v[48:51]
    v_mfma_f32_16x16x32_bf16 v[52:55], a[224:227], v[12:15], v[52:55]
    v_mfma_f32_16x16x32_bf16 v[56:59], a[228:231], v[8:11], v[56:59]
    v_mfma_f32_16x16x32_bf16 v[60:63], a[228:231], v[12:15], v[60:63]
    v_mfma_f32_16x16x32_bf16 v[64:67], v[8:11], a[232:235], v[64:67]
    v_mfma_f32_16x16x32_bf16 v[68:71], v[12:15], a[232:235], v[68:71]
    v_mfma_f32_16x16x32_bf16 v[72:75], v[8:11], a[236:239], v[72:75]
    v_mfma_f32_16x16x32_bf16 v[76:79], v[12:15], a[236:239], v[76:79]
    ds_read_b128 v[8:11], v7 offset:13056
    ds_read_b128 v[12:15], v7 offset:32640
    s_waitcnt lgkmcnt(4)
    v_mfma_f32_16x16x32_bf16 v[48:51], a[248:251], v[16:19], v[48:51]
    v_mfma_f32_16x16x32_bf16 v[52:55], a[248:251], v[20:23], v[52:55]
    v_mfma_f32_16x16x32_bf16 v[56:59], a[252:255], v[16:19], v[56:59]
    v_mfma_f32_16x16x32_bf16 v[60:63], a[252:255], v[20:23], v[60:63]
    v_mfma_f32_16x16x32_bf16 v[64:67], v[16:19], v[80:83], v[64:67]
    v_mfma_f32_16x16x32_bf16 v[68:71], v[20:23], v[80:83], v[68:71]
    v_mfma_f32_16x16x32_bf16 v[72:75], v[16:19], v[84:87], v[72:75]
    v_mfma_f32_16x16x32_bf16 v[76:79], v[20:23], v[84:87], v[76:79]
    ds_read_b128 v[16:19], v7 offset:14144
    ds_read_b128 v[20:23], v7 offset:33728
    s_waitcnt lgkmcnt(4)
    v_mfma_f32_16x16x32_bf16 v[48:51], v[96:99], v[24:27], v[48:51]
    v_mfma_f32_16x16x32_bf16 v[52:55], v[96:99], v[28:31], v[52:55]
    v_mfma_f32_16x16x32_bf16 v[56:59], v[100:103], v[24:27], v[56:59]
    v_mfma_f32_16x16x32_bf16 v[60:63], v[100:103], v[28:31], v[60:63]
    v_mfma_f32_16x16x32_bf16 v[64:67], v[24:27], v[104:107], v[64:67]
    v_mfma_f32_16x16x32_bf16 v[68:71], v[28:31], v[104:107], v[68:71]
    v_mfma_f32_16x16x32_bf16 v[72:75], v[24:27], v[108:111], v[72:75]
    v_mfma_f32_16x16x32_bf16 v[76:79], v[28:31], v[108:111], v[76:79]
    ds_read_b128 v[24:27], v7 offset:15232
    ds_read_b128 v[28:31], v7 offset:34816
    s_waitcnt lgkmcnt(4)
    v_mfma_f32_16x16x32_bf16 v[48:51], v[120:123], v[8:11], v[48:51]
    v_mfma_f32_16x16x32_bf16 v[52:55], v[120:123], v[12:15], v[52:55]
    v_mfma_f32_16x16x32_bf16 v[56:59], v[124:127], v[8:11], v[56:59]
    v_mfma_f32_16x16x32_bf16 v[60:63], v[124:127], v[12:15], v[60:63]
    v_mfma_f32_16x16x32_bf16 v[64:67], v[8:11], v[128:131], v[64:67]
    v_mfma_f32_16x16x32_bf16 v[68:71], v[12:15], v[128:131], v[68:71]
    v_mfma_f32_16x16x32_bf16 v[72:75], v[8:11], v[132:135], v[72:75]
    v_mfma_f32_16x16x32_bf16 v[76:79], v[12:15], v[132:135], v[76:79]
    ds_read_b128 v[8:11], v7 offset:16320
    ds_read_b128 v[12:15], v7 offset:35904
    s_waitcnt lgkmcnt(4)
    v_mfma_f32_16x16x32_bf16 v[48:51], v[144:147], v[16:19], v[48:51]
    v_mfma_f32_16x16x32_bf16 v[52:55], v[144:147], v[20:23], v[52:55]
    v_mfma_f32_16x16x32_bf16 v[56:59], v[148:151], v[16:19], v[56:59]
    v_mfma_f32_16x16x32_bf16 v[60:63], v[148:151], v[20:23], v[60:63]
    v_mfma_f32_16x16x32_bf16 v[64:67], v[16:19], v[152:155], v[64:67]
    v_mfma_f32_16x16x32_bf16 v[68:71], v[20:23], v[152:155], v[68:71]
    v_mfma_f32_16x16x32_bf16 v[72:75], v[16:19], v[156:159], v[72:75]
    v_mfma_f32_16x16x32_bf16 v[76:79], v[20:23], v[156:159], v[76:79]
    ds_read_b128 v[16:19], v7 offset:17408
    ds_read_b128 v[20:23], v7 offset:36992
    s_waitcnt lgkmcnt(4)
    v_mfma_f32_16x16x32_bf16 v[48:51], v[168:171], v[24:27], v[48:51]
    v_mfma_f32_16x16x32_bf16 v[52:55], v[168:171], v[28:31], v[52:55]
    v_mfma_f32_16x16x32_bf16 v[56:59], v[172:175], v[24:27], v[56:59]
    v_mfma_f32_16x16x32_bf16 v[60:63], v[172:175], v[28:31], v[60:63]
    v_mfma_f32_16x16x32_bf16 v[64:67], v[24:27], v[176:179], v[64:67]
    v_mfma_f32_16x16x32_bf16 v[68:71], v[28:31], v[176:179], v[68:71]
    v_mfma_f32_16x16x32_bf16 v[72:75], v[24:27], v[180:183], v[72:75]
    v_mfma_f32_16x16x32_bf16 v[76:79], v[28:31], v[180:183], v[76:79]
    ds_read_b128 v[24:27], v7 offset:18496
    ds_read_b128 v[28:31], v7 offset:38080
    s_waitcnt lgkmcnt(4)
    v_mfma_f32_16x16x32_bf16 v[48:51], v[192:195], v[8:11], v[48:51]
    v_mfma_f32_16x16x32_bf16 v[52:55], v[192:195], v[12:15], v[52:55]
    v_mfma_f32_16x16x32_bf16 v[56:59], v[196:199], v[8:11], v[56:59]
    v_mfma_f32_16x16x32_bf16 v[60:63], v[196:199], v[12:15], v[60:63]
    v_mfma_f32_16x16x32_bf16 v[64:67], v[8:11], v[200:203], v[64:67]
    v_mfma_f32_16x16x32_bf16 v[68:71], v[12:15], v[200:203], v[68:71]
    v_mfma_f32_16x16x32_bf16 v[72:75], v[8:11], v[204:207], v[72:75]
    v_mfma_f32_16x16x32_bf16 v[76:79], v[12:15], v[204:207], v[76:79]
    s_waitcnt lgkmcnt(2)
    v_mfma_f32_16x16x32_bf16 v[48:51], v[216:219], v[16:19], v[48:51]
    v_mfma_f32_16x16x32_bf16 v[52:55], v[216:219], v[20:23], v[52:55]
    v_mfma_f32_16x16x32_bf16 v[56:59], v[220:223], v[16:19], v[56:59]
    v_mfma_f32_16x16x32_bf16 v[60:63], v[220:223], v[20:23], v[60:63]
    v_mfma_f32_16x16x32_bf16 v[64:67], v[16:19], v[224:227], v[64:67]
    v_mfma_f32_16x16x32_bf16 v[68:71], v[20:23], v[224:227], v[68:71]
    v_mfma_f32_16x16x32_bf16 v[72:75], v[16:19], v[228:231], v[72:75]
    v_mfma_f32_16x16x32_bf16 v[76:79], v[20:23], v[228:231], v[76:79]
    s_waitcnt lgkmcnt(0)
    v_mfma_f32_16x16x32_bf16 v[48:51], v[240:243], v[24:27], v[48:51]
    v_mfma_f32_16x16x32_bf16 v[52:55], v[240:243], v[28:31], v[52:55]
    v_mfma_f32_16x16x32_bf16 v[56:59], v[244:247], v[24:27], v[56:59]
    v_mfma_f32_16x16x32_bf16 v[60:63], v[244:247], v[28:31], v[60:63]
    v_mfma_f32_16x16x32_bf16 v[64:67], v[24:27], v[248:251], v[64:67]
    v_mfma_f32_16x16x32_bf16 v[68:71], v[28:31], v[248:251], v[68:71]
    v_mfma_f32_16x16x32_bf16 v[72:75], v[24:27], v[252:255], v[72:75]
    v_mfma_f32_16x16x32_bf16 v[76:79], v[28:31], v[252:255], v[76:79]
    v_cvt_pk_bf16_f32 v32, v48, v49
    v_cvt_pk_bf16_f32 v33, v56, v57
    v_cvt_pk_bf16_f32 v34, v50, v51
    v_cvt_pk_bf16_f32 v35, v58, v59
    buffer_store_dwordx4 v[32:35], v0, s[20:23], s18 offen sc1
    ds_write_b128 v5, v[32:35] offset:8192
    v_cvt_pk_bf16_f32 v36, v52, v53
    v_cvt_pk_bf16_f32 v37, v60, v61
    v_cvt_pk_bf16_f32 v38, v54, v55
    v_cvt_pk_bf16_f32 v39, v62, v63
    buffer_store_dwordx4 v[36:39], v0, s[20:23], s39 offen sc1
    ds_write_b128 v5, v[36:39] offset:12288
    v_cvt_pk_bf16_f32 v40, v64, v65
    v_cvt_pk_bf16_f32 v41, v66, v67
    v_cvt_pk_bf16_f32 v42, v68, v69
    v_cvt_pk_bf16_f32 v43, v70, v71
    buffer_store_dwordx4 v[40:43], v0, s[20:23], s19 offen offset:0 sc1
    ds_write_b128 v6, v[40:43] offset:16384
    v_cvt_pk_bf16_f32 v44, v72, v73
    v_cvt_pk_bf16_f32 v45, v74, v75
    v_cvt_pk_bf16_f32 v46, v76, v77
    v_cvt_pk_bf16_f32 v47, v78, v79
    buffer_store_dwordx4 v[44:47], v0, s[20:23], s19 offen offset:1024 sc1
    ds_write_b128 v6, v[44:47] offset:17408
    s_waitcnt lgkmcnt(0)
    ds_read_b128 v[8:11], v7 offset:0
    ds_read_b128 v[12:15], v7 offset:19584
    ds_read_b128 v[16:19], v7 offset:1088
    ds_read_b128 v[20:23], v7 offset:20672
    ds_read_b128 v[24:27], v7 offset:2176
    ds_read_b128 v[28:31], v7 offset:21760
    s_waitcnt lgkmcnt(4)
    v_mfma_f32_16x16x32_bf16 v[32:35], a[0:3], v[8:11], 0
    v_mfma_f32_16x16x32_bf16 v[36:39], a[0:3], v[12:15], 0
    v_mfma_f32_16x16x32_bf16 v[40:43], a[4:7], v[8:11], 0
    v_mfma_f32_16x16x32_bf16 v[44:47], a[4:7], v[12:15], 0
    ds_read_b128 v[8:11], v7 offset:3264
    ds_read_b128 v[12:15], v7 offset:22848
    s_waitcnt lgkmcnt(4)
    v_mfma_f32_16x16x32_bf16 v[32:35], a[24:27], v[16:19], v[32:35]
    v_mfma_f32_16x16x32_bf16 v[36:39], a[24:27], v[20:23], v[36:39]
    v_mfma_f32_16x16x32_bf16 v[40:43], a[28:31], v[16:19], v[40:43]
    v_mfma_f32_16x16x32_bf16 v[44:47], a[28:31], v[20:23], v[44:47]
    ds_read_b128 v[16:19], v7 offset:4352
    ds_read_b128 v[20:23], v7 offset:23936
    s_waitcnt lgkmcnt(4)
    v_mfma_f32_16x16x32_bf16 v[32:35], a[48:51], v[24:27], v[32:35]
    v_mfma_f32_16x16x32_bf16 v[36:39], a[48:51], v[28:31], v[36:39]
    v_mfma_f32_16x16x32_bf16 v[40:43], a[52:55], v[24:27], v[40:43]
    v_mfma_f32_16x16x32_bf16 v[44:47], a[52:55], v[28:31], v[44:47]
    ds_read_b128 v[24:27], v7 offset:5440
    ds_read_b128 v[28:31], v7 offset:25024
    s_waitcnt lgkmcnt(4)
    v_mfma_f32_16x16x32_bf16 v[32:35], a[72:75], v[8:11], v[32:35]
    v_mfma_f32_16x16x32_bf16 v[36:39], a[72:75], v[12:15], v[36:39]
    v_mfma_f32_16x16x32_bf16 v[40:43], a[76:79], v[8:11], v[40:43]
    v_mfma_f32_16x16x32_bf16 v[44:47], a[76:79], v[12:15], v[44:47]
    ds_read_b128 v[8:11], v7 offset:6528
    ds_read_b128 v[12:15], v7 offset:26112
    s_waitcnt lgkmcnt(4)
    v_mfma_f32_16x16x32_bf16 v[32:35], a[96:99], v[16:19], v[32:35]
    v_mfma_f32_16x16x32_bf16 v[36:39], a[96:99], v[20:23], v[36:39]
    v_mfma_f32_16x16x32_bf16 v[40:43], a[100:103], v[16:19], v[40:43]
    v_mfma_f32_16x16x32_bf16 v[44:47], a[100:103], v[20:23], v[44:47]
    ds_read_b128 v[16:19], v7 offset:7616
    ds_read_b128 v[20:23], v7 offset:27200
    s_waitcnt lgkmcnt(4)
    v_mfma_f32_16x16x32_bf16 v[32:35], a[120:123], v[24:27], v[32:35]
    v_mfma_f32_16x16x32_bf16 v[36:39], a[120:123], v[28:31], v[36:39]
    v_mfma_f32_16x16x32_bf16 v[40:43], a[124:127], v[24:27], v[40:43]
    v_mfma_f32_16x16x32_bf16 v[44:47], a[124:127], v[28:31], v[44:47]
    ds_read_b128 v[24:27], v7 offset:8704
    ds_read_b128 v[28:31], v7 offset:28288
    s_waitcnt lgkmcnt(4)
    v_mfma_f32_16x16x32_bf16 v[32:35], a[144:147], v[8:11], v[32:35]
    v_mfma_f32_16x16x32_bf16 v[36:39], a[144:147], v[12:15], v[36:39]
    v_mfma_f32_16x16x32_bf16 v[40:43], a[148:151], v[8:11], v[40:43]
    v_mfma_f32_16x16x32_bf16 v[44:47], a[148:151], v[12:15], v[44:47]
    ds_read_b128 v[8:11], v7 offset:9792
    ds_read_b128 v[12:15], v7 offset:29376
    s_waitcnt lgkmcnt(4)
    v_mfma_f32_16x16x32_bf16 v[32:35], a[168:171], v[16:19], v[32:35]
    v_mfma_f32_16x16x32_bf16 v[36:39], a[168:171], v[20:23], v[36:39]
    v_mfma_f32_16x16x32_bf16 v[40:43], a[172:175], v[16:19], v[40:43]
    v_mfma_f32_16x16x32_bf16 v[44:47], a[172:175], v[20:23], v[44:47]
    ds_read_b128 v[16:19], v7 offset:10880
    ds_read_b128 v[20:23], v7 offset:30464
    s_waitcnt lgkmcnt(4)
    v_mfma_f32_16x16x32_bf16 v[32:35], a[192:195], v[24:27], v[32:35]
    v_mfma_f32_16x16x32_bf16 v[36:39], a[192:195], v[28:31], v[36:39]
    v_mfma_f32_16x16x32_bf16 v[40:43], a[196:199], v[24:27], v[40:43]
    v_mfma_f32_16x16x32_bf16 v[44:47], a[196:199], v[28:31], v[44:47]
    ds_read_b128 v[24:27], v7 offset:11968
    ds_read_b128 v[28:31], v7 offset:31552
    s_waitcnt lgkmcnt(4)
    v_mfma_f32_16x16x32_bf16 v[32:35], a[216:219], v[8:11], v[32:35]
    v_mfma_f32_16x16x32_bf16 v[36:39], a[216:219], v[12:15], v[36:39]
    v_mfma_f32_16x16x32_bf16 v[40:43], a[220:223], v[8:11], v[40:43]
    v_mfma_f32_16x16x32_bf16 v[44:47], a[220:223], v[12:15], v[44:47]
    ds_read_b128 v[8:11], v7 offset:13056
    ds_read_b128 v[12:15], v7 offset:32640
    s_waitcnt lgkmcnt(4)
    v_mfma_f32_16x16x32_bf16 v[32:35], a[240:243], v[16:19], v[32:35]
    v_mfma_f32_16x16x32_bf16 v[36:39], a[240:243], v[20:23], v[36:39]
    v_mfma_f32_16x16x32_bf16 v[40:43], a[244:247], v[16:19], v[40:43]
    v_mfma_f32_16x16x32_bf16 v[44:47], a[244:247], v[20:23], v[44:47]
    ds_read_b128 v[16:19], v7 offset:14144
    ds_read_b128 v[20:23], v7 offset:33728
    s_waitcnt lgkmcnt(4)
    v_mfma_f32_16x16x32_bf16 v[32:35], v[88:91], v[24:27], v[32:35]
    v_mfma_f32_16x16x32_bf16 v[36:39], v[88:91], v[28:31], v[36:39]
    v_mfma_f32_16x16x32_bf16 v[40:43], v[92:95], v[24:27], v[40:43]
    v_mfma_f32_16x16x32_bf16 v[44:47], v[92:95], v[28:31], v[44:47]
    ds_read_b128 v[24:27], v7 offset:15232
    ds_read_b128 v[28:31], v7 offset:34816
    s_waitcnt lgkmcnt(4)
    v_mfma_f32_16x16x32_bf16 v[32:35], v[112:115], v[8:11], v[32:35]
    v_mfma_f32_16x16x32_bf16 v[36:39], v[112:115], v[12:15], v[36:39]
    v_mfma_f32_16x16x32_bf16 v[40:43], v[116:119], v[8:11], v[40:43]
    v_mfma_f32_16x16x32_bf16 v[44:47], v[116:119], v[12:15], v[44:47]
    ds_read_b128 v[8:11], v7 offset:16320
    ds_read_b128 v[12:15], v7 offset:35904
    s_waitcnt lgkmcnt(4)
    v_mfma_f32_16x16x32_bf16 v[32:35], v[136:139], v[16:19], v[32:35]
    v_mfma_f32_16x16x32_bf16 v[36:39], v[136:139], v[20:23], v[36:39]
    v_mfma_f32_16x16x32_bf16 v[40:43], v[140:143], v[16:19], v[40:43]
    v_mfma_f32_16x16x32_bf16 v[44:47], v[140:143], v[20:23], v[44:47]
    ds_read_b128 v[16:19], v7 offset:17408
    ds_read_b128 v[20:23], v7 offset:36992
    s_waitcnt lgkmcnt(4)
    v_mfma_f32_16x16x32_bf16 v[32:35], v[160:163], v[24:27], v[32:35]
    v_mfma_f32_16x16x32_bf16 v[36:39], v[160:163], v[28:31], v[36:39]
    v_mfma_f32_16x16x32_bf16 v[40:43], v[164:167], v[24:27], v[40:43]
    v_mfma_f32_16x16x32_bf16 v[44:47], v[164:167], v[28:31], v[44:47]
    ds_read_b128 v[24:27], v7 offset:18496
    ds_read_b128 v[28:31], v7 offset:38080
    s_waitcnt lgkmcnt(4)
    v_mfma_f32_16x16x32_bf16 v[32:35], v[184:187], v[8:11], v[32:35]
    v_mfma_f32_16x16x32_bf16 v[36:39], v[184:187], v[12:15], v[36:39]
    v_mfma_f32_16x16x32_bf16 v[40:43], v[188:191], v[8:11], v[40:43]
    v_mfma_f32_16x16x32_bf16 v[44:47], v[188:191], v[12:15], v[44:47]
    s_waitcnt lgkmcnt(2)
    v_mfma_f32_16x16x32_bf16 v[32:35], v[208:211], v[16:19], v[32:35]
    v_mfma_f32_16x16x32_bf16 v[36:39], v[208:211], v[20:23], v[36:39]
    v_mfma_f32_16x16x32_bf16 v[40:43], v[212:215], v[16:19], v[40:43]
    v_mfma_f32_16x16x32_bf16 v[44:47], v[212:215], v[20:23], v[44:47]
    s_waitcnt lgkmcnt(0)
    v_mfma_f32_16x16x32_bf16 v[32:35], v[232:235], v[24:27], v[32:35]
    v_mfma_f32_16x16x32_bf16 v[36:39], v[232:235], v[28:31], v[36:39]
    v_mfma_f32_16x16x32_bf16 v[40:43], v[236:239], v[24:27], v[40:43]
    v_mfma_f32_16x16x32_bf16 v[44:47], v[236:239], v[28:31], v[44:47]
    s_waitcnt vmcnt(0)
    s_barrier
    s_cmp_lg_u32 s5, 0
    s_cbranch_scc1 M_B_q
    s_lshl_b32 s17, s6, 6
    s_add_u32 s17, s17, s10
    s_lshl_b32 s17, s17, 7
    s_add_u32 s17, s17, 93323264
    v_mov_b32 v8, 1
    s_mov_b64 exec, 1
    buffer_store_dword v8, off, s[20:23], s17 sc1
    s_mov_b64 exec, -1
M_B_q:
    s_nop 3
    v_cvt_pk_bf16_f32 v8, v32, v33
    v_cvt_pk_bf16_f32 v9, v40, v41
    v_cvt_pk_bf16_f32 v10, v34, v35
    v_cvt_pk_bf16_f32 v11, v42, v43
    ds_write_b128 v5, v[8:11] offset:0
    v_cvt_pk_bf16_f32 v12, v36, v37
    v_cvt_pk_bf16_f32 v13, v44, v45
    v_cvt_pk_bf16_f32 v14, v38, v39
    v_cvt_pk_bf16_f32 v15, v46, v47
    ds_write_b128 v5, v[12:15] offset:4096
    s_waitcnt lgkmcnt(0)
    s_barrier
M_B_attn:
    s_cmp_lt_i32 s11, 0
    s_cbranch_scc1 M_B_next
    s_lshl_b32 s16, s11, 5
    s_add_u32 s16, s16, s6
    s_lshl_b32 s17, s6, 21
    s_lshl_b32 s18, s11, 12
    s_add_u32 s17, s17, s18
    s_add_u32 s17, s17, 1052672
    s_lshl_b32 s18, s5, 10
    s_add_u32 s18, s18, s17
    v_add_u32 v6, s13, v0
    s_lshl_b32 s38, s5, 11
    v_add_u32 v7, s38, v6
    v_mov_b32 v76, 0xff800000
    ds_read_b128 v[28:31], v6 offset:0
    ds_read_b128 v[32:35], v6 offset:1024
    ds_read_b128 v[36:39], v6 offset:2048
    ds_read_b128 v[40:43], v6 offset:3072
    ds_read_b128 v[8:11], v6 offset:8192
    ds_read_b128 v[12:15], v6 offset:9216
    ds_read_b128 v[16:19], v6 offset:10240
    ds_read_b128 v[20:23], v6 offset:11264
    s_waitcnt lgkmcnt(0)
    v_mfma_f32_16x16x32_bf16 v[44:47], v[8:11], v[28:31], 0
    v_mfma_f32_16x16x32_bf16 v[44:47], v[12:15], v[32:35], v[44:47]
    v_mfma_f32_16x16x32_bf16 v[44:47], v[16:19], v[36:39], v[44:47]
    v_mfma_f32_16x16x32_bf16 v[44:47], v[20:23], v[40:43], v[44:47]
    s_nop 3
    ds_read_b128 v[8:11], v6 offset:12288
    ds_read_b128 v[12:15], v6 offset:13312
    ds_read_b128 v[16:19], v6 offset:14336
    ds_read_b128 v[20:23], v6 offset:15360
    s_waitcnt lgkmcnt(0)
    v_mfma_f32_16x16x32_bf16 v[48:51], v[8:11], v[28:31], 0
    v_mfma_f32_16x16x32_bf16 v[48:51], v[12:15], v[32:35], v[48:51]
    v_mfma_f32_16x16x32_bf16 v[48:51], v[16:19], v[36:39], v[48:51]
    v_mfma_f32_16x16x32_bf16 v[48:51], v[20:23], v[40:43], v[48:51]
    s_nop 3
    ds_read_b128 v[28:31], v6 offset:4096
    ds_read_b128 v[32:35], v6 offset:5120
    ds_read_b128 v[36:39], v6 offset:6144
    ds_read_b128 v[40:43], v6 offset:7168
    ds_read_b128 v[8:11], v6 offset:8192
    ds_read_b128 v[12:15], v6 offset:9216
    ds_read_b128 v[16:19], v6 offset:10240
    ds_read_b128 v[20:23], v6 offset:11264
    s_waitcnt lgkmcnt(0)
    v_mfma_f32_16x16x32_bf16 v[52:55], v[8:11], v[28:31], 0
    v_mfma_f32_16x16x32_bf16 v[52:55], v[12:15], v[32:35], v[52:55]
    v_mfma_f32_16x16x32_bf16 v[52:55], v[16:19], v[36:39], v[52:55]
    v_mfma_f32_16x16x32_bf16 v[52:55], v[20:23], v[40:43], v[52:55]
    s_nop 3
    ds_read_b128 v[8:11], v6 offset:12288
    ds_read_b128 v[12:15], v6 offset:13312
    ds_read_b128 v[16:19], v6 offset:14336
    ds_read_b128 v[20:23], v6 offset:15360
    s_waitcnt lgkmcnt(0)
    v_mfma_f32_16x16x32_bf16 v[56:59], v[8:11], v[28:31], 0
    v_mfma_f32_16x16x32_bf16 v[56:59], v[12:15], v[32:35], v[56:59]
    v_mfma_f32_16x16x32_bf16 v[56:59], v[16:19], v[36:39], v[56:59]
    v_mfma_f32_16x16x32_bf16 v[56:59], v[20:23], v[40:43], v[56:59]
    s_nop 3
    ds_read_b128 v[20:23], v7 offset:16384
    ds_read_b128 v[24:27], v7 offset:17408
    v_mov_b32 v68, 0x3f803f80
    v_mov_b32 v69, 0x3f803f80
    v_mov_b32 v70, 0x3f803f80
    v_mov_b32 v71, 0x3f803f80
    v_mov_b32 v60, 0
    v_mov_b32 v61, 0
    v_mov_b32 v62, 0
    v_mov_b32 v63, 0
    v_mov_b32 v64, 0
    v_mov_b32 v65, 0
    v_mov_b32 v66, 0
    v_mov_b32 v67, 0
    v_cmp_le_i32 vcc, 0, v3
    s_nop 1
    v_cndmask_b32 v44, v76, v44, vcc
    v_cmp_le_i32 vcc, 1, v3
    s_nop 1
    v_cndmask_b32 v45, v76, v45, vcc
    v_cmp_le_i32 vcc, 2, v3
    s_nop 1
    v_cndmask_b32 v46, v76, v46, vcc
    v_cmp_le_i32 vcc, 3, v3
    s_nop 1
    v_cndmask_b32 v47, v76, v47, vcc
    v_cmp_le_i32 vcc, 4, v3
    s_nop 1
    v_cndmask_b32 v48, v76, v48, vcc
    v_cmp_le_i32 vcc, 5, v3
    s_nop 1
    v_cndmask_b32 v49, v76, v49, vcc
    v_cmp_le_i32 vcc, 6, v3
    s_nop 1
    v_cndmask_b32 v50, v76, v50, vcc
    v_cmp_le_i32 vcc, 7, v3
    s_nop 1
    v_cndmask_b32 v51, v76, v51, vcc
    v_cmp_le_i32 vcc, -4, v3
    s_nop 1
    v_cndmask_b32 v52, v76, v52, vcc
    v_cmp_le_i32 vcc, -3, v3
    s_nop 1
    v_cndmask_b32 v53, v76, v53, vcc
    v_cmp_le_i32 vcc, -2, v3
    s_nop 1
    v_cndmask_b32 v54, v76, v54, vcc
    v_cmp_le_i32 vcc, -1, v3
    s_nop 1
    v_cndmask_b32 v55, v76, v55, vcc
    v_cmp_le_i32 vcc, 0, v3
    s_nop 1
    v_cndmask_b32 v56, v76, v56, vcc
    v_cmp_le_i32 vcc, 1, v3
    s_nop 1
    v_cndmask_b32 v57, v76, v57, vcc
    v_cmp_le_i32 vcc, 2, v3
    s_nop 1
    v_cndmask_b32 v58, v76, v58, vcc
    v_cmp_le_i32 vcc, 3, v3
    s_nop 1
    v_cndmask_b32 v59, v76, v59, vcc
    s_lshl_b32 s38, s5, 9
    v_lshrrev_b32 v5, 1, v0
    v_add_u32 v5, s38, v5
    v_and_b32 v7, 0x200, v0
    v_bfe_u32 v79, v0, 8, 1
    v_lshl_add_u32 v7, v79, 6, v7
    v_bfe_u32 v79, v0, 6, 2
    v_lshl_add_u32 v7, v79, 3, v7
    v_bfe_u32 v79, v0, 4, 2
    v_lshl_add_u32 v7, v79, 7, v7
    v_mov_b32 v19, 0
    s_lshl_b32 s17, s16, 13
    s_lshl_b32 s19, s5, 11
    s_add_u32 s17, s17, s19
    s_add_u32 s17, s17, 67108864
M_B_poll:
    buffer_load_dwordx4 v[8:11], v0, s[20:23], s18 offen sc1
    s_waitcnt vmcnt(0)
    v_max3_u32 v78, v8, v9, v10
    v_max_u32 v78, v78, v11
    v_cmp_eq_u32 vcc, -1, v78
    s_cbranch_vccz M_B_go
    s_sleep 2
    s_sub_u32 s94, s94, 1
    s_cbranch_scc0 M_B_poll
    s_mov_b32 s94, 0
M_B_go:
    ds_write_b64 v5, v[8:9] offset:40960
    v_mov_b64 v[16:17], v[10:11]
    v_mov_b32 v18, v11
    s_waitcnt lgkmcnt(0)
    s_barrier
    ds_read_b64_tr_b16 v[8:9], v7 offset:40960
    ds_read_b64_tr_b16 v[10:11], v7 offset:40992
    ds_read_b64_tr_b16 v[12:13], v7 offset:41984
    ds_read_b64_tr_b16 v[14:15], v7 offset:42016
    s_waitcnt lgkmcnt(0)
    v_smfmac_f32_16x16x64_bf16 v[64:67], v[8:11], v[28:35], v4
    v_smfmac_f32_16x16x64_bf16 v[64:67], v[12:15], v[36:43], v4
    s_nop 1
    ds_read_b128 v[28:31], v6 offset:0
    ds_read_b128 v[32:35], v6 offset:1024
    ds_read_b128 v[36:39], v6 offset:2048
    ds_read_b128 v[40:43], v6 offset:3072
    v_max3_f32 v78, v52, v53, v54
    s_nop 0
    v_pk_add_f32 v[64:65], v[64:65], v[66:67]
    v_max3_f32 v78, v78, v55, v64
    v_max3_f32 v79, v56, v57, v58
    v_max3_f32 v78, v78, v65, v59
    v_max_f32 v78, v78, v79
    v_mov_b32 v79, v78
    v_mov_b32 v66, 0
    v_mov_b32 v67, 0
    v_permlane16_swap_b32 v78, v79
    v_max_f32 v78, v78, v79
    v_mov_b32 v79, v78
    s_nop 1
    v_permlane32_swap_b32 v78, v79
    v_max_f32 v78, v78, v79
    v_mul_f32 v78, s14, v78
    v_fma_f32 v52, v52, s14, -v78
    v_fma_f32 v53, v53, s14, -v78
    v_fma_f32 v54, v54, s14, -v78
    v_fma_f32 v55, v55, s14, -v78
    v_fma_f32 v56, v56, s14, -v78
    v_fma_f32 v57, v57, s14, -v78
    v_fma_f32 v58, v58, s14, -v78
    v_fma_f32 v59, v59, s14, -v78
    v_fma_f32 v64, v64, s14, -v78
    v_fma_f32 v65, v65, s14, -v78
    v_exp_f32 v52, v52
    v_exp_f32 v53, v53
    v_exp_f32 v54, v54
    v_exp_f32 v55, v55
    v_exp_f32 v56, v56
    v_exp_f32 v57, v57
    v_exp_f32 v58, v58
    v_exp_f32 v59, v59
    v_exp_f32 v64, v64
    v_exp_f32 v65, v65
    v_cvt_pk_bf16_f32 v52, v52, v53
    v_cvt_pk_bf16_f32 v53, v54, v55
    v_cvt_pk_bf16_f32 v54, v56, v57
    v_cvt_pk_bf16_f32 v55, v58, v59
    v_cvt_pk_bf16_f32 v64, v64, v65
    v_mov_b32 v65, 0
    v_mfma_f32_16x16x32_bf16 v[56:59], v[68:71], v[52:55], 0
    s_nop 0
    v_mfma_f32_16x16x32_bf16 v[56:59], v[68:71], v[64:67], v[56:59]
    v_mfma_f32_16x16x32_bf16 v[72:75], v[20:23], v[52:55], 0
    v_mfma_f32_16x16x32_bf16 v[76:79], v[24:27], v[52:55], 0
    v_mfma_f32_16x16x32_bf16 v[72:75], v[16:19], v[64:67], v[72:75]
    v_mfma_f32_16x16x32_bf16 v[76:79], v[18:21], v[64:67], v[76:79]
    v_rcp_f32 v56, v56
    v_rcp_f32 v57, v57
    s_nop 1
    v_pk_mul_f32 v[72:73], v[72:73], v[56:57]
    v_pk_mul_f32 v[74:75], v[74:75], v[56:57]
    s_nop 1
    v_pk_mul_f32 v[76:77], v[76:77], v[56:57]
    v_pk_mul_f32 v[78:79], v[78:79], v[56:57]
    v_cvt_pk_bf16_f32 v52, v72, v73
    v_cvt_pk_bf16_f32 v53, v74, v75
    v_cvt_pk_bf16_f32 v54, v76, v77
    v_cvt_pk_bf16_f32 v55, v78, v79
    buffer_store_dwordx4 v[52:55], v0, s[20:23], s17 offen offset:1024 sc1
    s_waitcnt lgkmcnt(0)
    v_smfmac_f32_16x16x64_bf16 v[60:63], v[8:11], v[28:35], v4
    v_smfmac_f32_16x16x64_bf16 v[60:63], v[12:15], v[36:43], v4
    v_max3_f32 v78, v44, v45, v46
    s_nop 6
    v_pk_add_f32 v[60:61], v[60:61], v[62:63]
    v_max3_f32 v78, v78, v47, v60
    v_max3_f32 v79, v48, v49, v50
    v_max3_f32 v78, v78, v61, v51
    v_max_f32 v78, v78, v79
    v_mov_b32 v79, v78
    v_mov_b32 v62, 0
    v_mov_b32 v63, 0
    v_permlane16_swap_b32 v78, v79
    v_max_f32 v78, v78, v79
    v_mov_b32 v79, v78
    s_nop 1
    v_permlane32_swap_b32 v78, v79
    v_max_f32 v78, v78, v79
    v_mul_f32 v78, s14, v78
    v_fma_f32 v44, v44, s14, -v78
    v_fma_f32 v45, v45, s14, -v78
    v_fma_f32 v46, v46, s14, -v78
    v_fma_f32 v47, v47, s14, -v78
    v_fma_f32 v48, v48, s14, -v78
    v_fma_f32 v49, v49, s14, -v78
    v_fma_f32 v50, v50, s14, -v78
    v_fma_f32 v51, v51, s14, -v78
    v_fma_f32 v60, v60, s14, -v78
    v_fma_f32 v61, v61, s14, -v78
    v_exp_f32 v44, v44
    v_exp_f32 v45, v45
    v_exp_f32 v46, v46
    v_exp_f32 v47, v47
    v_exp_f32 v48, v48
    v_exp_f32 v49, v49
    v_exp_f32 v50, v50
    v_exp_f32 v51, v51
    v_exp_f32 v60, v60
    v_exp_f32 v61, v61
    v_cvt_pk_bf16_f32 v44, v44, v45
    v_cvt_pk_bf16_f32 v45, v46, v47
    v_cvt_pk_bf16_f32 v46, v48, v49
    v_cvt_pk_bf16_f32 v47, v50, v51
    v_cvt_pk_bf16_f32 v60, v60, v61
    v_mov_b32 v61, 0
    v_mfma_f32_16x16x32_bf16 v[48:51], v[68:71], v[44:47], 0
    s_nop 0
    v_mfma_f32_16x16x32_bf16 v[48:51], v[68:71], v[60:63], v[48:51]
    v_mfma_f32_16x16x32_bf16 v[72:75], v[20:23], v[44:47], 0
    v_mfma_f32_16x16x32_bf16 v[76:79], v[24:27], v[44:47], 0
    v_mfma_f32_16x16x32_bf16 v[72:75], v[16:19], v[60:63], v[72:75]
    v_mfma_f32_16x16x32_bf16 v[76:79], v[18:21], v[60:63], v[76:79]
    v_rcp_f32 v48, v48
    v_rcp_f32 v49, v49
    s_nop 1
    v_pk_mul_f32 v[72:73], v[72:73], v[48:49]
    v_pk_mul_f32 v[74:75], v[74:75], v[48:49]
    s_nop 1
    v_pk_mul_f32 v[76:77], v[76:77], v[48:49]
    v_pk_mul_f32 v[78:79], v[78:79], v[48:49]
    v_cvt_pk_bf16_f32 v44, v72, v73
    v_cvt_pk_bf16_f32 v45, v74, v75
    v_cvt_pk_bf16_f32 v46, v76, v77
    v_cvt_pk_bf16_f32 v47, v78, v79
    buffer_store_dwordx4 v[44:47], v0, s[20:23], s17 offen offset:0 sc1
    s_lshl_b32 s17, s16, 7
    s_add_u32 s17, s17, 93585408
    s_waitcnt vmcnt(0)
    s_barrier
    s_cmp_lg_u32 s5, 0
    s_cbranch_scc1 p2_7b
    v_mov_b32 v8, 2
    s_mov_b64 exec, 1
    buffer_store_dword v8, off, s[20:23], s17 sc1
    s_mov_b64 exec, -1
p2_7b:
M_B_next:
    s_mov_b32 s11, s10
    s_add_u32 s10, s10, 4
    s_mov_b32 s38, s12
    s_mov_b32 s12, s13
    s_mov_b32 s13, s38
    s_cmp_lt_u32 s11, 64
    s_cbranch_scc1 M_B_loop
    s_cmp_eq_u32 s95, 1
    s_cbranch_scc1 M_Efin
    s_add_u32 s95, s95, 1
    s_add_u32 s20, s20, 100663296
    s_addc_u32 s21, s21, 0
    s_mov_b32 s22, 167772160
    s_add_u32 s24, s20, 96468992
    s_addc_u32 s25, s21, 0
    s_branch M_B_layer
M_C:
    v_mbcnt_lo_u32_b32 v0, -1, 0
    v_mbcnt_hi_u32_b32 v0, -1, v0
    s_and_b32 s8, s4, 31
    s_cmp_ge_u32 s4, 224
    s_cselect_b32 s9, 8, 0
    s_sub_u32 s8, s8, s9
    s_mov_b32 s39, s8
    s_sub_u32 s9, s4, 160
    s_lshr_b32 s9, s9, 5
    s_cmp_eq_u32 s9, 2
    s_cselect_b32 s6, 54, s9
    s_mul_i32 s40, s9, 24
    s_add_u32 s40, s40, s8
    s_cmp_ge_u32 s8, 12
    s_cselect_b32 s9, 1, 0
    s_mov_b32 s15, s9
    s_mul_i32 s9, s9, 12
    s_sub_u32 s7, s8, s9
    v_and_b32 v1, 7, v0
    v_lshlrev_b32 v1, 2, v1
    v_and_b32 v10, 15, v0
    v_lshrrev_b32 v11, 2, v10
    v_lshlrev_b32 v11, 3, v11
    v_and_b32 v12, 3, v10
    v_add_u32 v11, v11, v12
    v_mul_u32_u24 v2, 1152, v11
    v_lshrrev_b32 v12, 4, v0
    v_mul_u32_u24 v12, 24, v12
    v_add_u32 v2, v2, v12
    v_lshlrev_b32 v0, 4, v0
    s_mul_i32 s9, s5, 3072
    v_add_u32 v3, s9, v0
    s_mul_i32 s30, s5, 1179648
    s_mul_i32 s9, s7, 96
    s_add_u32 s30, s30, s9
    s_lshl_b32 s9, s5, 12
    v_add_u32 v9, s9, v0
    v_bfe_u32 v20, v0, 6, 2
    v_lshrrev_b32 v21, 8, v0
    v_lshl_add_u32 v20, v21, 3, v20
    v_mul_u32_u24 v20, 96, v20
    v_bfe_u32 v21, v0, 4, 2
    v_mul_u32_u24 v21, 24, v21
    v_add3_u32 v8, v20, v21, s9
    v_lshrrev_b32 v20, 4, v0
    v_add_u32 v21, 0, v20
    v_mul_u32_u24 v22, 171, v21
    v_lshrrev_b32 v22, 10, v22
    v_mul_u32_u24 v23, 6, v22
    v_sub_u32 v23, v21, v23
    v_mul_u32_u24 v22, 1152, v22
    v_lshl_add_u32 v5, v23, 4, v22
    v_add_u32 v21, 64, v20
    v_mul_u32_u24 v22, 171, v21
    v_lshrrev_b32 v22, 10, v22
    v_mul_u32_u24 v23, 6, v22
    v_sub_u32 v23, v21, v23
    v_mul_u32_u24 v22, 1152, v22
    v_lshl_add_u32 v6, v23, 4, v22
    v_add_u32 v21, 128, v20
    v_mul_u32_u24 v22, 171, v21
    v_lshrrev_b32 v22, 10, v22
    v_mul_u32_u24 v23, 6, v22
    v_sub_u32 v23, v21, v23
    v_mul_u32_u24 v22, 1152, v22
    v_lshl_add_u32 v7, v23, 4, v22
    s_add_u32 s9, s30, 0
    buffer_load_dwordx4 a[0:3], v5, s[76:79], s9 offen
    s_add_u32 s9, s30, 0
    buffer_load_dwordx4 a[4:7], v6, s[76:79], s9 offen
    s_add_u32 s9, s30, 0
    buffer_load_dwordx4 a[8:11], v7, s[76:79], s9 offen
    s_add_u32 s9, s30, 36864
    buffer_load_dwordx4 a[12:15], v5, s[76:79], s9 offen
    s_add_u32 s9, s30, 36864
    buffer_load_dwordx4 a[16:19], v6, s[76:79], s9 offen
    s_add_u32 s9, s30, 36864
    buffer_load_dwordx4 a[20:23], v7, s[76:79], s9 offen
    s_add_u32 s9, s30, 73728
    buffer_load_dwordx4 a[24:27], v5, s[76:79], s9 offen
    s_add_u32 s9, s30, 73728
    buffer_load_dwordx4 a[28:31], v6, s[76:79], s9 offen
    s_add_u32 s9, s30, 73728
    buffer_load_dwordx4 a[32:35], v7, s[76:79], s9 offen
    s_add_u32 s9, s30, 110592
    buffer_load_dwordx4 a[36:39], v5, s[76:79], s9 offen
    s_add_u32 s9, s30, 110592
    buffer_load_dwordx4 a[40:43], v6, s[76:79], s9 offen
    s_add_u32 s9, s30, 110592
    buffer_load_dwordx4 a[44:47], v7, s[76:79], s9 offen
    s_add_u32 s9, s30, 147456
    buffer_load_dwordx4 a[48:51], v5, s[76:79], s9 offen
    s_add_u32 s9, s30, 147456
    buffer_load_dwordx4 a[52:55], v6, s[76:79], s9 offen
    s_add_u32 s9, s30, 147456
    buffer_load_dwordx4 a[56:59], v7, s[76:79], s9 offen
    s_add_u32 s9, s30, 184320
    buffer_load_dwordx4 a[60:63], v5, s[76:79], s9 offen
    s_add_u32 s9, s30, 184320
    buffer_load_dwordx4 a[64:67], v6, s[76:79], s9 offen
    s_add_u32 s9, s30, 184320
    buffer_load_dwordx4 a[68:71], v7, s[76:79], s9 offen
    s_add_u32 s9, s30, 221184
    buffer_load_dwordx4 a[72:75], v5, s[76:79], s9 offen
    s_add_u32 s9, s30, 221184
    buffer_load_dwordx4 a[76:79], v6, s[76:79], s9 offen
    s_add_u32 s9, s30, 221184
    buffer_load_dwordx4 a[80:83], v7, s[76:79], s9 offen
    s_add_u32 s9, s30, 258048
    buffer_load_dwordx4 a[84:87], v5, s[76:79], s9 offen
    s_add_u32 s9, s30, 258048
    buffer_load_dwordx4 a[88:91], v6, s[76:79], s9 offen
    s_add_u32 s9, s30, 258048
    buffer_load_dwordx4 a[92:95], v7, s[76:79], s9 offen
    s_add_u32 s9, s30, 294912
    buffer_load_dwordx4 a[96:99], v5, s[76:79], s9 offen
    s_add_u32 s9, s30, 294912
    buffer_load_dwordx4 a[100:103], v6, s[76:79], s9 offen
    s_add_u32 s9, s30, 294912
    buffer_load_dwordx4 a[104:107], v7, s[76:79], s9 offen
    s_add_u32 s9, s30, 331776
    buffer_load_dwordx4 a[108:111], v5, s[76:79], s9 offen
    s_add_u32 s9, s30, 331776
    buffer_load_dwordx4 a[112:115], v6, s[76:79], s9 offen
    s_add_u32 s9, s30, 331776
    buffer_load_dwordx4 a[116:119], v7, s[76:79], s9 offen
    s_add_u32 s9, s30, 368640
    buffer_load_dwordx4 a[120:123], v5, s[76:79], s9 offen
    s_add_u32 s9, s30, 368640
    buffer_load_dwordx4 a[124:127], v6, s[76:79], s9 offen
    s_add_u32 s9, s30, 368640
    buffer_load_dwordx4 a[128:131], v7, s[76:79], s9 offen
    s_add_u32 s9, s30, 405504
    buffer_load_dwordx4 a[132:135], v5, s[76:79], s9 offen
    s_add_u32 s9, s30, 405504
    buffer_load_dwordx4 a[136:139], v6, s[76:79], s9 offen
    s_add_u32 s9, s30, 405504
    buffer_load_dwordx4 a[140:143], v7, s[76:79], s9 offen
    s_add_u32 s9, s30, 442368
    buffer_load_dwordx4 a[144:147], v5, s[76:79], s9 offen
    s_add_u32 s9, s30, 442368
    buffer_load_dwordx4 a[148:151], v6, s[76:79], s9 offen
    s_add_u32 s9, s30, 442368
    buffer_load_dwordx4 a[152:155], v7, s[76:79], s9 offen
    s_add_u32 s9, s30, 479232
    buffer_load_dwordx4 a[156:159], v5, s[76:79], s9 offen
    s_add_u32 s9, s30, 479232
    buffer_load_dwordx4 a[160:163], v6, s[76:79], s9 offen
    s_add_u32 s9, s30, 479232
    buffer_load_dwordx4 a[164:167], v7, s[76:79], s9 offen
    s_add_u32 s9, s30, 516096
    buffer_load_dwordx4 a[168:171], v5, s[76:79], s9 offen
    s_add_u32 s9, s30, 516096
    buffer_load_dwordx4 a[172:175], v6, s[76:79], s9 offen
    s_add_u32 s9, s30, 516096
    buffer_load_dwordx4 a[176:179], v7, s[76:79], s9 offen
    s_add_u32 s9, s30, 552960
    buffer_load_dwordx4 a[180:183], v5, s[76:79], s9 offen
    s_add_u32 s9, s30, 552960
    buffer_load_dwordx4 a[184:187], v6, s[76:79], s9 offen
    s_add_u32 s9, s30, 552960
    buffer_load_dwordx4 a[188:191], v7, s[76:79], s9 offen
    s_add_u32 s9, s30, 589824
    buffer_load_dwordx4 a[192:195], v5, s[76:79], s9 offen
    s_add_u32 s9, s30, 589824
    buffer_load_dwordx4 a[196:199], v6, s[76:79], s9 offen
    s_add_u32 s9, s30, 589824
    buffer_load_dwordx4 a[200:203], v7, s[76:79], s9 offen
    s_add_u32 s9, s30, 626688
    buffer_load_dwordx4 a[204:207], v5, s[76:79], s9 offen
    s_add_u32 s9, s30, 626688
    buffer_load_dwordx4 a[208:211], v6, s[76:79], s9 offen
    s_add_u32 s9, s30, 626688
    buffer_load_dwordx4 a[212:215], v7, s[76:79], s9 offen
    s_waitcnt vmcnt(51)
    ds_write_b128 v9, a[0:3] offset:0
    ds_write_b128 v9, a[4:7] offset:1024
    ds_write_b128 v9, a[8:11] offset:2048
    ds_read_b64_tr_b16 a[0:1], v8 offset:0
    ds_read_b64_tr_b16 a[2:3], v8 offset:384
    ds_read_b64_tr_b16 a[4:5], v8 offset:8
    ds_read_b64_tr_b16 a[6:7], v8 offset:392
    ds_read_b64_tr_b16 a[8:9], v8 offset:16
    ds_read_b64_tr_b16 a[10:11], v8 offset:400
    s_add_u32 s9, s30, 663552
    buffer_load_dwordx4 a[216:219], v5, s[76:79], s9 offen
    s_add_u32 s9, s30, 663552
    buffer_load_dwordx4 a[220:223], v6, s[76:79], s9 offen
    s_add_u32 s9, s30, 663552
    buffer_load_dwordx4 a[224:227], v7, s[76:79], s9 offen
    s_waitcnt vmcnt(51)
    ds_write_b128 v9, a[12:15] offset:0
    ds_write_b128 v9, a[16:19] offset:1024
    ds_write_b128 v9, a[20:23] offset:2048
    ds_read_b64_tr_b16 a[12:13], v8 offset:0
    ds_read_b64_tr_b16 a[14:15], v8 offset:384
    ds_read_b64_tr_b16 a[16:17], v8 offset:8
    ds_read_b64_tr_b16 a[18:19], v8 offset:392
    ds_read_b64_tr_b16 a[20:21], v8 offset:16
    ds_read_b64_tr_b16 a[22:23], v8 offset:400
    s_add_u32 s9, s30, 700416
    buffer_load_dwordx4 a[228:231], v5, s[76:79], s9 offen
    s_add_u32 s9, s30, 700416
    buffer_load_dwordx4 a[232:235], v6, s[76:79], s9 offen
    s_add_u32 s9, s30, 700416
    buffer_load_dwordx4 a[236:239], v7, s[76:79], s9 offen
    s_waitcnt vmcnt(51)
    ds_write_b128 v9, a[24:27] offset:0
    ds_write_b128 v9, a[28:31] offset:1024
    ds_write_b128 v9, a[32:35] offset:2048
    ds_read_b64_tr_b16 a[24:25], v8 offset:0
    ds_read_b64_tr_b16 a[26:27], v8 offset:384
    ds_read_b64_tr_b16 a[28:29], v8 offset:8
    ds_read_b64_tr_b16 a[30:31], v8 offset:392
    ds_read_b64_tr_b16 a[32:33], v8 offset:16
    ds_read_b64_tr_b16 a[34:35], v8 offset:400
    s_add_u32 s9, s30, 737280
    buffer_load_dwordx4 a[240:243], v5, s[76:79], s9 offen
    s_add_u32 s9, s30, 737280
    buffer_load_dwordx4 a[244:247], v6, s[76:79], s9 offen
    s_add_u32 s9, s30, 737280
    buffer_load_dwordx4 a[248:251], v7, s[76:79], s9 offen
    s_waitcnt vmcnt(51)
    ds_write_b128 v9, a[36:39] offset:0
    ds_write_b128 v9, a[40:43] offset:1024
    ds_write_b128 v9, a[44:47] offset:2048
    ds_read_b64_tr_b16 a[36:37], v8 offset:0
    ds_read_b64_tr_b16 a[38:39], v8 offset:384
    ds_read_b64_tr_b16 a[40:41], v8 offset:8
    ds_read_b64_tr_b16 a[42:43], v8 offset:392
    ds_read_b64_tr_b16 a[44:45], v8 offset:16
    ds_read_b64_tr_b16 a[46:47], v8 offset:400
    s_add_u32 s9, s30, 774144
    buffer_load_dwordx4 a[252:255], v5, s[76:79], s9 offen
    s_add_u32 s9, s30, 774144
    buffer_load_dwordx4 v[128:131], v6, s[76:79], s9 offen
    s_add_u32 s9, s30, 774144
    buffer_load_dwordx4 v[132:135], v7, s[76:79], s9 offen
    s_waitcnt vmcnt(51)
    ds_write_b128 v9, a[48:51] offset:0
    ds_write_b128 v9, a[52:55] offset:1024
    ds_write_b128 v9, a[56:59] offset:2048
    ds_read_b64_tr_b16 a[48:49], v8 offset:0
    ds_read_b64_tr_b16 a[50:51], v8 offset:384
    ds_read_b64_tr_b16 a[52:53], v8 offset:8
    ds_read_b64_tr_b16 a[54:55], v8 offset:392
    ds_read_b64_tr_b16 a[56:57], v8 offset:16
    ds_read_b64_tr_b16 a[58:59], v8 offset:400
    s_add_u32 s9, s30, 811008
    buffer_load_dwordx4 v[136:139], v5, s[76:79], s9 offen
    s_add_u32 s9, s30, 811008
    buffer_load_dwordx4 v[140:143], v6, s[76:79], s9 offen
    s_add_u32 s9, s30, 811008
    buffer_load_dwordx4 v[144:147], v7, s[76:79], s9 offen
    s_waitcnt vmcnt(51)
    ds_write_b128 v9, a[60:63] offset:0
    ds_write_b128 v9, a[64:67] offset:1024
    ds_write_b128 v9, a[68:71] offset:2048
    ds_read_b64_tr_b16 a[60:61], v8 offset:0
    ds_read_b64_tr_b16 a[62:63], v8 offset:384
    ds_read_b64_tr_b16 a[64:65], v8 offset:8
    ds_read_b64_tr_b16 a[66:67], v8 offset:392
    ds_read_b64_tr_b16 a[68:69], v8 offset:16
    ds_read_b64_tr_b16 a[70:71], v8 offset:400
    s_add_u32 s9, s30, 847872
    buffer_load_dwordx4 v[148:151], v5, s[76:79], s9 offen
    s_add_u32 s9, s30, 847872
    buffer_load_dwordx4 v[152:155], v6, s[76:79], s9 offen
    s_add_u32 s9, s30, 847872
    buffer_load_dwordx4 v[156:159], v7, s[76:79], s9 offen
    s_waitcnt vmcnt(51)
    ds_write_b128 v9, a[72:75] offset:0
    ds_write_b128 v9, a[76:79] offset:1024
    ds_write_b128 v9, a[80:83] offset:2048
    ds_read_b64_tr_b16 a[72:73], v8 offset:0
    ds_read_b64_tr_b16 a[74:75], v8 offset:384
    ds_read_b64_tr_b16 a[76:77], v8 offset:8
    ds_read_b64_tr_b16 a[78:79], v8 offset:392
    ds_read_b64_tr_b16 a[80:81], v8 offset:16
    ds_read_b64_tr_b16 a[82:83], v8 offset:400
    s_add_u32 s9, s30, 884736
    buffer_load_dwordx4 v[160:163], v5, s[76:79], s9 offen
    s_add_u32 s9, s30, 884736
    buffer_load_dwordx4 v[164:167], v6, s[76:79], s9 offen
    s_add_u32 s9, s30, 884736
    buffer_load_dwordx4 v[168:171], v7, s[76:79], s9 offen
    s_waitcnt vmcnt(51)
    ds_write_b128 v9, a[84:87] offset:0
    ds_write_b128 v9, a[88:91] offset:1024
    ds_write_b128 v9, a[92:95] offset:2048
    ds_read_b64_tr_b16 a[84:85], v8 offset:0
    ds_read_b64_tr_b16 a[86:87], v8 offset:384
    ds_read_b64_tr_b16 a[88:89], v8 offset:8
    ds_read_b64_tr_b16 a[90:91], v8 offset:392
    ds_read_b64_tr_b16 a[92:93], v8 offset:16
    ds_read_b64_tr_b16 a[94:95], v8 offset:400
    s_add_u32 s9, s30, 921600
    buffer_load_dwordx4 v[172:175], v5, s[76:79], s9 offen
    s_add_u32 s9, s30, 921600
    buffer_load_dwordx4 v[176:179], v6, s[76:79], s9 offen
    s_add_u32 s9, s30, 921600
    buffer_load_dwordx4 v[180:183], v7, s[76:79], s9 offen
    s_waitcnt vmcnt(51)
    ds_write_b128 v9, a[96:99] offset:0
    ds_write_b128 v9, a[100:103] offset:1024
    ds_write_b128 v9, a[104:107] offset:2048
    ds_read_b64_tr_b16 a[96:97], v8 offset:0
    ds_read_b64_tr_b16 a[98:99], v8 offset:384
    ds_read_b64_tr_b16 a[100:101], v8 offset:8
    ds_read_b64_tr_b16 a[102:103], v8 offset:392
    ds_read_b64_tr_b16 a[104:105], v8 offset:16
    ds_read_b64_tr_b16 a[106:107], v8 offset:400
    s_add_u32 s9, s30, 958464
    buffer_load_dwordx4 v[184:187], v5, s[76:79], s9 offen
    s_add_u32 s9, s30, 958464
    buffer_load_dwordx4 v[188:191], v6, s[76:79], s9 offen
    s_add_u32 s9, s30, 958464
    buffer_load_dwordx4 v[192:195], v7, s[76:79], s9 offen
    s_waitcnt vmcnt(51)
    ds_write_b128 v9, a[108:111] offset:0
    ds_write_b128 v9, a[112:115] offset:1024
    ds_write_b128 v9, a[116:119] offset:2048
    ds_read_b64_tr_b16 a[108:109], v8 offset:0
    ds_read_b64_tr_b16 a[110:111], v8 offset:384
    ds_read_b64_tr_b16 a[112:113], v8 offset:8
    ds_read_b64_tr_b16 a[114:115], v8 offset:392
    ds_read_b64_tr_b16 a[116:117], v8 offset:16
    ds_read_b64_tr_b16 a[118:119], v8 offset:400
    s_add_u32 s9, s30, 995328
    buffer_load_dwordx4 v[196:199], v5, s[76:79], s9 offen
    s_add_u32 s9, s30, 995328
    buffer_load_dwordx4 v[200:203], v6, s[76:79], s9 offen
    s_add_u32 s9, s30, 995328
    buffer_load_dwordx4 v[204:207], v7, s[76:79], s9 offen
    s_waitcnt vmcnt(51)
    ds_write_b128 v9, a[120:123] offset:0
    ds_write_b128 v9, a[124:127] offset:1024
    ds_write_b128 v9, a[128:131] offset:2048
    ds_read_b64_tr_b16 a[120:121], v8 offset:0
    ds_read_b64_tr_b16 a[122:123], v8 offset:384
    ds_read_b64_tr_b16 a[124:125], v8 offset:8
    ds_read_b64_tr_b16 a[126:127], v8 offset:392
    ds_read_b64_tr_b16 a[128:129], v8 offset:16
    ds_read_b64_tr_b16 a[130:131], v8 offset:400
    s_add_u32 s9, s30, 1032192
    buffer_load_dwordx4 v[208:211], v5, s[76:79], s9 offen
    s_add_u32 s9, s30, 1032192
    buffer_load_dwordx4 v[212:215], v6, s[76:79], s9 offen
    s_add_u32 s9, s30, 1032192
    buffer_load_dwordx4 v[216:219], v7, s[76:79], s9 offen
    s_waitcnt vmcnt(51)
    ds_write_b128 v9, a[132:135] offset:0
    ds_write_b128 v9, a[136:139] offset:1024
    ds_write_b128 v9, a[140:143] offset:2048
    ds_read_b64_tr_b16 a[132:133], v8 offset:0
    ds_read_b64_tr_b16 a[134:135], v8 offset:384
    ds_read_b64_tr_b16 a[136:137], v8 offset:8
    ds_read_b64_tr_b16 a[138:139], v8 offset:392
    ds_read_b64_tr_b16 a[140:141], v8 offset:16
    ds_read_b64_tr_b16 a[142:143], v8 offset:400
    s_add_u32 s9, s30, 1069056
    buffer_load_dwordx4 v[220:223], v5, s[76:79], s9 offen
    s_add_u32 s9, s30, 1069056
    buffer_load_dwordx4 v[224:227], v6, s[76:79], s9 offen
    s_add_u32 s9, s30, 1069056
    buffer_load_dwordx4 v[228:231], v7, s[76:79], s9 offen
    s_waitcnt vmcnt(51)
    ds_write_b128 v9, a[144:147] offset:0
    ds_write_b128 v9, a[148:151] offset:1024
    ds_write_b128 v9, a[152:155] offset:2048
    ds_read_b64_tr_b16 a[144:145], v8 offset:0
    ds_read_b64_tr_b16 a[146:147], v8 offset:384
    ds_read_b64_tr_b16 a[148:149], v8 offset:8
    ds_read_b64_tr_b16 a[150:151], v8 offset:392
    ds_read_b64_tr_b16 a[152:153], v8 offset:16
    ds_read_b64_tr_b16 a[154:155], v8 offset:400
    s_add_u32 s9, s30, 1105920
    buffer_load_dwordx4 v[232:235], v5, s[76:79], s9 offen
    s_add_u32 s9, s30, 1105920
    buffer_load_dwordx4 v[236:239], v6, s[76:79], s9 offen
    s_add_u32 s9, s30, 1105920
    buffer_load_dwordx4 v[240:243], v7, s[76:79], s9 offen
    s_waitcnt vmcnt(51)
    ds_write_b128 v9, a[156:159] offset:0
    ds_write_b128 v9, a[160:163] offset:1024
    ds_write_b128 v9, a[164:167] offset:2048
    ds_read_b64_tr_b16 a[156:157], v8 offset:0
    ds_read_b64_tr_b16 a[158:159], v8 offset:384
    ds_read_b64_tr_b16 a[160:161], v8 offset:8
    ds_read_b64_tr_b16 a[162:163], v8 offset:392
    ds_read_b64_tr_b16 a[164:165], v8 offset:16
    ds_read_b64_tr_b16 a[166:167], v8 offset:400
    s_add_u32 s9, s30, 1142784
    buffer_load_dwordx4 v[244:247], v5, s[76:79], s9 offen
    s_add_u32 s9, s30, 1142784
    buffer_load_dwordx4 v[248:251], v6, s[76:79], s9 offen
    s_add_u32 s9, s30, 1142784
    buffer_load_dwordx4 v[252:255], v7, s[76:79], s9 offen
    s_waitcnt vmcnt(51)
    ds_write_b128 v9, a[168:171] offset:0
    ds_write_b128 v9, a[172:175] offset:1024
    ds_write_b128 v9, a[176:179] offset:2048
    ds_read_b64_tr_b16 a[168:169], v8 offset:0
    ds_read_b64_tr_b16 a[170:171], v8 offset:384
    ds_read_b64_tr_b16 a[172:173], v8 offset:8
    ds_read_b64_tr_b16 a[174:175], v8 offset:392
    ds_read_b64_tr_b16 a[176:177], v8 offset:16
    ds_read_b64_tr_b16 a[178:179], v8 offset:400
    s_waitcnt vmcnt(48)
    ds_write_b128 v9, a[180:183] offset:0
    ds_write_b128 v9, a[184:187] offset:1024
    ds_write_b128 v9, a[188:191] offset:2048
    ds_read_b64_tr_b16 a[180:181], v8 offset:0
    ds_read_b64_tr_b16 a[182:183], v8 offset:384
    ds_read_b64_tr_b16 a[184:185], v8 offset:8
    ds_read_b64_tr_b16 a[186:187], v8 offset:392
    ds_read_b64_tr_b16 a[188:189], v8 offset:16
    ds_read_b64_tr_b16 a[190:191], v8 offset:400
    s_waitcnt vmcnt(45)
    ds_write_b128 v9, a[192:195] offset:0
    ds_write_b128 v9, a[196:199] offset:1024
    ds_write_b128 v9, a[200:203] offset:2048
    ds_read_b64_tr_b16 a[192:193], v8 offset:0
    ds_read_b64_tr_b16 a[194:195], v8 offset:384
    ds_read_b64_tr_b16 a[196:197], v8 offset:8
    ds_read_b64_tr_b16 a[198:199], v8 offset:392
    ds_read_b64_tr_b16 a[200:201], v8 offset:16
    ds_read_b64_tr_b16 a[202:203], v8 offset:400
    s_waitcnt vmcnt(42)
    ds_write_b128 v9, a[204:207] offset:0
    ds_write_b128 v9, a[208:211] offset:1024
    ds_write_b128 v9, a[212:215] offset:2048
    ds_read_b64_tr_b16 a[204:205], v8 offset:0
    ds_read_b64_tr_b16 a[206:207], v8 offset:384
    ds_read_b64_tr_b16 a[208:209], v8 offset:8
    ds_read_b64_tr_b16 a[210:211], v8 offset:392
    ds_read_b64_tr_b16 a[212:213], v8 offset:16
    ds_read_b64_tr_b16 a[214:215], v8 offset:400
    s_waitcnt vmcnt(39)
    ds_write_b128 v9, a[216:219] offset:0
    ds_write_b128 v9, a[220:223] offset:1024
    ds_write_b128 v9, a[224:227] offset:2048
    ds_read_b64_tr_b16 a[216:217], v8 offset:0
    ds_read_b64_tr_b16 a[218:219], v8 offset:384
    ds_read_b64_tr_b16 a[220:221], v8 offset:8
    ds_read_b64_tr_b16 a[222:223], v8 offset:392
    ds_read_b64_tr_b16 a[224:225], v8 offset:16
    ds_read_b64_tr_b16 a[226:227], v8 offset:400
    s_waitcnt vmcnt(36)
    ds_write_b128 v9, a[228:231] offset:0
    ds_write_b128 v9, a[232:235] offset:1024
    ds_write_b128 v9, a[236:239] offset:2048
    ds_read_b64_tr_b16 a[228:229], v8 offset:0
    ds_read_b64_tr_b16 a[230:231], v8 offset:384
    ds_read_b64_tr_b16 a[232:233], v8 offset:8
    ds_read_b64_tr_b16 a[234:235], v8 offset:392
    ds_read_b64_tr_b16 a[236:237], v8 offset:16
    ds_read_b64_tr_b16 a[238:239], v8 offset:400
    s_waitcnt vmcnt(33)
    ds_write_b128 v9, a[240:243] offset:0
    ds_write_b128 v9, a[244:247] offset:1024
    ds_write_b128 v9, a[248:251] offset:2048
    ds_read_b64_tr_b16 a[240:241], v8 offset:0
    ds_read_b64_tr_b16 a[242:243], v8 offset:384
    ds_read_b64_tr_b16 a[244:245], v8 offset:8
    ds_read_b64_tr_b16 a[246:247], v8 offset:392
    ds_read_b64_tr_b16 a[248:249], v8 offset:16
    ds_read_b64_tr_b16 a[250:251], v8 offset:400
    s_waitcnt vmcnt(30)
    ds_write_b128 v9, a[252:255] offset:0
    ds_write_b128 v9, v[128:131] offset:1024
    ds_write_b128 v9, v[132:135] offset:2048
    ds_read_b64_tr_b16 a[252:253], v8 offset:0
    ds_read_b64_tr_b16 a[254:255], v8 offset:384
    ds_read_b64_tr_b16 v[128:129], v8 offset:8
    ds_read_b64_tr_b16 v[130:131], v8 offset:392
    ds_read_b64_tr_b16 v[132:133], v8 offset:16
    ds_read_b64_tr_b16 v[134:135], v8 offset:400
    s_waitcnt vmcnt(27)
    ds_write_b128 v9, v[136:139] offset:0
    ds_write_b128 v9, v[140:143] offset:1024
    ds_write_b128 v9, v[144:147] offset:2048
    ds_read_b64_tr_b16 v[136:137], v8 offset:0
    ds_read_b64_tr_b16 v[138:139], v8 offset:384
    ds_read_b64_tr_b16 v[140:141], v8 offset:8
    ds_read_b64_tr_b16 v[142:143], v8 offset:392
    ds_read_b64_tr_b16 v[144:145], v8 offset:16
    ds_read_b64_tr_b16 v[146:147], v8 offset:400
    s_waitcnt vmcnt(24)
    ds_write_b128 v9, v[148:151] offset:0
    ds_write_b128 v9, v[152:155] offset:1024
    ds_write_b128 v9, v[156:159] offset:2048
    ds_read_b64_tr_b16 v[148:149], v8 offset:0
    ds_read_b64_tr_b16 v[150:151], v8 offset:384
    ds_read_b64_tr_b16 v[152:153], v8 offset:8
    ds_read_b64_tr_b16 v[154:155], v8 offset:392
    ds_read_b64_tr_b16 v[156:157], v8 offset:16
    ds_read_b64_tr_b16 v[158:159], v8 offset:400
    s_waitcnt vmcnt(21)
    ds_write_b128 v9, v[160:163] offset:0
    ds_write_b128 v9, v[164:167] offset:1024
    ds_write_b128 v9, v[168:171] offset:2048
    ds_read_b64_tr_b16 v[160:161], v8 offset:0
    ds_read_b64_tr_b16 v[162:163], v8 offset:384
    ds_read_b64_tr_b16 v[164:165], v8 offset:8
    ds_read_b64_tr_b16 v[166:167], v8 offset:392
    ds_read_b64_tr_b16 v[168:169], v8 offset:16
    ds_read_b64_tr_b16 v[170:171], v8 offset:400
    s_waitcnt vmcnt(18)
    ds_write_b128 v9, v[172:175] offset:0
    ds_write_b128 v9, v[176:179] offset:1024
    ds_write_b128 v9, v[180:183] offset:2048
    ds_read_b64_tr_b16 v[172:173], v8 offset:0
    ds_read_b64_tr_b16 v[174:175], v8 offset:384
    ds_read_b64_tr_b16 v[176:177], v8 offset:8
    ds_read_b64_tr_b16 v[178:179], v8 offset:392
    ds_read_b64_tr_b16 v[180:181], v8 offset:16
    ds_read_b64_tr_b16 v[182:183], v8 offset:400
    s_waitcnt vmcnt(15)
    ds_write_b128 v9, v[184:187] offset:0
    ds_write_b128 v9, v[188:191] offset:1024
    ds_write_b128 v9, v[192:195] offset:2048
    ds_read_b64_tr_b16 v[184:185], v8 offset:0
    ds_read_b64_tr_b16 v[186:187], v8 offset:384
    ds_read_b64_tr_b16 v[188:189], v8 offset:8
    ds_read_b64_tr_b16 v[190:191], v8 offset:392
    ds_read_b64_tr_b16 v[192:193], v8 offset:16
    ds_read_b64_tr_b16 v[194:195], v8 offset:400
    s_waitcnt vmcnt(12)
    ds_write_b128 v9, v[196:199] offset:0
    ds_write_b128 v9, v[200:203] offset:1024
    ds_write_b128 v9, v[204:207] offset:2048
    ds_read_b64_tr_b16 v[196:197], v8 offset:0
    ds_read_b64_tr_b16 v[198:199], v8 offset:384
    ds_read_b64_tr_b16 v[200:201], v8 offset:8
    ds_read_b64_tr_b16 v[202:203], v8 offset:392
    ds_read_b64_tr_b16 v[204:205], v8 offset:16
    ds_read_b64_tr_b16 v[206:207], v8 offset:400
    s_waitcnt vmcnt(9)
    ds_write_b128 v9, v[208:211] offset:0
    ds_write_b128 v9, v[212:215] offset:1024
    ds_write_b128 v9, v[216:219] offset:2048
    ds_read_b64_tr_b16 v[208:209], v8 offset:0
    ds_read_b64_tr_b16 v[210:211], v8 offset:384
    ds_read_b64_tr_b16 v[212:213], v8 offset:8
    ds_read_b64_tr_b16 v[214:215], v8 offset:392
    ds_read_b64_tr_b16 v[216:217], v8 offset:16
    ds_read_b64_tr_b16 v[218:219], v8 offset:400
    s_waitcnt vmcnt(6)
    ds_write_b128 v9, v[220:223] offset:0
    ds_write_b128 v9, v[224:227] offset:1024
    ds_write_b128 v9, v[228:231] offset:2048
    ds_read_b64_tr_b16 v[220:221], v8 offset:0
    ds_read_b64_tr_b16 v[222:223], v8 offset:384
    ds_read_b64_tr_b16 v[224:225], v8 offset:8
    ds_read_b64_tr_b16 v[226:227], v8 offset:392
    ds_read_b64_tr_b16 v[228:229], v8 offset:16
    ds_read_b64_tr_b16 v[230:231], v8 offset:400
    s_waitcnt vmcnt(3)
    ds_write_b128 v9, v[232:235] offset:0
    ds_write_b128 v9, v[236:239] offset:1024
    ds_write_b128 v9, v[240:243] offset:2048
    ds_read_b64_tr_b16 v[232:233], v8 offset:0
    ds_read_b64_tr_b16 v[234:235], v8 offset:384
    ds_read_b64_tr_b16 v[236:237], v8 offset:8
    ds_read_b64_tr_b16 v[238:239], v8 offset:392
    ds_read_b64_tr_b16 v[240:241], v8 offset:16
    ds_read_b64_tr_b16 v[242:243], v8 offset:400
    s_waitcnt vmcnt(0)
    ds_write_b128 v9, v[244:247] offset:0
    ds_write_b128 v9, v[248:251] offset:1024
    ds_write_b128 v9, v[252:255] offset:2048
    ds_read_b64_tr_b16 v[244:245], v8 offset:0
    ds_read_b64_tr_b16 v[246:247], v8 offset:384
    ds_read_b64_tr_b16 v[248:249], v8 offset:8
    ds_read_b64_tr_b16 v[250:251], v8 offset:392
    ds_read_b64_tr_b16 v[252:253], v8 offset:16
    ds_read_b64_tr_b16 v[254:255], v8 offset:400
    s_waitcnt lgkmcnt(0)
    s_barrier
    v_mov_b32 v8, 44
wd_8:
    global_load_dword v9, v8, s[28:29] sc1
    s_waitcnt vmcnt(0)
    v_readfirstlane_b32 s9, v9
    s_cmp_ge_u32 s9, 96
    s_cbranch_scc1 wd_8d
    s_sleep 4
    s_sub_u32 s94, s94, 1
    s_cbranch_scc0 wd_8
    s_mov_b32 s94, 0
wd_8d:
M_C_loop:
    s_lshl_b32 s10, s6, 5
    s_lshl_b32 s11, s5, 3
    s_add_u32 s10, s10, s11
    s_lshl_b32 s11, s6, 12
    s_add_u32 s11, s11, 93585408
    s_lshl_b32 s12, s10, 13
    s_add_u32 s12, s12, 67108864
    s_lshl_b32 s14, s15, 10
    s_add_u32 s12, s12, s14
    s_mul_i32 s13, s6, 36864
    s_mul_i32 s14, s7, 96
    s_add_u32 s13, s13, s14
    s_mul_i32 s14, s15, 4608
    s_add_u32 s13, s13, s14
    s_cmp_lg_u32 s5, 1
    s_cbranch_scc1 wf_9d
    v_lshlrev_b32 v4, 3, v0
    v_min_u32 v4, 3968, v4
wf_9:
    buffer_load_dword v5, v4, s[20:23], s11 offen sc1
    s_waitcnt vmcnt(0)
    v_cmp_gt_u32 vcc, 1, v5
    s_cbranch_vccz wf_9d
    s_sleep 2
    s_sub_u32 s94, s94, 1
    s_cbranch_scc0 wf_9
    s_mov_b32 s94, 0
wf_9d:
    s_barrier
    s_mov_b32 s38, 0
    s_mov_b32 s37, s12
M_C_go:
    buffer_load_dwordx4 v[28:31], v0, s[20:23], s12 offen offset:0 sc1
    buffer_load_dwordx4 v[32:35], v0, s[20:23], s12 offen offset:2048 sc1
    s_add_u32 s12, s12, 4096
    buffer_load_dwordx4 v[36:39], v0, s[20:23], s12 offen offset:0 sc1
    buffer_load_dwordx4 v[40:43], v0, s[20:23], s12 offen offset:2048 sc1
    s_add_u32 s12, s12, 4096
    buffer_load_dwordx4 v[44:47], v0, s[20:23], s12 offen offset:0 sc1
    buffer_load_dwordx4 v[48:51], v0, s[20:23], s12 offen offset:2048 sc1
    s_add_u32 s12, s12, 4096
    buffer_load_dwordx4 v[52:55], v0, s[20:23], s12 offen offset:0 sc1
    buffer_load_dwordx4 v[56:59], v0, s[20:23], s12 offen offset:2048 sc1
    s_add_u32 s12, s12, 4096
    buffer_load_dwordx4 v[60:63], v0, s[20:23], s12 offen offset:0 sc1
    buffer_load_dwordx4 v[64:67], v0, s[20:23], s12 offen offset:2048 sc1
    s_add_u32 s12, s12, 4096
    buffer_load_dwordx4 v[68:71], v0, s[20:23], s12 offen offset:0 sc1
    buffer_load_dwordx4 v[72:75], v0, s[20:23], s12 offen offset:2048 sc1
    s_add_u32 s12, s12, 4096
    buffer_load_dwordx4 v[76:79], v0, s[20:23], s12 offen offset:0 sc1
    buffer_load_dwordx4 v[80:83], v0, s[20:23], s12 offen offset:2048 sc1
    s_add_u32 s12, s12, 4096
    buffer_load_dwordx4 v[84:87], v0, s[20:23], s12 offen offset:0 sc1
    buffer_load_dwordx4 v[88:91], v0, s[20:23], s12 offen offset:2048 sc1
    s_add_u32 s12, s12, 4096
    buffer_load_dwordx4 v[92:95], v0, s[20:23], s12 offen offset:0 sc1
    buffer_load_dwordx4 v[96:99], v0, s[20:23], s12 offen offset:2048 sc1
    s_add_u32 s12, s12, 4096
    buffer_load_dwordx4 v[100:103], v0, s[20:23], s12 offen offset:0 sc1
    buffer_load_dwordx4 v[104:107], v0, s[20:23], s12 offen offset:2048 sc1
    s_add_u32 s12, s12, 4096
    buffer_load_dwordx4 v[108:111], v0, s[20:23], s12 offen offset:0 sc1
    buffer_load_dwordx4 v[112:115], v0, s[20:23], s12 offen offset:2048 sc1
    s_add_u32 s12, s12, 4096
    buffer_load_dwordx4 v[116:119], v0, s[20:23], s12 offen offset:0 sc1
    buffer_load_dwordx4 v[120:123], v0, s[20:23], s12 offen offset:2048 sc1
    s_add_u32 s12, s12, 4096
    buffer_load_dwordx4 v[124:127], v0, s[20:23], s12 offen offset:0 sc1
    s_waitcnt vmcnt(24)
    v_mfma_f32_16x16x32_bf16 v[16:19], a[0:3], v[28:31], 0
    v_mfma_f32_16x16x32_bf16 v[20:23], a[4:7], v[28:31], 0
    v_mfma_f32_16x16x32_bf16 v[24:27], a[8:11], v[28:31], 0
    buffer_load_dwordx4 v[28:31], v0, s[20:23], s12 offen offset:2048 sc1
    s_add_u32 s12, s12, 4096
    s_waitcnt vmcnt(24)
    v_mfma_f32_16x16x32_bf16 v[16:19], a[12:15], v[32:35], v[16:19]
    v_mfma_f32_16x16x32_bf16 v[20:23], a[16:19], v[32:35], v[20:23]
    v_mfma_f32_16x16x32_bf16 v[24:27], a[20:23], v[32:35], v[24:27]
    buffer_load_dwordx4 v[32:35], v0, s[20:23], s12 offen offset:0 sc1
    s_waitcnt vmcnt(24)
    v_mfma_f32_16x16x32_bf16 v[16:19], a[24:27], v[36:39], v[16:19]
    v_mfma_f32_16x16x32_bf16 v[20:23], a[28:31], v[36:39], v[20:23]
    v_mfma_f32_16x16x32_bf16 v[24:27], a[32:35], v[36:39], v[24:27]
    buffer_load_dwordx4 v[36:39], v0, s[20:23], s12 offen offset:2048 sc1
    s_add_u32 s12, s12, 4096
    s_waitcnt vmcnt(24)
    v_mfma_f32_16x16x32_bf16 v[16:19], a[36:39], v[40:43], v[16:19]
    v_mfma_f32_16x16x32_bf16 v[20:23], a[40:43], v[40:43], v[20:23]
    v_mfma_f32_16x16x32_bf16 v[24:27], a[44:47], v[40:43], v[24:27]
    buffer_load_dwordx4 v[40:43], v0, s[20:23], s12 offen offset:0 sc1
    s_waitcnt vmcnt(24)
    v_mfma_f32_16x16x32_bf16 v[16:19], a[48:51], v[44:47], v[16:19]
    v_mfma_f32_16x16x32_bf16 v[20:23], a[52:55], v[44:47], v[20:23]
    v_mfma_f32_16x16x32_bf16 v[24:27], a[56:59], v[44:47], v[24:27]
    buffer_load_dwordx4 v[44:47], v0, s[20:23], s12 offen offset:2048 sc1
    s_add_u32 s12, s12, 4096
    s_waitcnt vmcnt(24)
    v_mfma_f32_16x16x32_bf16 v[16:19], a[60:63], v[48:51], v[16:19]
    v_mfma_f32_16x16x32_bf16 v[20:23], a[64:67], v[48:51], v[20:23]
    v_mfma_f32_16x16x32_bf16 v[24:27], a[68:71], v[48:51], v[24:27]
    buffer_load_dwordx4 v[48:51], v0, s[20:23], s12 offen offset:0 sc1
    s_waitcnt vmcnt(24)
    v_mfma_f32_16x16x32_bf16 v[16:19], a[72:75], v[52:55], v[16:19]
    v_mfma_f32_16x16x32_bf16 v[20:23], a[76:79], v[52:55], v[20:23]
    v_mfma_f32_16x16x32_bf16 v[24:27], a[80:83], v[52:55], v[24:27]
    buffer_load_dwordx4 v[52:55], v0, s[20:23], s12 offen offset:2048 sc1
    s_add_u32 s12, s12, 4096
    s_waitcnt vmcnt(24)
    v_mfma_f32_16x16x32_bf16 v[16:19], a[84:87], v[56:59], v[16:19]
    v_mfma_f32_16x16x32_bf16 v[20:23], a[88:91], v[56:59], v[20:23]
    v_mfma_f32_16x16x32_bf16 v[24:27], a[92:95], v[56:59], v[24:27]
    buffer_load_dwordx4 v[8:11], v2, s[24:27], s13 offen sc1
    buffer_load_dwordx2 v[12:13], v2, s[24:27], s13 offen offset:16 sc1
    s_waitcnt vmcnt(25)
    v_mfma_f32_16x16x32_bf16 v[16:19], a[96:99], v[60:63], v[16:19]
    v_mfma_f32_16x16x32_bf16 v[20:23], a[100:103], v[60:63], v[20:23]
    v_mfma_f32_16x16x32_bf16 v[24:27], a[104:107], v[60:63], v[24:27]
    s_waitcnt vmcnt(24)
    v_mfma_f32_16x16x32_bf16 v[16:19], a[108:111], v[64:67], v[16:19]
    v_mfma_f32_16x16x32_bf16 v[20:23], a[112:115], v[64:67], v[20:23]
    v_mfma_f32_16x16x32_bf16 v[24:27], a[116:119], v[64:67], v[24:27]
    s_waitcnt vmcnt(23)
    v_mfma_f32_16x16x32_bf16 v[16:19], a[120:123], v[68:71], v[16:19]
    v_mfma_f32_16x16x32_bf16 v[20:23], a[124:127], v[68:71], v[20:23]
    v_mfma_f32_16x16x32_bf16 v[24:27], a[128:131], v[68:71], v[24:27]
    s_waitcnt vmcnt(22)
    v_mfma_f32_16x16x32_bf16 v[16:19], a[132:135], v[72:75], v[16:19]
    v_mfma_f32_16x16x32_bf16 v[20:23], a[136:139], v[72:75], v[20:23]
    v_mfma_f32_16x16x32_bf16 v[24:27], a[140:143], v[72:75], v[24:27]
    s_waitcnt vmcnt(21)
    v_mfma_f32_16x16x32_bf16 v[16:19], a[144:147], v[76:79], v[16:19]
    v_mfma_f32_16x16x32_bf16 v[20:23], a[148:151], v[76:79], v[20:23]
    v_mfma_f32_16x16x32_bf16 v[24:27], a[152:155], v[76:79], v[24:27]
    s_waitcnt vmcnt(20)
    v_mfma_f32_16x16x32_bf16 v[16:19], a[156:159], v[80:83], v[16:19]
    v_mfma_f32_16x16x32_bf16 v[20:23], a[160:163], v[80:83], v[20:23]
    v_mfma_f32_16x16x32_bf16 v[24:27], a[164:167], v[80:83], v[24:27]
    s_waitcnt vmcnt(19)
    v_mfma_f32_16x16x32_bf16 v[16:19], a[168:171], v[84:87], v[16:19]
    v_mfma_f32_16x16x32_bf16 v[20:23], a[172:175], v[84:87], v[20:23]
    v_mfma_f32_16x16x32_bf16 v[24:27], a[176:179], v[84:87], v[24:27]
    s_waitcnt vmcnt(18)
    v_mfma_f32_16x16x32_bf16 v[16:19], a[180:183], v[88:91], v[16:19]
    v_mfma_f32_16x16x32_bf16 v[20:23], a[184:187], v[88:91], v[20:23]
    v_mfma_f32_16x16x32_bf16 v[24:27], a[188:191], v[88:91], v[24:27]
    s_waitcnt vmcnt(17)
    v_mfma_f32_16x16x32_bf16 v[16:19], a[192:195], v[92:95], v[16:19]
    v_mfma_f32_16x16x32_bf16 v[20:23], a[196:199], v[92:95], v[20:23]
    v_mfma_f32_16x16x32_bf16 v[24:27], a[200:203], v[92:95], v[24:27]
    s_waitcnt vmcnt(16)
    v_mfma_f32_16x16x32_bf16 v[16:19], a[204:207], v[96:99], v[16:19]
    v_mfma_f32_16x16x32_bf16 v[20:23], a[208:211], v[96:99], v[20:23]
    v_mfma_f32_16x16x32_bf16 v[24:27], a[212:215], v[96:99], v[24:27]
    s_waitcnt vmcnt(15)
    v_mfma_f32_16x16x32_bf16 v[16:19], a[216:219], v[100:103], v[16:19]
    v_mfma_f32_16x16x32_bf16 v[20:23], a[220:223], v[100:103], v[20:23]
    v_mfma_f32_16x16x32_bf16 v[24:27], a[224:227], v[100:103], v[24:27]
    s_waitcnt vmcnt(14)
    v_mfma_f32_16x16x32_bf16 v[16:19], a[228:231], v[104:107], v[16:19]
    v_mfma_f32_16x16x32_bf16 v[20:23], a[232:235], v[104:107], v[20:23]
    v_mfma_f32_16x16x32_bf16 v[24:27], a[236:239], v[104:107], v[24:27]
    s_waitcnt vmcnt(13)
    v_mfma_f32_16x16x32_bf16 v[16:19], a[240:243], v[108:111], v[16:19]
    v_mfma_f32_16x16x32_bf16 v[20:23], a[244:247], v[108:111], v[20:23]
    v_mfma_f32_16x16x32_bf16 v[24:27], a[248:251], v[108:111], v[24:27]
    s_waitcnt vmcnt(12)
    v_mfma_f32_16x16x32_bf16 v[16:19], a[252:255], v[112:115], v[16:19]
    v_mfma_f32_16x16x32_bf16 v[20:23], v[128:131], v[112:115], v[20:23]
    v_mfma_f32_16x16x32_bf16 v[24:27], v[132:135], v[112:115], v[24:27]
    s_waitcnt vmcnt(11)
    v_mfma_f32_16x16x32_bf16 v[16:19], v[136:139], v[116:119], v[16:19]
    v_mfma_f32_16x16x32_bf16 v[20:23], v[140:143], v[116:119], v[20:23]
    v_mfma_f32_16x16x32_bf16 v[24:27], v[144:147], v[116:119], v[24:27]
    s_waitcnt vmcnt(10)
    v_mfma_f32_16x16x32_bf16 v[16:19], v[148:151], v[120:123], v[16:19]
    v_mfma_f32_16x16x32_bf16 v[20:23], v[152:155], v[120:123], v[20:23]
    v_mfma_f32_16x16x32_bf16 v[24:27], v[156:159], v[120:123], v[24:27]
    s_waitcnt vmcnt(9)
    v_mfma_f32_16x16x32_bf16 v[16:19], v[160:163], v[124:127], v[16:19]
    v_mfma_f32_16x16x32_bf16 v[20:23], v[164:167], v[124:127], v[20:23]
    v_mfma_f32_16x16x32_bf16 v[24:27], v[168:171], v[124:127], v[24:27]
    s_waitcnt vmcnt(8)
    v_mfma_f32_16x16x32_bf16 v[16:19], v[172:175], v[28:31], v[16:19]
    v_mfma_f32_16x16x32_bf16 v[20:23], v[176:179], v[28:31], v[20:23]
    v_mfma_f32_16x16x32_bf16 v[24:27], v[180:183], v[28:31], v[24:27]
    s_waitcnt vmcnt(7)
    v_mfma_f32_16x16x32_bf16 v[16:19], v[184:187], v[32:35], v[16:19]
    v_mfma_f32_16x16x32_bf16 v[20:23], v[188:191], v[32:35], v[20:23]
    v_mfma_f32_16x16x32_bf16 v[24:27], v[192:195], v[32:35], v[24:27]
    s_waitcnt vmcnt(6)
    v_mfma_f32_16x16x32_bf16 v[16:19], v[196:199], v[36:39], v[16:19]
    v_mfma_f32_16x16x32_bf16 v[20:23], v[200:203], v[36:39], v[20:23]
    v_mfma_f32_16x16x32_bf16 v[24:27], v[204:207], v[36:39], v[24:27]
    s_waitcnt vmcnt(5)
    v_mfma_f32_16x16x32_bf16 v[16:19], v[208:211], v[40:43], v[16:19]
    v_mfma_f32_16x16x32_bf16 v[20:23], v[212:215], v[40:43], v[20:23]
    v_mfma_f32_16x16x32_bf16 v[24:27], v[216:219], v[40:43], v[24:27]
    s_waitcnt vmcnt(4)
    v_mfma_f32_16x16x32_bf16 v[16:19], v[220:223], v[44:47], v[16:19]
    v_mfma_f32_16x16x32_bf16 v[20:23], v[224:227], v[44:47], v[20:23]
    v_mfma_f32_16x16x32_bf16 v[24:27], v[228:231], v[44:47], v[24:27]
    s_waitcnt vmcnt(3)
    v_mfma_f32_16x16x32_bf16 v[16:19], v[232:235], v[48:51], v[16:19]
    v_mfma_f32_16x16x32_bf16 v[20:23], v[236:239], v[48:51], v[20:23]
    v_mfma_f32_16x16x32_bf16 v[24:27], v[240:243], v[48:51], v[24:27]
    s_waitcnt vmcnt(2)
    v_mfma_f32_16x16x32_bf16 v[16:19], v[244:247], v[52:55], v[16:19]
    v_mfma_f32_16x16x32_bf16 v[20:23], v[248:251], v[52:55], v[20:23]
    v_mfma_f32_16x16x32_bf16 v[24:27], v[252:255], v[52:55], v[24:27]
    ds_write_b128 v3, v[16:19] offset:0
    s_nop 2
    ds_write_b128 v3, v[20:23] offset:1024
    s_nop 2
    ds_write_b128 v3, v[24:27] offset:2048
    s_waitcnt vmcnt(0) lgkmcnt(0)
    s_barrier
    s_cmp_lg_u32 s5, 0
    s_cbranch_scc1 M_C_next
    ds_read_b128 v[28:31], v0 offset:3072
    ds_read_b128 v[32:35], v0 offset:4096
    ds_read_b128 v[36:39], v0 offset:5120
    ds_read_b128 v[40:43], v0 offset:6144
    ds_read_b128 v[44:47], v0 offset:7168
    ds_read_b128 v[48:51], v0 offset:8192
    ds_read_b128 v[52:55], v0 offset:9216
    ds_read_b128 v[56:59], v0 offset:10240
    ds_read_b128 v[60:63], v0 offset:11264
    s_waitcnt lgkmcnt(0)
    s_barrier
    v_pk_add_f32 v[16:17], v[16:17], v[28:29]
    v_pk_add_f32 v[40:41], v[40:41], v[52:53]
    v_lshlrev_b32 v14, 16, v8
    v_and_b32 v15, 0xffff0000, v8
    v_pk_add_f32 v[16:17], v[16:17], v[40:41]
    v_pk_add_f32 v[14:15], v[14:15], v[16:17]
    v_cvt_pk_bf16_f32 v8, v14, v15
    v_pk_add_f32 v[18:19], v[18:19], v[30:31]
    v_pk_add_f32 v[42:43], v[42:43], v[54:55]
    v_lshlrev_b32 v14, 16, v9
    v_and_b32 v15, 0xffff0000, v9
    v_pk_add_f32 v[18:19], v[18:19], v[42:43]
    v_pk_add_f32 v[14:15], v[14:15], v[18:19]
    v_cvt_pk_bf16_f32 v9, v14, v15
    v_pk_add_f32 v[20:21], v[20:21], v[32:33]
    v_pk_add_f32 v[44:45], v[44:45], v[56:57]
    v_lshlrev_b32 v14, 16, v10
    v_and_b32 v15, 0xffff0000, v10
    v_pk_add_f32 v[20:21], v[20:21], v[44:45]
    v_pk_add_f32 v[14:15], v[14:15], v[20:21]
    v_cvt_pk_bf16_f32 v10, v14, v15
    v_pk_add_f32 v[22:23], v[22:23], v[34:35]
    v_pk_add_f32 v[46:47], v[46:47], v[58:59]
    v_lshlrev_b32 v14, 16, v11
    v_and_b32 v15, 0xffff0000, v11
    v_pk_add_f32 v[22:23], v[22:23], v[46:47]
    v_pk_add_f32 v[14:15], v[14:15], v[22:23]
    v_cvt_pk_bf16_f32 v11, v14, v15
    v_pk_add_f32 v[24:25], v[24:25], v[36:37]
    v_pk_add_f32 v[48:49], v[48:49], v[60:61]
    v_lshlrev_b32 v14, 16, v12
    v_and_b32 v15, 0xffff0000, v12
    v_pk_add_f32 v[24:25], v[24:25], v[48:49]
    v_pk_add_f32 v[14:15], v[14:15], v[24:25]
    v_cvt_pk_bf16_f32 v12, v14, v15
    v_pk_add_f32 v[26:27], v[26:27], v[38:39]
    v_pk_add_f32 v[50:51], v[50:51], v[62:63]
    v_lshlrev_b32 v14, 16, v13
    v_and_b32 v15, 0xffff0000, v13
    v_pk_add_f32 v[26:27], v[26:27], v[50:51]
    v_pk_add_f32 v[14:15], v[14:15], v[26:27]
    v_cvt_pk_bf16_f32 v13, v14, v15
    s_add_u32 s13, s13, 83886080
    buffer_store_dwordx4 v[8:11], v2, s[20:23], s13 offen sc1
    buffer_store_dwordx2 v[12:13], v2, s[20:23], s13 offen offset:16 sc1
    s_lshl_b32 s11, s6, 10
    s_lshl_b32 s12, s39, 5
    s_add_u32 s11, s11, s12
    s_add_u32 s11, s11, 93847552
    s_waitcnt vmcnt(0)
    v_mov_b32 v14, 2
    s_mov_b64 exec, 1
    buffer_store_dword v14, off, s[20:23], s11 sc1
    s_mov_b64 exec, -1
p2_10b:
    s_branch M_C_nf
M_C_next:
    s_barrier
M_C_nf:
    s_cmp_ge_u32 s6, 52
    s_addc_u32 s6, s6, 2
    s_cmp_lt_u32 s6, 64
    s_cbranch_scc1 M_C_loop
    s_mov_b32 s41, 0
    s_branch M_L5
M_O:
    s_lshl_b32 s45, s44, 2
    s_add_u32 s45, s45, s5
    s_mov_b32 s50, 384
    s_mov_b32 s51, 0
    v_lshrrev_b32 v1, 4, v0
    v_and_b32 v2, 15, v0
    v_lshlrev_b32 v3, 4, v0
    v_mov_b32 v4, 0
    v_mov_b32 v5, 0
    v_mov_b32 v6, 0
    v_mov_b32 v7, 0
    v_mov_b32 v8, -1
    v_mov_b32 v9, -1
    v_mov_b32 v10, -1
    v_mov_b32 v11, -1
    s_mov_b32 s3, s45
fl_11:
    s_cmp_ge_u32 s3, 584
    s_cbranch_scc1 fl_11d
    s_lshl_b32 s6, s3, 10
    s_add_u32 s6, s6, 93323264
    buffer_store_dwordx4 v[4:7], v3, s[20:23], s6 offen sc1
    s_add_u32 s3, s3, s50
    s_branch fl_11
fl_11d:
    s_mov_b32 s3, s45
fl_12:
    s_cmp_ge_u32 s3, 288
    s_cbranch_scc1 fl_12d
    s_lshl_b32 s6, s3, 10
    s_add_u32 s6, s6, 207618048
    buffer_store_dwordx4 v[8:11], v3, s[20:23], s6 offen sc1
    s_add_u32 s3, s3, s50
    s_branch fl_12
fl_12d:
    s_mov_b32 s3, s45
fl_13:
    s_cmp_ge_u32 s3, 72
    s_cbranch_scc1 fl_13d
    s_lshl_b32 s6, s3, 10
    s_add_u32 s6, s6, 208666624
    buffer_store_dwordx4 v[8:11], v3, s[20:23], s6 offen sc1
    s_add_u32 s3, s3, s50
    s_branch fl_13
fl_13d:
    s_mov_b32 s3, s45
fl_14:
    s_cmp_ge_u32 s3, 584
    s_cbranch_scc1 fl_14d
    s_lshl_b32 s6, s3, 10
    s_add_u32 s6, s6, 193986560
    buffer_store_dwordx4 v[4:7], v3, s[20:23], s6 offen sc1
    s_add_u32 s3, s3, s50
    s_branch fl_14
fl_14d:
    s_cmp_lg_u32 s45, 100
    s_cbranch_scc1 M_O_nm
    s_load_dwordx2 s[8:9], s[0:1], 8
    v_lshrrev_b32 v12, 2, v2
    v_lshlrev_b32 v12, 1, v12
    v_and_b32 v13, 1, v0
    v_add_u32 v12, v12, v13
    v_mul_u32_u24 v17, 1152, v12
    v_bfe_u32 v12, v0, 1, 1
    v_lshl_add_u32 v18, v12, 6, v17
    v_lshl_add_u32 v18, v1, 3, v18
    v_lshl_add_u32 v17, v1, 5, v17
    v_lshl_add_u32 v17, v12, 2, v17
    s_mov_b32 s30, 0x05040100
    s_mov_b32 s31, 0x07060302
    s_waitcnt lgkmcnt(0)
    s_mov_b32 s80, s8
    s_and_b32 s81, s9, 0xffff
    s_mov_b32 s82, 9216
    s_mov_b32 s83, 0x00020000
    buffer_load_dwordx2 v[24:25], v18, s[80:83], 0 offen offset:0
    buffer_load_dwordx2 v[26:27], v18, s[80:83], 0 offen offset:32
    buffer_load_dwordx2 v[28:29], v18, s[80:83], 0 offen offset:128
    buffer_load_dwordx2 v[30:31], v18, s[80:83], 0 offen offset:160
    buffer_load_dwordx2 v[32:33], v18, s[80:83], 0 offen offset:256
    buffer_load_dwordx2 v[34:35], v18, s[80:83], 0 offen offset:288
    buffer_load_dwordx2 v[36:37], v18, s[80:83], 0 offen offset:384
    buffer_load_dwordx2 v[38:39], v18, s[80:83], 0 offen offset:416
    buffer_load_dwordx2 v[40:41], v18, s[80:83], 0 offen offset:512
    buffer_load_dwordx2 v[42:43], v18, s[80:83], 0 offen offset:544
    buffer_load_dwordx2 v[44:45], v18, s[80:83], 0 offen offset:640
    buffer_load_dwordx2 v[46:47], v18, s[80:83], 0 offen offset:672
    buffer_load_dwordx2 v[48:49], v18, s[80:83], 0 offen offset:768
    buffer_load_dwordx2 v[50:51], v18, s[80:83], 0 offen offset:800
    buffer_load_dwordx2 v[52:53], v18, s[80:83], 0 offen offset:896
    buffer_load_dwordx2 v[54:55], v18, s[80:83], 0 offen offset:928
    buffer_load_dword v56, v17, s[80:83], 0 offen offset:1024
    buffer_load_dword v57, v17, s[80:83], 0 offen offset:1032
    buffer_load_dword v58, v17, s[80:83], 0 offen offset:1040
    buffer_load_dword v59, v17, s[80:83], 0 offen offset:1048
    s_mov_b32 s9, 208740352
    s_waitcnt vmcnt(0)
    v_perm_b32 v60, v26, v24, s30
    v_perm_b32 v61, v26, v24, s31
    v_perm_b32 v62, v27, v25, s30
    v_perm_b32 v63, v27, v25, s31
    buffer_store_dwordx4 v[60:63], v3, s[20:23], s9 offen sc1
    s_add_u32 s9, s9, 1024
    s_nop 0
    v_perm_b32 v60, v30, v28, s30
    v_perm_b32 v61, v30, v28, s31
    v_perm_b32 v62, v31, v29, s30
    v_perm_b32 v63, v31, v29, s31
    buffer_store_dwordx4 v[60:63], v3, s[20:23], s9 offen sc1
    s_add_u32 s9, s9, 1024
    s_nop 0
    v_perm_b32 v60, v34, v32, s30
    v_perm_b32 v61, v34, v32, s31
    v_perm_b32 v62, v35, v33, s30
    v_perm_b32 v63, v35, v33, s31
    buffer_store_dwordx4 v[60:63], v3, s[20:23], s9 offen sc1
    s_add_u32 s9, s9, 1024
    s_nop 0
    v_perm_b32 v60, v38, v36, s30
    v_perm_b32 v61, v38, v36, s31
    v_perm_b32 v62, v39, v37, s30
    v_perm_b32 v63, v39, v37, s31
    buffer_store_dwordx4 v[60:63], v3, s[20:23], s9 offen sc1
    s_add_u32 s9, s9, 1024
    s_nop 0
    v_perm_b32 v60, v42, v40, s30
    v_perm_b32 v61, v42, v40, s31
    v_perm_b32 v62, v43, v41, s30
    v_perm_b32 v63, v43, v41, s31
    buffer_store_dwordx4 v[60:63], v3, s[20:23], s9 offen sc1
    s_add_u32 s9, s9, 1024
    s_nop 0
    v_perm_b32 v60, v46, v44, s30
    v_perm_b32 v61, v46, v44, s31
    v_perm_b32 v62, v47, v45, s30
    v_perm_b32 v63, v47, v45, s31
    buffer_store_dwordx4 v[60:63], v3, s[20:23], s9 offen sc1
    s_add_u32 s9, s9, 1024
    s_nop 0
    v_perm_b32 v60, v50, v48, s30
    v_perm_b32 v61, v50, v48, s31
    v_perm_b32 v62, v51, v49, s30
    v_perm_b32 v63, v51, v49, s31
    buffer_store_dwordx4 v[60:63], v3, s[20:23], s9 offen sc1
    s_add_u32 s9, s9, 1024
    s_nop 0
    v_perm_b32 v60, v54, v52, s30
    v_perm_b32 v61, v54, v52, s31
    v_perm_b32 v62, v55, v53, s30
    v_perm_b32 v63, v55, v53, s31
    buffer_store_dwordx4 v[60:63], v3, s[20:23], s9 offen sc1
    s_add_u32 s9, s9, 1024
    buffer_store_dwordx4 v[56:59], v3, s[20:23], s9 offen sc1
M_O_nm:
    s_load_dwordx4 s[12:15], s[0:1], 64
    s_waitcnt vmcnt(0) lgkmcnt(0)
    s_barrier
    s_cmp_lg_u32 s5, 0
    s_cbranch_scc1 M_O_t
    v_mov_b32 v12, 40
    v_mov_b32 v13, 1
    s_mov_b64 exec, 1
    global_atomic_add v12, v13, s[28:29]
    s_mov_b64 exec, -1
M_O_t:
    s_mov_b32 s56, s12
    s_and_b32 s57, s13, 0xffff
    s_mov_b32 s58, 1183744
    s_mov_b32 s59, 0x00020000
    s_mov_b32 s80, s14
    s_and_b32 s81, s15, 0xffff
    s_mov_b32 s82, 1183744
    s_mov_b32 s83, 0x00020000
    s_mov_b32 s3, s45
fl_15:
    s_cmp_ge_u32 s3, 2304
    s_cbranch_scc1 fl_15d
    s_lshl_b32 s6, s3, 10
    s_add_u32 s6, s6, 83886080
    buffer_store_dwordx4 v[8:11], v3, s[20:23], s6 offen sc1
    s_add_u32 s3, s3, s50
    s_branch fl_15
fl_15d:
    s_sub_u32 s46, s45, 384
P_end:
    s_mov_b64 exec, -1
    s_add_u32 s46, s46, s50
    s_mov_b32 s3, s46
    s_cmp_eq_u32 s51, 1
    s_cbranch_scc1 M_O_p2
    s_cmp_lt_u32 s3, 1296
    s_cbranch_scc1 P_T4
    s_waitcnt vmcnt(0)
    s_barrier
    s_cmp_lg_u32 s5, 0
    s_cbranch_scc1 M_O_c
    v_mov_b32 v12, 44
    v_mov_b32 v13, 1
    s_mov_b64 exec, 1
    global_atomic_add v12, v13, s[28:29]
    s_mov_b64 exec, -1
M_O_c:
    s_cmp_lt_u32 s44, 9
    s_cbranch_scc1 M_D
    s_mov_b32 s51, 1
    s_mov_b32 s50, 348
    s_sub_u32 s45, s45, 36
    s_mov_b32 s46, s45
    s_mov_b32 s3, s45
M_O_p2:
    s_cmp_lt_u32 s3, 640
    s_cbranch_scc1 P_T5
    s_cmp_lt_u32 s3, 696
    s_cbranch_scc1 P_T6
    v_lshlrev_b32 v3, 4, v0
    v_mov_b32 v8, -1
    v_mov_b32 v9, -1
    v_mov_b32 v10, -1
    v_mov_b32 v11, -1
    s_mov_b32 s3, s45
fl_16:
    s_cmp_ge_u32 s3, 2304
    s_cbranch_scc1 fl_16d
    s_lshl_b32 s6, s3, 10
    s_add_u32 s6, s6, 197132288
    buffer_store_dwordx4 v[8:11], v3, s[20:23], s6 offen sc1
    s_add_u32 s3, s3, s50
    s_branch fl_16
fl_16d:
    s_mov_b32 s3, s45
fl_17:
    s_cmp_ge_u32 s3, 2304
    s_cbranch_scc1 fl_17d
    s_lshl_b32 s6, s3, 10
    s_add_u32 s6, s6, 184549376
    buffer_store_dwordx4 v[8:11], v3, s[20:23], s6 offen sc1
    s_add_u32 s3, s3, s50
    s_branch fl_17
fl_17d:
    s_waitcnt vmcnt(0)
    s_barrier
    s_cmp_lg_u32 s5, 0
    s_cbranch_scc1 M_O_d
    v_mov_b32 v12, 48
    v_mov_b32 v13, 1
    s_mov_b64 exec, 1
    global_atomic_add v12, v13, s[28:29]
    s_mov_b64 exec, -1
M_O_d:
    s_cmp_lt_u32 s44, 21
    s_cbranch_scc1 M_E
    s_cmp_ge_u32 s44, 24
    s_cbranch_scc1 M_C
    s_add_u32 s40, s44, 51
    s_mov_b32 s41, 1
    s_branch M_L5
P_T4:
    s_sub_u32 s3, s3, 0
    s_cmp_ge_u32 s3, 648
    s_cselect_b32 s38, 1, 0
    s_cselect_b32 s39, 648, 0
    s_sub_u32 s3, s3, s39
    s_mul_hi_u32 s32, s3, 238609295
    s_mul_i32 s33, s32, 18
    s_sub_u32 s33, s3, s33
    s_lshl_b32 s34, s33, 5
    v_lshl_add_u32 v3, v1, 3, s34
    s_mov_b32 s40, 7456541
    s_mov_b32 s41, 0x3ae38e39
    s_cmp_eq_u32 s38, 1
    s_cbranch_scc1 P_T4i
    s_lshl_b32 s34, s32, 4
    v_add_u32 v4, s34, v2
    v_add_u32 v5, 0, v3
    v_cmp_eq_u32 vcc, 1, v4
    v_lshrrev_b32 v30, 1, v4
    v_and_b32 v31, 1, v4
    v_mul_u32_u24 v31, 144, v31
    v_mov_b32 v32, 288
    v_cndmask_b32 v30, v30, v32, vcc
    v_cndmask_b32 v31, v31, 0, vcc
    v_mad_u32_u24 v30, v30, v5, v31
    v_mul_hi_u32 v31, v30, s40
    v_mul_u32_u24 v31, 576, v31
    v_sub_u32 v30, v30, v31
    v_cvt_f32_u32 v30, v30
    v_mul_f32 v30, s41, v30
    v_cos_f32 v8, v30
    v_add_u32 v5, 1, v3
    v_cmp_eq_u32 vcc, 1, v4
    v_lshrrev_b32 v30, 1, v4
    v_and_b32 v31, 1, v4
    v_mul_u32_u24 v31, 144, v31
    v_mov_b32 v32, 288
    v_cndmask_b32 v30, v30, v32, vcc
    v_cndmask_b32 v31, v31, 0, vcc
    v_mad_u32_u24 v30, v30, v5, v31
    v_mul_hi_u32 v31, v30, s40
    v_mul_u32_u24 v31, 576, v31
    v_sub_u32 v30, v30, v31
    v_cvt_f32_u32 v30, v30
    v_mul_f32 v30, s41, v30
    v_cos_f32 v9, v30
    v_add_u32 v5, 2, v3
    v_cmp_eq_u32 vcc, 1, v4
    v_lshrrev_b32 v30, 1, v4
    v_and_b32 v31, 1, v4
    v_mul_u32_u24 v31, 144, v31
    v_mov_b32 v32, 288
    v_cndmask_b32 v30, v30, v32, vcc
    v_cndmask_b32 v31, v31, 0, vcc
    v_mad_u32_u24 v30, v30, v5, v31
    v_mul_hi_u32 v31, v30, s40
    v_mul_u32_u24 v31, 576, v31
    v_sub_u32 v30, v30, v31
    v_cvt_f32_u32 v30, v30
    v_mul_f32 v30, s41, v30
    v_cos_f32 v10, v30
    v_add_u32 v5, 3, v3
    v_cmp_eq_u32 vcc, 1, v4
    v_lshrrev_b32 v30, 1, v4
    v_and_b32 v31, 1, v4
    v_mul_u32_u24 v31, 144, v31
    v_mov_b32 v32, 288
    v_cndmask_b32 v30, v30, v32, vcc
    v_cndmask_b32 v31, v31, 0, vcc
    v_mad_u32_u24 v30, v30, v5, v31
    v_mul_hi_u32 v31, v30, s40
    v_mul_u32_u24 v31, 576, v31
    v_sub_u32 v30, v30, v31
    v_cvt_f32_u32 v30, v30
    v_mul_f32 v30, s41, v30
    v_cos_f32 v11, v30
    v_add_u32 v5, 4, v3
    v_cmp_eq_u32 vcc, 1, v4
    v_lshrrev_b32 v30, 1, v4
    v_and_b32 v31, 1, v4
    v_mul_u32_u24 v31, 144, v31
    v_mov_b32 v32, 288
    v_cndmask_b32 v30, v30, v32, vcc
    v_cndmask_b32 v31, v31, 0, vcc
    v_mad_u32_u24 v30, v30, v5, v31
    v_mul_hi_u32 v31, v30, s40
    v_mul_u32_u24 v31, 576, v31
    v_sub_u32 v30, v30, v31
    v_cvt_f32_u32 v30, v30
    v_mul_f32 v30, s41, v30
    v_cos_f32 v12, v30
    v_add_u32 v5, 5, v3
    v_cmp_eq_u32 vcc, 1, v4
    v_lshrrev_b32 v30, 1, v4
    v_and_b32 v31, 1, v4
    v_mul_u32_u24 v31, 144, v31
    v_mov_b32 v32, 288
    v_cndmask_b32 v30, v30, v32, vcc
    v_cndmask_b32 v31, v31, 0, vcc
    v_mad_u32_u24 v30, v30, v5, v31
    v_mul_hi_u32 v31, v30, s40
    v_mul_u32_u24 v31, 576, v31
    v_sub_u32 v30, v30, v31
    v_cvt_f32_u32 v30, v30
    v_mul_f32 v30, s41, v30
    v_cos_f32 v13, v30
    v_add_u32 v5, 6, v3
    v_cmp_eq_u32 vcc, 1, v4
    v_lshrrev_b32 v30, 1, v4
    v_and_b32 v31, 1, v4
    v_mul_u32_u24 v31, 144, v31
    v_mov_b32 v32, 288
    v_cndmask_b32 v30, v30, v32, vcc
    v_cndmask_b32 v31, v31, 0, vcc
    v_mad_u32_u24 v30, v30, v5, v31
    v_mul_hi_u32 v31, v30, s40
    v_mul_u32_u24 v31, 576, v31
    v_sub_u32 v30, v30, v31
    v_cvt_f32_u32 v30, v30
    v_mul_f32 v30, s41, v30
    v_cos_f32 v14, v30
    v_add_u32 v5, 7, v3
    v_cmp_eq_u32 vcc, 1, v4
    v_lshrrev_b32 v30, 1, v4
    v_and_b32 v31, 1, v4
    v_mul_u32_u24 v31, 144, v31
    v_mov_b32 v32, 288
    v_cndmask_b32 v30, v30, v32, vcc
    v_cndmask_b32 v31, v31, 0, vcc
    v_mad_u32_u24 v30, v30, v5, v31
    v_mul_hi_u32 v31, v30, s40
    v_mul_u32_u24 v31, 576, v31
    v_sub_u32 v30, v30, v31
    v_cvt_f32_u32 v30, v30
    v_mul_f32 v30, s41, v30
    v_cos_f32 v15, v30
    s_mov_b32 s35, 201326592
    s_branch P_T4s
P_T4i:
    s_mul_hi_u32 s36, s32, 1431655766
    s_mul_i32 s37, s36, 3
    s_sub_u32 s37, s32, s37
    s_mul_i32 s36, s36, 48
    s_lshl_b32 s37, s37, 2
    s_add_u32 s36, s36, s37
    v_lshrrev_b32 v4, 2, v2
    v_mul_u32_u24 v4, 12, v4
    v_and_b32 v5, 3, v2
    v_add3_u32 v4, v4, v5, s36
    v_mov_b32 v34, 288
    v_add_u32 v5, 0, v3
    v_cmp_eq_u32 vcc, 1, v5
    v_lshrrev_b32 v30, 1, v5
    v_and_b32 v31, 1, v5
    v_mul_u32_u24 v31, 144, v31
    v_mov_b32 v32, 288
    v_cndmask_b32 v30, v30, v32, vcc
    v_cndmask_b32 v31, v31, 0, vcc
    v_mad_u32_u24 v30, v30, v4, v31
    v_mul_hi_u32 v31, v30, s40
    v_mul_u32_u24 v31, 576, v31
    v_sub_u32 v30, v30, v31
    v_cvt_f32_u32 v30, v30
    v_mul_f32 v30, s41, v30
    v_cos_f32 v8, v30
    v_cmp_gt_u32 vcc, 2, v5
    v_add_f32 v31, v8, v8
    s_nop 0
    v_cndmask_b32 v8, v31, v8, vcc
    v_add_u32 v5, 1, v3
    v_cmp_eq_u32 vcc, 1, v5
    v_lshrrev_b32 v30, 1, v5
    v_and_b32 v31, 1, v5
    v_mul_u32_u24 v31, 144, v31
    v_mov_b32 v32, 288
    v_cndmask_b32 v30, v30, v32, vcc
    v_cndmask_b32 v31, v31, 0, vcc
    v_mad_u32_u24 v30, v30, v4, v31
    v_mul_hi_u32 v31, v30, s40
    v_mul_u32_u24 v31, 576, v31
    v_sub_u32 v30, v30, v31
    v_cvt_f32_u32 v30, v30
    v_mul_f32 v30, s41, v30
    v_cos_f32 v9, v30
    v_cmp_gt_u32 vcc, 2, v5
    v_add_f32 v31, v9, v9
    s_nop 0
    v_cndmask_b32 v9, v31, v9, vcc
    v_add_u32 v5, 2, v3
    v_cmp_eq_u32 vcc, 1, v5
    v_lshrrev_b32 v30, 1, v5
    v_and_b32 v31, 1, v5
    v_mul_u32_u24 v31, 144, v31
    v_mov_b32 v32, 288
    v_cndmask_b32 v30, v30, v32, vcc
    v_cndmask_b32 v31, v31, 0, vcc
    v_mad_u32_u24 v30, v30, v4, v31
    v_mul_hi_u32 v31, v30, s40
    v_mul_u32_u24 v31, 576, v31
    v_sub_u32 v30, v30, v31
    v_cvt_f32_u32 v30, v30
    v_mul_f32 v30, s41, v30
    v_cos_f32 v10, v30
    v_cmp_gt_u32 vcc, 2, v5
    v_add_f32 v31, v10, v10
    s_nop 0
    v_cndmask_b32 v10, v31, v10, vcc
    v_add_u32 v5, 3, v3
    v_cmp_eq_u32 vcc, 1, v5
    v_lshrrev_b32 v30, 1, v5
    v_and_b32 v31, 1, v5
    v_mul_u32_u24 v31, 144, v31
    v_mov_b32 v32, 288
    v_cndmask_b32 v30, v30, v32, vcc
    v_cndmask_b32 v31, v31, 0, vcc
    v_mad_u32_u24 v30, v30, v4, v31
    v_mul_hi_u32 v31, v30, s40
    v_mul_u32_u24 v31, 576, v31
    v_sub_u32 v30, v30, v31
    v_cvt_f32_u32 v30, v30
    v_mul_f32 v30, s41, v30
    v_cos_f32 v11, v30
    v_cmp_gt_u32 vcc, 2, v5
    v_add_f32 v31, v11, v11
    s_nop 0
    v_cndmask_b32 v11, v31, v11, vcc
    v_add_u32 v5, 4, v3
    v_cmp_eq_u32 vcc, 1, v5
    v_lshrrev_b32 v30, 1, v5
    v_and_b32 v31, 1, v5
    v_mul_u32_u24 v31, 144, v31
    v_mov_b32 v32, 288
    v_cndmask_b32 v30, v30, v32, vcc
    v_cndmask_b32 v31, v31, 0, vcc
    v_mad_u32_u24 v30, v30, v4, v31
    v_mul_hi_u32 v31, v30, s40
    v_mul_u32_u24 v31, 576, v31
    v_sub_u32 v30, v30, v31
    v_cvt_f32_u32 v30, v30
    v_mul_f32 v30, s41, v30
    v_cos_f32 v12, v30
    v_cmp_gt_u32 vcc, 2, v5
    v_add_f32 v31, v12, v12
    s_nop 0
    v_cndmask_b32 v12, v31, v12, vcc
    v_add_u32 v5, 5, v3
    v_cmp_eq_u32 vcc, 1, v5
    v_lshrrev_b32 v30, 1, v5
    v_and_b32 v31, 1, v5
    v_mul_u32_u24 v31, 144, v31
    v_mov_b32 v32, 288
    v_cndmask_b32 v30, v30, v32, vcc
    v_cndmask_b32 v31, v31, 0, vcc
    v_mad_u32_u24 v30, v30, v4, v31
    v_mul_hi_u32 v31, v30, s40
    v_mul_u32_u24 v31, 576, v31
    v_sub_u32 v30, v30, v31
    v_cvt_f32_u32 v30, v30
    v_mul_f32 v30, s41, v30
    v_cos_f32 v13, v30
    v_cmp_gt_u32 vcc, 2, v5
    v_add_f32 v31, v13, v13
    s_nop 0
    v_cndmask_b32 v13, v31, v13, vcc
    v_add_u32 v5, 6, v3
    v_cmp_eq_u32 vcc, 1, v5
    v_lshrrev_b32 v30, 1, v5
    v_and_b32 v31, 1, v5
    v_mul_u32_u24 v31, 144, v31
    v_mov_b32 v32, 288
    v_cndmask_b32 v30, v30, v32, vcc
    v_cndmask_b32 v31, v31, 0, vcc
    v_mad_u32_u24 v30, v30, v4, v31
    v_mul_hi_u32 v31, v30, s40
    v_mul_u32_u24 v31, 576, v31
    v_sub_u32 v30, v30, v31
    v_cvt_f32_u32 v30, v30
    v_mul_f32 v30, s41, v30
    v_cos_f32 v14, v30
    v_cmp_gt_u32 vcc, 2, v5
    v_add_f32 v31, v14, v14
    s_nop 0
    v_cndmask_b32 v14, v31, v14, vcc
    v_add_u32 v5, 7, v3
    v_cmp_eq_u32 vcc, 1, v5
    v_lshrrev_b32 v30, 1, v5
    v_and_b32 v31, 1, v5
    v_mul_u32_u24 v31, 144, v31
    v_mov_b32 v32, 288
    v_cndmask_b32 v30, v30, v32, vcc
    v_cndmask_b32 v31, v31, 0, vcc
    v_mad_u32_u24 v30, v30, v4, v31
    v_mul_hi_u32 v31, v30, s40
    v_mul_u32_u24 v31, 576, v31
    v_sub_u32 v30, v30, v31
    v_cvt_f32_u32 v30, v30
    v_mul_f32 v30, s41, v30
    v_cos_f32 v15, v30
    v_cmp_gt_u32 vcc, 2, v5
    v_add_f32 v31, v15, v15
    s_nop 0
    v_cndmask_b32 v15, v31, v15, vcc
    s_mov_b32 s35, 202375168
P_T4s:
    s_nop 1
    v_cvt_pk_bf16_f32 v20, v8, v9
    v_cvt_pk_bf16_f32 v21, v10, v11
    v_cvt_pk_bf16_f32 v22, v12, v13
    v_cvt_pk_bf16_f32 v23, v14, v15
    s_lshl_b32 s3, s3, 10
    s_add_u32 s35, s35, s3
    v_lshlrev_b32 v4, 4, v0
    buffer_store_dwordx4 v[20:23], v4, s[20:23], s35 offen sc1
    s_branch P_end
P_T5:
    s_lshr_b32 s32, s3, 7
    s_lshr_b32 s33, s3, 6
    s_and_b32 s33, s33, 1
    s_lshr_b32 s34, s3, 3
    s_and_b32 s34, s34, 7
    s_and_b32 s35, s3, 7
    s_lshl_b32 s36, s32, 6
    v_add_u32 v3, s36, v0
    v_lshlrev_b32 v4, 1, v3
    s_lshl_b32 s36, s33, 5
    s_lshl_b32 s37, s34, 2
    s_add_u32 s36, s36, s37
    s_lshl_b32 s36, s36, 5
    s_lshl_b32 s37, s35, 2
    s_add_u32 s36, s36, s37
    s_mul_i32 s36, s36, 578
    buffer_load_ushort v8, v4, s[56:59], s36 offen offset:0
    buffer_load_ushort v24, v4, s[80:83], s36 offen offset:0
    buffer_load_ushort v12, v4, s[56:59], s36 offen offset:578
    buffer_load_ushort v28, v4, s[80:83], s36 offen offset:578
    buffer_load_ushort v16, v4, s[56:59], s36 offen offset:1156
    buffer_load_ushort v32, v4, s[80:83], s36 offen offset:1156
    buffer_load_ushort v20, v4, s[56:59], s36 offen offset:1734
    buffer_load_ushort v36, v4, s[80:83], s36 offen offset:1734
    s_add_u32 s36, s36, 18496
    buffer_load_ushort v9, v4, s[56:59], s36 offen offset:0
    buffer_load_ushort v25, v4, s[80:83], s36 offen offset:0
    buffer_load_ushort v13, v4, s[56:59], s36 offen offset:578
    buffer_load_ushort v29, v4, s[80:83], s36 offen offset:578
    buffer_load_ushort v17, v4, s[56:59], s36 offen offset:1156
    buffer_load_ushort v33, v4, s[80:83], s36 offen offset:1156
    buffer_load_ushort v21, v4, s[56:59], s36 offen offset:1734
    buffer_load_ushort v37, v4, s[80:83], s36 offen offset:1734
    s_add_u32 s36, s36, 18496
    buffer_load_ushort v10, v4, s[56:59], s36 offen offset:0
    buffer_load_ushort v26, v4, s[80:83], s36 offen offset:0
    buffer_load_ushort v14, v4, s[56:59], s36 offen offset:578
    buffer_load_ushort v30, v4, s[80:83], s36 offen offset:578
    buffer_load_ushort v18, v4, s[56:59], s36 offen offset:1156
    buffer_load_ushort v34, v4, s[80:83], s36 offen offset:1156
    buffer_load_ushort v22, v4, s[56:59], s36 offen offset:1734
    buffer_load_ushort v38, v4, s[80:83], s36 offen offset:1734
    s_add_u32 s36, s36, 18496
    buffer_load_ushort v11, v4, s[56:59], s36 offen offset:0
    buffer_load_ushort v27, v4, s[80:83], s36 offen offset:0
    buffer_load_ushort v15, v4, s[56:59], s36 offen offset:578
    buffer_load_ushort v31, v4, s[80:83], s36 offen offset:578
    buffer_load_ushort v19, v4, s[56:59], s36 offen offset:1156
    buffer_load_ushort v35, v4, s[80:83], s36 offen offset:1156
    buffer_load_ushort v23, v4, s[56:59], s36 offen offset:1734
    buffer_load_ushort v39, v4, s[80:83], s36 offen offset:1734
    v_lshlrev_b32 v5, 13, v3
    s_lshl_b32 s36, s34, 10
    s_lshl_b32 s37, s33, 9
    s_add_u32 s36, s36, s37
    s_lshl_b32 s37, s35, 6
    s_add_u32 s36, s36, s37
    s_add_u32 s36, s36, 203423744
    v_cmp_gt_u32 vcc, 289, v3
    s_and_saveexec_b64 s[48:49], vcc
    s_waitcnt vmcnt(0)
    v_lshl_or_b32 v8, v24, 16, v8
    v_lshl_or_b32 v9, v25, 16, v9
    v_lshl_or_b32 v10, v26, 16, v10
    v_lshl_or_b32 v11, v27, 16, v11
    v_lshl_or_b32 v12, v28, 16, v12
    v_lshl_or_b32 v13, v29, 16, v13
    v_lshl_or_b32 v14, v30, 16, v14
    v_lshl_or_b32 v15, v31, 16, v15
    v_lshl_or_b32 v16, v32, 16, v16
    v_lshl_or_b32 v17, v33, 16, v17
    v_lshl_or_b32 v18, v34, 16, v18
    v_lshl_or_b32 v19, v35, 16, v19
    v_lshl_or_b32 v20, v36, 16, v20
    v_lshl_or_b32 v21, v37, 16, v21
    v_lshl_or_b32 v22, v38, 16, v22
    v_lshl_or_b32 v23, v39, 16, v23
    buffer_store_dwordx4 v[8:11], v5, s[20:23], s36 offen offset:0 sc1
    buffer_store_dwordx4 v[12:15], v5, s[20:23], s36 offen offset:16 sc1
    buffer_store_dwordx4 v[16:19], v5, s[20:23], s36 offen offset:32 sc1
    buffer_store_dwordx4 v[20:23], v5, s[20:23], s36 offen offset:48 sc1
    s_branch P_end
P_T6:
    s_sub_u32 s3, s3, 640
    v_and_b32 v3, 31, v0
    v_lshrrev_b32 v4, 5, v0
    v_bfe_u32 v5, v3, 2, 1
    v_lshlrev_b32 v5, 5, v5
    v_lshrrev_b32 v6, 3, v3
    v_lshl_add_u32 v5, v6, 2, v5
    v_and_b32 v6, 3, v3
    v_add_u32 v5, v5, v6
    s_mov_b32 s41, 0x3a000000
    v_lshlrev_b32 v7, 4, v0
    s_cmp_ge_u32 s3, 54
    s_cbranch_scc1 P_end
    s_cmp_ge_u32 s3, 32
    s_cbranch_scc1 P_T6c
    s_cmp_ge_u32 s3, 16
    s_cbranch_scc1 P_T6b
    s_lshl_b32 s32, s3, 1
    v_lshl_add_u32 v8, v4, 5, s32
    v_mul_u32_u24 v9, v8, v3
    v_add_u32 v10, v9, v3
    v_add_u32 v30, 0, v9
    v_and_b32 v30, 0x7ff, v30
    v_cvt_f32_u32 v30, v30
    v_mul_f32 v30, s41, v30
    v_cos_f32 v12, v30
    v_add_u32 v30, 0, v10
    v_and_b32 v30, 0x7ff, v30
    v_cvt_f32_u32 v30, v30
    v_mul_f32 v30, s41, v30
    v_cos_f32 v13, v30
    v_add_u32 v30, 1536, v9
    v_and_b32 v30, 0x7ff, v30
    v_cvt_f32_u32 v30, v30
    v_mul_f32 v30, s41, v30
    v_cos_f32 v14, v30
    v_add_u32 v30, 1536, v10
    v_and_b32 v30, 0x7ff, v30
    v_cvt_f32_u32 v30, v30
    v_mul_f32 v30, s41, v30
    v_cos_f32 v15, v30
    s_lshl_b32 s3, s3, 10
    s_add_u32 s3, s3, 206569472
    s_nop 0
    buffer_store_dwordx4 v[12:15], v7, s[20:23], s3 offen sc1
    s_branch P_end
P_T6b:
    s_sub_u32 s3, s3, 16
    s_lshr_b32 s32, s3, 3
    s_lshl_b32 s32, s32, 4
    v_add_u32 v8, s32, v5
    s_and_b32 s33, s3, 1
    s_lshl_b32 s33, s33, 1
    s_bfe_u32 s34, s3, 0x20001
    s_lshl_b32 s34, s34, 3
    s_add_u32 s33, s33, s34
    v_lshl_add_u32 v11, v4, 2, s33
    v_mul_u32_u24 v9, v8, v11
    v_add_u32 v10, v9, v8
    v_add_u32 v30, 0, v9
    v_and_b32 v30, 0x7ff, v30
    v_cvt_f32_u32 v30, v30
    v_mul_f32 v30, s41, v30
    v_cos_f32 v12, v30
    v_add_u32 v30, 0, v10
    v_and_b32 v30, 0x7ff, v30
    v_cvt_f32_u32 v30, v30
    v_mul_f32 v30, s41, v30
    v_cos_f32 v13, v30
    v_add_u32 v30, 1536, v9
    v_and_b32 v30, 0x7ff, v30
    v_cvt_f32_u32 v30, v30
    v_mul_f32 v30, s41, v30
    v_cos_f32 v14, v30
    v_add_u32 v30, 1536, v10
    v_and_b32 v30, 0x7ff, v30
    v_cvt_f32_u32 v30, v30
    v_mul_f32 v30, s41, v30
    v_cos_f32 v15, v30
    s_mov_b32 s35, 0x35638e39
    s_nop 0
    v_mul_f32 v12, s35, v12
    v_mul_f32 v13, s35, v13
    v_mul_f32 v14, s35, v14
    v_mul_f32 v15, s35, v15
    s_lshl_b32 s3, s3, 10
    s_add_u32 s3, s3, 206585856
    buffer_store_dwordx4 v[12:15], v7, s[20:23], s3 offen sc1
    s_branch P_end
P_T6c:
    s_sub_u32 s3, s3, 32
    s_cmp_ge_u32 s3, 6
    s_cbranch_scc1 P_T6d
    s_lshr_b32 s32, s3, 1
    s_mov_b32 s36, 0
    s_cmp_eq_u32 s32, 1
    s_cselect_b32 s36, 1536, s36
    s_cmp_eq_u32 s32, 2
    s_cselect_b32 s36, 512, s36
    s_and_b32 s33, s3, 1
    s_lshl_b32 s33, s33, 4
    v_lshl_add_u32 v8, v4, 2, s33
    v_lshlrev_b32 v9, 6, v3
    v_add_u32 v10, 0, v8
    v_mul_u32_u24 v10, v10, v9
    v_add_u32 v30, s36, v10
    v_and_b32 v30, 0x7ff, v30
    v_cvt_f32_u32 v30, v30
    v_mul_f32 v30, s41, v30
    v_cos_f32 v12, v30
    v_add_u32 v10, 1, v8
    v_mul_u32_u24 v10, v10, v9
    v_add_u32 v30, s36, v10
    v_and_b32 v30, 0x7ff, v30
    v_cvt_f32_u32 v30, v30
    v_mul_f32 v30, s41, v30
    v_cos_f32 v13, v30
    v_add_u32 v10, 2, v8
    v_mul_u32_u24 v10, v10, v9
    v_add_u32 v30, s36, v10
    v_and_b32 v30, 0x7ff, v30
    v_cvt_f32_u32 v30, v30
    v_mul_f32 v30, s41, v30
    v_cos_f32 v14, v30
    v_add_u32 v10, 3, v8
    v_mul_u32_u24 v10, v10, v9
    v_add_u32 v30, s36, v10
    v_and_b32 v30, 0x7ff, v30
    v_cvt_f32_u32 v30, v30
    v_mul_f32 v30, s41, v30
    v_cos_f32 v15, v30
    v_add_u32 v10, 8, v8
    v_mul_u32_u24 v10, v10, v9
    v_add_u32 v30, s36, v10
    v_and_b32 v30, 0x7ff, v30
    v_cvt_f32_u32 v30, v30
    v_mul_f32 v30, s41, v30
    v_cos_f32 v16, v30
    v_add_u32 v10, 9, v8
    v_mul_u32_u24 v10, v10, v9
    v_add_u32 v30, s36, v10
    v_and_b32 v30, 0x7ff, v30
    v_cvt_f32_u32 v30, v30
    v_mul_f32 v30, s41, v30
    v_cos_f32 v17, v30
    v_add_u32 v10, 10, v8
    v_mul_u32_u24 v10, v10, v9
    v_add_u32 v30, s36, v10
    v_and_b32 v30, 0x7ff, v30
    v_cvt_f32_u32 v30, v30
    v_mul_f32 v30, s41, v30
    v_cos_f32 v18, v30
    v_add_u32 v10, 11, v8
    v_mul_u32_u24 v10, v10, v9
    v_add_u32 v30, s36, v10
    v_and_b32 v30, 0x7ff, v30
    v_cvt_f32_u32 v30, v30
    v_mul_f32 v30, s41, v30
    v_cos_f32 v19, v30
    s_branch P_T6s
P_T6d:
    s_sub_u32 s32, s3, 6
    s_cmp_ge_u32 s32, 8
    s_cselect_b32 s36, 1536, 0
    s_bfe_u32 s33, s32, 0x10002
    s_lshl_b32 s33, s33, 4
    v_add_u32 v9, s33, v5
    v_lshlrev_b32 v9, 5, v9
    s_and_b32 s34, s32, 3
    s_lshl_b32 s34, s34, 3
    v_lshl_add_u32 v8, v4, 5, s34
    v_add_u32 v10, 0, v8
    v_mul_u32_u24 v10, v10, v9
    v_add_u32 v30, s36, v10
    v_and_b32 v30, 0x7ff, v30
    v_cvt_f32_u32 v30, v30
    v_mul_f32 v30, s41, v30
    v_cos_f32 v12, v30
    v_add_u32 v10, 1, v8
    v_mul_u32_u24 v10, v10, v9
    v_add_u32 v30, s36, v10
    v_and_b32 v30, 0x7ff, v30
    v_cvt_f32_u32 v30, v30
    v_mul_f32 v30, s41, v30
    v_cos_f32 v13, v30
    v_add_u32 v10, 2, v8
    v_mul_u32_u24 v10, v10, v9
    v_add_u32 v30, s36, v10
    v_and_b32 v30, 0x7ff, v30
    v_cvt_f32_u32 v30, v30
    v_mul_f32 v30, s41, v30
    v_cos_f32 v14, v30
    v_add_u32 v10, 3, v8
    v_mul_u32_u24 v10, v10, v9
    v_add_u32 v30, s36, v10
    v_and_b32 v30, 0x7ff, v30
    v_cvt_f32_u32 v30, v30
    v_mul_f32 v30, s41, v30
    v_cos_f32 v15, v30
    v_add_u32 v10, 4, v8
    v_mul_u32_u24 v10, v10, v9
    v_add_u32 v30, s36, v10
    v_and_b32 v30, 0x7ff, v30
    v_cvt_f32_u32 v30, v30
    v_mul_f32 v30, s41, v30
    v_cos_f32 v16, v30
    v_add_u32 v10, 5, v8
    v_mul_u32_u24 v10, v10, v9
    v_add_u32 v30, s36, v10
    v_and_b32 v30, 0x7ff, v30
    v_cvt_f32_u32 v30, v30
    v_mul_f32 v30, s41, v30
    v_cos_f32 v17, v30
    v_add_u32 v10, 6, v8
    v_mul_u32_u24 v10, v10, v9
    v_add_u32 v30, s36, v10
    v_and_b32 v30, 0x7ff, v30
    v_cvt_f32_u32 v30, v30
    v_mul_f32 v30, s41, v30
    v_cos_f32 v18, v30
    v_add_u32 v10, 7, v8
    v_mul_u32_u24 v10, v10, v9
    v_add_u32 v30, s36, v10
    v_and_b32 v30, 0x7ff, v30
    v_cvt_f32_u32 v30, v30
    v_mul_f32 v30, s41, v30
    v_cos_f32 v19, v30
P_T6s:
    s_nop 1
    v_cvt_pk_bf16_f32 v20, v12, v13
    v_cvt_pk_bf16_f32 v21, v14, v15
    v_cvt_pk_bf16_f32 v22, v16, v17
    v_cvt_pk_bf16_f32 v23, v18, v19
    s_lshl_b32 s3, s3, 10
    s_add_u32 s3, s3, 206602240
    buffer_store_dwordx4 v[20:23], v7, s[20:23], s3 offen sc1
    s_branch P_end
M_D:
    v_mbcnt_lo_u32_b32 v0, -1, 0
    v_mbcnt_hi_u32_b32 v0, -1, v0
    s_mul_hi_u32 s3, s44, 1431655766
    s_mul_i32 s43, s3, 3
    s_sub_u32 s43, s44, s43
    v_mov_b32 v1, s5
    v_lshrrev_b32 v4, 3, v0
    v_lshl_add_u32 v2, v1, 3, v4
    v_mul_u32_u24 v2, 1152, v2
    v_and_b32 v5, 7, v0
    v_lshl_add_u32 v2, v5, 4, v2
    v_lshrrev_b32 v3, 2, v4
    v_mul_u32_u24 v3, 19584, v3
    v_mul_u32_u24 v5, 272, v5
    v_add_u32 v3, v3, v5
    v_and_b32 v4, 3, v4
    v_lshl_add_u32 v4, v1, 2, v4
    v_lshl_add_u32 v3, v4, 4, v3
    v_lshlrev_b32 v6, 4, v0
    v_bfe_u32 v7, v0, 1, 3
    v_lshlrev_b32 v7, 13, v7
    v_and_b32 v8, 1, v0
    v_lshl_add_u32 v7, v8, 6, v7
    v_lshrrev_b32 v8, 4, v0
    v_lshl_add_u32 v7, v8, 4, v7
    v_lshl_add_u32 v10, v8, 4, v6
    s_mov_b32 s40, s3
    v_mov_b32 v8, 44
wd_18:
    global_load_dword v9, v8, s[28:29] sc1
    s_waitcnt vmcnt(0)
    v_readfirstlane_b32 s9, v9
    s_cmp_ge_u32 s9, 96
    s_cbranch_scc1 wd_18d
    s_sleep 4
    s_sub_u32 s94, s94, 1
    s_cbranch_scc0 wd_18
    s_mov_b32 s94, 0
wd_18d:
    s_lshl_b32 s7, s43, 2
    s_add_u32 s7, s7, s5
    s_mul_i32 s10, s7, 55296
    s_add_u32 s10, s10, 201326592
    s_add_u32 s11, s10, 18432
    s_add_u32 s12, s10, 36864
    buffer_load_dwordx4 a[0:3], v6, s[84:87], s10 offen offset:0 sc1
    buffer_load_dwordx4 a[4:7], v6, s[84:87], s11 offen offset:0 sc1
    buffer_load_dwordx4 a[8:11], v6, s[84:87], s12 offen offset:0 sc1
    buffer_load_dwordx4 a[12:15], v6, s[84:87], s10 offen offset:1024 sc1
    buffer_load_dwordx4 a[16:19], v6, s[84:87], s11 offen offset:1024 sc1
    buffer_load_dwordx4 a[20:23], v6, s[84:87], s12 offen offset:1024 sc1
    buffer_load_dwordx4 a[24:27], v6, s[84:87], s10 offen offset:2048 sc1
    buffer_load_dwordx4 a[28:31], v6, s[84:87], s11 offen offset:2048 sc1
    buffer_load_dwordx4 a[32:35], v6, s[84:87], s12 offen offset:2048 sc1
    buffer_load_dwordx4 a[36:39], v6, s[84:87], s10 offen offset:3072 sc1
    buffer_load_dwordx4 a[40:43], v6, s[84:87], s11 offen offset:3072 sc1
    buffer_load_dwordx4 a[44:47], v6, s[84:87], s12 offen offset:3072 sc1
    s_add_u32 s10, s10, 4096
    s_add_u32 s11, s11, 4096
    s_add_u32 s12, s12, 4096
    buffer_load_dwordx4 a[48:51], v6, s[84:87], s10 offen offset:0 sc1
    buffer_load_dwordx4 a[52:55], v6, s[84:87], s11 offen offset:0 sc1
    buffer_load_dwordx4 a[56:59], v6, s[84:87], s12 offen offset:0 sc1
    buffer_load_dwordx4 a[60:63], v6, s[84:87], s10 offen offset:1024 sc1
    buffer_load_dwordx4 a[64:67], v6, s[84:87], s11 offen offset:1024 sc1
    buffer_load_dwordx4 a[68:71], v6, s[84:87], s12 offen offset:1024 sc1
    buffer_load_dwordx4 a[72:75], v6, s[84:87], s10 offen offset:2048 sc1
    buffer_load_dwordx4 a[76:79], v6, s[84:87], s11 offen offset:2048 sc1
    buffer_load_dwordx4 a[80:83], v6, s[84:87], s12 offen offset:2048 sc1
    buffer_load_dwordx4 a[84:87], v6, s[84:87], s10 offen offset:3072 sc1
    buffer_load_dwordx4 a[88:91], v6, s[84:87], s11 offen offset:3072 sc1
    buffer_load_dwordx4 a[92:95], v6, s[84:87], s12 offen offset:3072 sc1
    s_add_u32 s10, s10, 4096
    s_add_u32 s11, s11, 4096
    s_add_u32 s12, s12, 4096
    buffer_load_dwordx4 a[96:99], v6, s[84:87], s10 offen offset:0 sc1
    buffer_load_dwordx4 a[100:103], v6, s[84:87], s11 offen offset:0 sc1
    buffer_load_dwordx4 a[104:107], v6, s[84:87], s12 offen offset:0 sc1
    buffer_load_dwordx4 a[108:111], v6, s[84:87], s10 offen offset:1024 sc1
    buffer_load_dwordx4 a[112:115], v6, s[84:87], s11 offen offset:1024 sc1
    buffer_load_dwordx4 a[116:119], v6, s[84:87], s12 offen offset:1024 sc1
    buffer_load_dwordx4 a[120:123], v6, s[84:87], s10 offen offset:2048 sc1
    buffer_load_dwordx4 a[124:127], v6, s[84:87], s11 offen offset:2048 sc1
    buffer_load_dwordx4 a[128:131], v6, s[84:87], s12 offen offset:2048 sc1
    buffer_load_dwordx4 a[132:135], v6, s[84:87], s10 offen offset:3072 sc1
    buffer_load_dwordx4 a[136:139], v6, s[84:87], s11 offen offset:3072 sc1
    buffer_load_dwordx4 a[140:143], v6, s[84:87], s12 offen offset:3072 sc1
    s_add_u32 s10, s10, 4096
    s_add_u32 s11, s11, 4096
    s_add_u32 s12, s12, 4096
    buffer_load_dwordx4 a[144:147], v6, s[84:87], s10 offen offset:0 sc1
    buffer_load_dwordx4 a[148:151], v6, s[84:87], s11 offen offset:0 sc1
    buffer_load_dwordx4 a[152:155], v6, s[84:87], s12 offen offset:0 sc1
    buffer_load_dwordx4 a[156:159], v6, s[84:87], s10 offen offset:1024 sc1
    buffer_load_dwordx4 a[160:163], v6, s[84:87], s11 offen offset:1024 sc1
    buffer_load_dwordx4 a[164:167], v6, s[84:87], s12 offen offset:1024 sc1
    buffer_load_dwordx4 a[168:171], v6, s[84:87], s10 offen offset:2048 sc1
    buffer_load_dwordx4 a[172:175], v6, s[84:87], s11 offen offset:2048 sc1
    buffer_load_dwordx4 a[176:179], v6, s[84:87], s12 offen offset:2048 sc1
    buffer_load_dwordx4 a[180:183], v6, s[84:87], s10 offen offset:3072 sc1
    buffer_load_dwordx4 a[184:187], v6, s[84:87], s11 offen offset:3072 sc1
    buffer_load_dwordx4 a[188:191], v6, s[84:87], s12 offen offset:3072 sc1
    s_add_u32 s10, s10, 4096
    s_add_u32 s11, s11, 4096
    s_add_u32 s12, s12, 4096
    buffer_load_dwordx4 a[192:195], v6, s[84:87], s10 offen offset:0 sc1
    buffer_load_dwordx4 a[196:199], v6, s[84:87], s11 offen offset:0 sc1
    buffer_load_dwordx4 a[200:203], v6, s[84:87], s12 offen offset:0 sc1
    buffer_load_dwordx4 a[204:207], v6, s[84:87], s10 offen offset:1024 sc1
    buffer_load_dwordx4 a[208:211], v6, s[84:87], s11 offen offset:1024 sc1
    buffer_load_dwordx4 a[212:215], v6, s[84:87], s12 offen offset:1024 sc1
M_D_loop:
    s_lshl_b32 s14, s3, 10
    s_add_u32 s14, s14, 93847552
    s_mov_b32 s15, 0
    s_cmp_lg_u32 s5, 1
    s_cbranch_scc1 wf_19d
    v_lshlrev_b32 v8, 1, v6
    v_min_u32 v8, 736, v8
wf_19:
    buffer_load_dword v9, v8, s[20:23], s14 offen sc1
    s_waitcnt vmcnt(0)
    v_cmp_gt_u32 vcc, 1, v9
    s_cbranch_vccz wf_19d
    s_sleep 2
    s_sub_u32 s94, s94, 1
    s_cbranch_scc0 wf_19
    s_mov_b32 s94, 0
wf_19d:
    s_barrier
    s_mul_i32 s6, s3, 36864
    s_add_u32 s6, s6, 83886080
    buffer_load_dwordx4 v[16:19], v2, s[20:23], s6 offen offset:0 sc1
    buffer_load_dwordx4 v[20:23], v2, s[20:23], s6 offen offset:128 sc1
    buffer_load_dwordx4 v[24:27], v2, s[20:23], s6 offen offset:256 sc1
    buffer_load_dwordx4 v[28:31], v2, s[20:23], s6 offen offset:384 sc1
    buffer_load_dwordx4 v[32:35], v2, s[20:23], s6 offen offset:512 sc1
    buffer_load_dwordx4 v[36:39], v2, s[20:23], s6 offen offset:640 sc1
    buffer_load_dwordx4 v[40:43], v2, s[20:23], s6 offen offset:768 sc1
    buffer_load_dwordx4 v[44:47], v2, s[20:23], s6 offen offset:896 sc1
    buffer_load_dwordx4 v[48:51], v2, s[20:23], s6 offen offset:1024 sc1
    s_waitcnt vmcnt(0)
ln_20:
    s_mov_b32 s12, 0x3f803f80
    s_mov_b32 s13, 0x3ae38e39
    v_mov_b32 v52, 0
    v_mov_b32 v53, 0
    v_dot2_f32_bf16 v52, v16, s12, v52
    v_dot2_f32_bf16 v53, v17, s12, v53
    v_dot2_f32_bf16 v52, v18, s12, v52
    v_dot2_f32_bf16 v53, v19, s12, v53
    v_dot2_f32_bf16 v52, v20, s12, v52
    v_dot2_f32_bf16 v53, v21, s12, v53
    v_dot2_f32_bf16 v52, v22, s12, v52
    v_dot2_f32_bf16 v53, v23, s12, v53
    v_dot2_f32_bf16 v52, v24, s12, v52
    v_dot2_f32_bf16 v53, v25, s12, v53
    v_dot2_f32_bf16 v52, v26, s12, v52
    v_dot2_f32_bf16 v53, v27, s12, v53
    v_dot2_f32_bf16 v52, v28, s12, v52
    v_dot2_f32_bf16 v53, v29, s12, v53
    v_dot2_f32_bf16 v52, v30, s12, v52
    v_dot2_f32_bf16 v53, v31, s12, v53
    v_dot2_f32_bf16 v52, v32, s12, v52
    v_dot2_f32_bf16 v53, v33, s12, v53
    v_dot2_f32_bf16 v52, v34, s12, v52
    v_dot2_f32_bf16 v53, v35, s12, v53
    v_dot2_f32_bf16 v52, v36, s12, v52
    v_dot2_f32_bf16 v53, v37, s12, v53
    v_dot2_f32_bf16 v52, v38, s12, v52
    v_dot2_f32_bf16 v53, v39, s12, v53
    v_dot2_f32_bf16 v52, v40, s12, v52
    v_dot2_f32_bf16 v53, v41, s12, v53
    v_dot2_f32_bf16 v52, v42, s12, v52
    v_dot2_f32_bf16 v53, v43, s12, v53
    v_dot2_f32_bf16 v52, v44, s12, v52
    v_dot2_f32_bf16 v53, v45, s12, v53
    v_dot2_f32_bf16 v52, v46, s12, v52
    v_dot2_f32_bf16 v53, v47, s12, v53
    v_dot2_f32_bf16 v52, v48, s12, v52
    v_dot2_f32_bf16 v53, v49, s12, v53
    v_dot2_f32_bf16 v52, v50, s12, v52
    v_dot2_f32_bf16 v53, v51, s12, v53
    s_nop 2
    v_add_f32 v52, v52, v53
    s_nop 1
    v_add_f32_dpp v52, v52, v52 quad_perm:[1,0,3,2] row_mask:0xf bank_mask:0xf
    s_nop 1
    v_add_f32_dpp v52, v52, v52 quad_perm:[2,3,0,1] row_mask:0xf bank_mask:0xf
    s_nop 1
    v_add_f32_dpp v52, v52, v52 row_half_mirror row_mask:0xf bank_mask:0xf
    v_mul_f32 v52, s13, v52
    v_mov_b32 v54, v52
    v_cvt_pk_bf16_f32 v54, v54, v54
    v_and_b32 v54, 0xffff0000, v54
    v_mov_b32 v55, v54
    v_sub_f32 v52, v52, v54
    v_mov_b32 v56, 0
    v_mov_b32 v57, 0
    v_lshlrev_b32 v58, 16, v16
    v_and_b32 v59, 0xffff0000, v16
    v_pk_add_f32 v[58:59], v[58:59], v[54:55] neg_lo:[0,1] neg_hi:[0,1]
    v_pk_fma_f32 v[56:57], v[58:59], v[58:59], v[56:57]
    v_cvt_pk_bf16_f32 v16, v58, v59
    v_lshlrev_b32 v60, 16, v17
    v_and_b32 v61, 0xffff0000, v17
    v_pk_add_f32 v[60:61], v[60:61], v[54:55] neg_lo:[0,1] neg_hi:[0,1]
    v_pk_fma_f32 v[56:57], v[60:61], v[60:61], v[56:57]
    v_cvt_pk_bf16_f32 v17, v60, v61
    v_lshlrev_b32 v58, 16, v18
    v_and_b32 v59, 0xffff0000, v18
    v_pk_add_f32 v[58:59], v[58:59], v[54:55] neg_lo:[0,1] neg_hi:[0,1]
    v_pk_fma_f32 v[56:57], v[58:59], v[58:59], v[56:57]
    v_cvt_pk_bf16_f32 v18, v58, v59
    v_lshlrev_b32 v60, 16, v19
    v_and_b32 v61, 0xffff0000, v19
    v_pk_add_f32 v[60:61], v[60:61], v[54:55] neg_lo:[0,1] neg_hi:[0,1]
    v_pk_fma_f32 v[56:57], v[60:61], v[60:61], v[56:57]
    v_cvt_pk_bf16_f32 v19, v60, v61
    v_lshlrev_b32 v58, 16, v20
    v_and_b32 v59, 0xffff0000, v20
    v_pk_add_f32 v[58:59], v[58:59], v[54:55] neg_lo:[0,1] neg_hi:[0,1]
    v_pk_fma_f32 v[56:57], v[58:59], v[58:59], v[56:57]
    v_cvt_pk_bf16_f32 v20, v58, v59
    v_lshlrev_b32 v60, 16, v21
    v_and_b32 v61, 0xffff0000, v21
    v_pk_add_f32 v[60:61], v[60:61], v[54:55] neg_lo:[0,1] neg_hi:[0,1]
    v_pk_fma_f32 v[56:57], v[60:61], v[60:61], v[56:57]
    v_cvt_pk_bf16_f32 v21, v60, v61
    v_lshlrev_b32 v58, 16, v22
    v_and_b32 v59, 0xffff0000, v22
    v_pk_add_f32 v[58:59], v[58:59], v[54:55] neg_lo:[0,1] neg_hi:[0,1]
    v_pk_fma_f32 v[56:57], v[58:59], v[58:59], v[56:57]
    v_cvt_pk_bf16_f32 v22, v58, v59
    v_lshlrev_b32 v60, 16, v23
    v_and_b32 v61, 0xffff0000, v23
    v_pk_add_f32 v[60:61], v[60:61], v[54:55] neg_lo:[0,1] neg_hi:[0,1]
    v_pk_fma_f32 v[56:57], v[60:61], v[60:61], v[56:57]
    v_cvt_pk_bf16_f32 v23, v60, v61
    v_lshlrev_b32 v58, 16, v24
    v_and_b32 v59, 0xffff0000, v24
    v_pk_add_f32 v[58:59], v[58:59], v[54:55] neg_lo:[0,1] neg_hi:[0,1]
    v_pk_fma_f32 v[56:57], v[58:59], v[58:59], v[56:57]
    v_cvt_pk_bf16_f32 v24, v58, v59
    v_lshlrev_b32 v60, 16, v25
    v_and_b32 v61, 0xffff0000, v25
    v_pk_add_f32 v[60:61], v[60:61], v[54:55] neg_lo:[0,1] neg_hi:[0,1]
    v_pk_fma_f32 v[56:57], v[60:61], v[60:61], v[56:57]
    v_cvt_pk_bf16_f32 v25, v60, v61
    v_lshlrev_b32 v58, 16, v26
    v_and_b32 v59, 0xffff0000, v26
    v_pk_add_f32 v[58:59], v[58:59], v[54:55] neg_lo:[0,1] neg_hi:[0,1]
    v_pk_fma_f32 v[56:57], v[58:59], v[58:59], v[56:57]
    v_cvt_pk_bf16_f32 v26, v58, v59
    v_lshlrev_b32 v60, 16, v27
    v_and_b32 v61, 0xffff0000, v27
    v_pk_add_f32 v[60:61], v[60:61], v[54:55] neg_lo:[0,1] neg_hi:[0,1]
    v_pk_fma_f32 v[56:57], v[60:61], v[60:61], v[56:57]
    v_cvt_pk_bf16_f32 v27, v60, v61
    v_lshlrev_b32 v58, 16, v28
    v_and_b32 v59, 0xffff0000, v28
    v_pk_add_f32 v[58:59], v[58:59], v[54:55] neg_lo:[0,1] neg_hi:[0,1]
    v_pk_fma_f32 v[56:57], v[58:59], v[58:59], v[56:57]
    v_cvt_pk_bf16_f32 v28, v58, v59
    v_lshlrev_b32 v60, 16, v29
    v_and_b32 v61, 0xffff0000, v29
    v_pk_add_f32 v[60:61], v[60:61], v[54:55] neg_lo:[0,1] neg_hi:[0,1]
    v_pk_fma_f32 v[56:57], v[60:61], v[60:61], v[56:57]
    v_cvt_pk_bf16_f32 v29, v60, v61
    v_lshlrev_b32 v58, 16, v30
    v_and_b32 v59, 0xffff0000, v30
    v_pk_add_f32 v[58:59], v[58:59], v[54:55] neg_lo:[0,1] neg_hi:[0,1]
    v_pk_fma_f32 v[56:57], v[58:59], v[58:59], v[56:57]
    v_cvt_pk_bf16_f32 v30, v58, v59
    v_lshlrev_b32 v60, 16, v31
    v_and_b32 v61, 0xffff0000, v31
    v_pk_add_f32 v[60:61], v[60:61], v[54:55] neg_lo:[0,1] neg_hi:[0,1]
    v_pk_fma_f32 v[56:57], v[60:61], v[60:61], v[56:57]
    v_cvt_pk_bf16_f32 v31, v60, v61
    v_lshlrev_b32 v58, 16, v32
    v_and_b32 v59, 0xffff0000, v32
    v_pk_add_f32 v[58:59], v[58:59], v[54:55] neg_lo:[0,1] neg_hi:[0,1]
    v_pk_fma_f32 v[56:57], v[58:59], v[58:59], v[56:57]
    v_cvt_pk_bf16_f32 v32, v58, v59
    v_lshlrev_b32 v60, 16, v33
    v_and_b32 v61, 0xffff0000, v33
    v_pk_add_f32 v[60:61], v[60:61], v[54:55] neg_lo:[0,1] neg_hi:[0,1]
    v_pk_fma_f32 v[56:57], v[60:61], v[60:61], v[56:57]
    v_cvt_pk_bf16_f32 v33, v60, v61
    v_lshlrev_b32 v58, 16, v34
    v_and_b32 v59, 0xffff0000, v34
    v_pk_add_f32 v[58:59], v[58:59], v[54:55] neg_lo:[0,1] neg_hi:[0,1]
    v_pk_fma_f32 v[56:57], v[58:59], v[58:59], v[56:57]
    v_cvt_pk_bf16_f32 v34, v58, v59
    v_lshlrev_b32 v60, 16, v35
    v_and_b32 v61, 0xffff0000, v35
    v_pk_add_f32 v[60:61], v[60:61], v[54:55] neg_lo:[0,1] neg_hi:[0,1]
    v_pk_fma_f32 v[56:57], v[60:61], v[60:61], v[56:57]
    v_cvt_pk_bf16_f32 v35, v60, v61
    v_lshlrev_b32 v58, 16, v36
    v_and_b32 v59, 0xffff0000, v36
    v_pk_add_f32 v[58:59], v[58:59], v[54:55] neg_lo:[0,1] neg_hi:[0,1]
    v_pk_fma_f32 v[56:57], v[58:59], v[58:59], v[56:57]
    v_cvt_pk_bf16_f32 v36, v58, v59
    v_lshlrev_b32 v60, 16, v37
    v_and_b32 v61, 0xffff0000, v37
    v_pk_add_f32 v[60:61], v[60:61], v[54:55] neg_lo:[0,1] neg_hi:[0,1]
    v_pk_fma_f32 v[56:57], v[60:61], v[60:61], v[56:57]
    v_cvt_pk_bf16_f32 v37, v60, v61
    v_lshlrev_b32 v58, 16, v38
    v_and_b32 v59, 0xffff0000, v38
    v_pk_add_f32 v[58:59], v[58:59], v[54:55] neg_lo:[0,1] neg_hi:[0,1]
    v_pk_fma_f32 v[56:57], v[58:59], v[58:59], v[56:57]
    v_cvt_pk_bf16_f32 v38, v58, v59
    v_lshlrev_b32 v60, 16, v39
    v_and_b32 v61, 0xffff0000, v39
    v_pk_add_f32 v[60:61], v[60:61], v[54:55] neg_lo:[0,1] neg_hi:[0,1]
    v_pk_fma_f32 v[56:57], v[60:61], v[60:61], v[56:57]
    v_cvt_pk_bf16_f32 v39, v60, v61
    v_lshlrev_b32 v58, 16, v40
    v_and_b32 v59, 0xffff0000, v40
    v_pk_add_f32 v[58:59], v[58:59], v[54:55] neg_lo:[0,1] neg_hi:[0,1]
    v_pk_fma_f32 v[56:57], v[58:59], v[58:59], v[56:57]
    v_cvt_pk_bf16_f32 v40, v58, v59
    v_lshlrev_b32 v60, 16, v41
    v_and_b32 v61, 0xffff0000, v41
    v_pk_add_f32 v[60:61], v[60:61], v[54:55] neg_lo:[0,1] neg_hi:[0,1]
    v_pk_fma_f32 v[56:57], v[60:61], v[60:61], v[56:57]
    v_cvt_pk_bf16_f32 v41, v60, v61
    v_lshlrev_b32 v58, 16, v42
    v_and_b32 v59, 0xffff0000, v42
    v_pk_add_f32 v[58:59], v[58:59], v[54:55] neg_lo:[0,1] neg_hi:[0,1]
    v_pk_fma_f32 v[56:57], v[58:59], v[58:59], v[56:57]
    v_cvt_pk_bf16_f32 v42, v58, v59
    v_lshlrev_b32 v60, 16, v43
    v_and_b32 v61, 0xffff0000, v43
    v_pk_add_f32 v[60:61], v[60:61], v[54:55] neg_lo:[0,1] neg_hi:[0,1]
    v_pk_fma_f32 v[56:57], v[60:61], v[60:61], v[56:57]
    v_cvt_pk_bf16_f32 v43, v60, v61
    v_lshlrev_b32 v58, 16, v44
    v_and_b32 v59, 0xffff0000, v44
    v_pk_add_f32 v[58:59], v[58:59], v[54:55] neg_lo:[0,1] neg_hi:[0,1]
    v_pk_fma_f32 v[56:57], v[58:59], v[58:59], v[56:57]
    v_cvt_pk_bf16_f32 v44, v58, v59
    v_lshlrev_b32 v60, 16, v45
    v_and_b32 v61, 0xffff0000, v45
    v_pk_add_f32 v[60:61], v[60:61], v[54:55] neg_lo:[0,1] neg_hi:[0,1]
    v_pk_fma_f32 v[56:57], v[60:61], v[60:61], v[56:57]
    v_cvt_pk_bf16_f32 v45, v60, v61
    v_lshlrev_b32 v58, 16, v46
    v_and_b32 v59, 0xffff0000, v46
    v_pk_add_f32 v[58:59], v[58:59], v[54:55] neg_lo:[0,1] neg_hi:[0,1]
    v_pk_fma_f32 v[56:57], v[58:59], v[58:59], v[56:57]
    v_cvt_pk_bf16_f32 v46, v58, v59
    v_lshlrev_b32 v60, 16, v47
    v_and_b32 v61, 0xffff0000, v47
    v_pk_add_f32 v[60:61], v[60:61], v[54:55] neg_lo:[0,1] neg_hi:[0,1]
    v_pk_fma_f32 v[56:57], v[60:61], v[60:61], v[56:57]
    v_cvt_pk_bf16_f32 v47, v60, v61
    v_lshlrev_b32 v58, 16, v48
    v_and_b32 v59, 0xffff0000, v48
    v_pk_add_f32 v[58:59], v[58:59], v[54:55] neg_lo:[0,1] neg_hi:[0,1]
    v_pk_fma_f32 v[56:57], v[58:59], v[58:59], v[56:57]
    v_cvt_pk_bf16_f32 v48, v58, v59
    v_lshlrev_b32 v60, 16, v49
    v_and_b32 v61, 0xffff0000, v49
    v_pk_add_f32 v[60:61], v[60:61], v[54:55] neg_lo:[0,1] neg_hi:[0,1]
    v_pk_fma_f32 v[56:57], v[60:61], v[60:61], v[56:57]
    v_cvt_pk_bf16_f32 v49, v60, v61
    v_lshlrev_b32 v58, 16, v50
    v_and_b32 v59, 0xffff0000, v50
    v_pk_add_f32 v[58:59], v[58:59], v[54:55] neg_lo:[0,1] neg_hi:[0,1]
    v_pk_fma_f32 v[56:57], v[58:59], v[58:59], v[56:57]
    v_cvt_pk_bf16_f32 v50, v58, v59
    v_lshlrev_b32 v60, 16, v51
    v_and_b32 v61, 0xffff0000, v51
    v_pk_add_f32 v[60:61], v[60:61], v[54:55] neg_lo:[0,1] neg_hi:[0,1]
    v_pk_fma_f32 v[56:57], v[60:61], v[60:61], v[56:57]
    v_cvt_pk_bf16_f32 v51, v60, v61
    v_add_f32 v56, v56, v57
    s_nop 1
    v_add_f32_dpp v56, v56, v56 quad_perm:[1,0,3,2] row_mask:0xf bank_mask:0xf
    s_nop 1
    v_add_f32_dpp v56, v56, v56 quad_perm:[2,3,0,1] row_mask:0xf bank_mask:0xf
    s_nop 1
    v_add_f32_dpp v56, v56, v56 row_half_mirror row_mask:0xf bank_mask:0xf
    v_mul_f32 v56, s13, v56
    v_fma_f32 v56, -v52, v52, v56
    v_max_f32 v56, 0, v56
    v_cvt_pk_bf16_f32 v56, v56, v56
    v_and_b32 v56, 0xffff0000, v56
    v_add_f32 v56, 0x3727c5ac, v56
    v_cvt_pk_bf16_f32 v56, v56, v56
    v_and_b32 v56, 0xffff0000, v56
    v_sqrt_f32 v56, v56
    s_nop 0
    v_cvt_pk_bf16_f32 v56, v56, v56
    v_and_b32 v56, 0xffff0000, v56
    v_rcp_f32 v56, v56
    s_nop 0
    v_mov_b32 v57, v56
    v_lshlrev_b32 v58, 16, v16
    v_and_b32 v59, 0xffff0000, v16
    v_pk_mul_f32 v[58:59], v[58:59], v[56:57]
    v_cvt_pk_bf16_f32 v16, v58, v59
    v_lshlrev_b32 v60, 16, v17
    v_and_b32 v61, 0xffff0000, v17
    v_pk_mul_f32 v[60:61], v[60:61], v[56:57]
    v_cvt_pk_bf16_f32 v17, v60, v61
    v_lshlrev_b32 v58, 16, v18
    v_and_b32 v59, 0xffff0000, v18
    v_pk_mul_f32 v[58:59], v[58:59], v[56:57]
    v_cvt_pk_bf16_f32 v18, v58, v59
    v_lshlrev_b32 v60, 16, v19
    v_and_b32 v61, 0xffff0000, v19
    v_pk_mul_f32 v[60:61], v[60:61], v[56:57]
    v_cvt_pk_bf16_f32 v19, v60, v61
    ds_write_b128 v3, v[16:19] offset:0
    v_lshlrev_b32 v58, 16, v20
    v_and_b32 v59, 0xffff0000, v20
    v_pk_mul_f32 v[58:59], v[58:59], v[56:57]
    v_cvt_pk_bf16_f32 v20, v58, v59
    v_lshlrev_b32 v60, 16, v21
    v_and_b32 v61, 0xffff0000, v21
    v_pk_mul_f32 v[60:61], v[60:61], v[56:57]
    v_cvt_pk_bf16_f32 v21, v60, v61
    v_lshlrev_b32 v58, 16, v22
    v_and_b32 v59, 0xffff0000, v22
    v_pk_mul_f32 v[58:59], v[58:59], v[56:57]
    v_cvt_pk_bf16_f32 v22, v58, v59
    v_lshlrev_b32 v60, 16, v23
    v_and_b32 v61, 0xffff0000, v23
    v_pk_mul_f32 v[60:61], v[60:61], v[56:57]
    v_cvt_pk_bf16_f32 v23, v60, v61
    ds_write_b128 v3, v[20:23] offset:2176
    v_lshlrev_b32 v58, 16, v24
    v_and_b32 v59, 0xffff0000, v24
    v_pk_mul_f32 v[58:59], v[58:59], v[56:57]
    v_cvt_pk_bf16_f32 v24, v58, v59
    v_lshlrev_b32 v60, 16, v25
    v_and_b32 v61, 0xffff0000, v25
    v_pk_mul_f32 v[60:61], v[60:61], v[56:57]
    v_cvt_pk_bf16_f32 v25, v60, v61
    v_lshlrev_b32 v58, 16, v26
    v_and_b32 v59, 0xffff0000, v26
    v_pk_mul_f32 v[58:59], v[58:59], v[56:57]
    v_cvt_pk_bf16_f32 v26, v58, v59
    v_lshlrev_b32 v60, 16, v27
    v_and_b32 v61, 0xffff0000, v27
    v_pk_mul_f32 v[60:61], v[60:61], v[56:57]
    v_cvt_pk_bf16_f32 v27, v60, v61
    ds_write_b128 v3, v[24:27] offset:4352
    v_lshlrev_b32 v58, 16, v28
    v_and_b32 v59, 0xffff0000, v28
    v_pk_mul_f32 v[58:59], v[58:59], v[56:57]
    v_cvt_pk_bf16_f32 v28, v58, v59
    v_lshlrev_b32 v60, 16, v29
    v_and_b32 v61, 0xffff0000, v29
    v_pk_mul_f32 v[60:61], v[60:61], v[56:57]
    v_cvt_pk_bf16_f32 v29, v60, v61
    v_lshlrev_b32 v58, 16, v30
    v_and_b32 v59, 0xffff0000, v30
    v_pk_mul_f32 v[58:59], v[58:59], v[56:57]
    v_cvt_pk_bf16_f32 v30, v58, v59
    v_lshlrev_b32 v60, 16, v31
    v_and_b32 v61, 0xffff0000, v31
    v_pk_mul_f32 v[60:61], v[60:61], v[56:57]
    v_cvt_pk_bf16_f32 v31, v60, v61
    ds_write_b128 v3, v[28:31] offset:6528
    v_lshlrev_b32 v58, 16, v32
    v_and_b32 v59, 0xffff0000, v32
    v_pk_mul_f32 v[58:59], v[58:59], v[56:57]
    v_cvt_pk_bf16_f32 v32, v58, v59
    v_lshlrev_b32 v60, 16, v33
    v_and_b32 v61, 0xffff0000, v33
    v_pk_mul_f32 v[60:61], v[60:61], v[56:57]
    v_cvt_pk_bf16_f32 v33, v60, v61
    v_lshlrev_b32 v58, 16, v34
    v_and_b32 v59, 0xffff0000, v34
    v_pk_mul_f32 v[58:59], v[58:59], v[56:57]
    v_cvt_pk_bf16_f32 v34, v58, v59
    v_lshlrev_b32 v60, 16, v35
    v_and_b32 v61, 0xffff0000, v35
    v_pk_mul_f32 v[60:61], v[60:61], v[56:57]
    v_cvt_pk_bf16_f32 v35, v60, v61
    ds_write_b128 v3, v[32:35] offset:8704
    v_lshlrev_b32 v58, 16, v36
    v_and_b32 v59, 0xffff0000, v36
    v_pk_mul_f32 v[58:59], v[58:59], v[56:57]
    v_cvt_pk_bf16_f32 v36, v58, v59
    v_lshlrev_b32 v60, 16, v37
    v_and_b32 v61, 0xffff0000, v37
    v_pk_mul_f32 v[60:61], v[60:61], v[56:57]
    v_cvt_pk_bf16_f32 v37, v60, v61
    v_lshlrev_b32 v58, 16, v38
    v_and_b32 v59, 0xffff0000, v38
    v_pk_mul_f32 v[58:59], v[58:59], v[56:57]
    v_cvt_pk_bf16_f32 v38, v58, v59
    v_lshlrev_b32 v60, 16, v39
    v_and_b32 v61, 0xffff0000, v39
    v_pk_mul_f32 v[60:61], v[60:61], v[56:57]
    v_cvt_pk_bf16_f32 v39, v60, v61
    ds_write_b128 v3, v[36:39] offset:10880
    v_lshlrev_b32 v58, 16, v40
    v_and_b32 v59, 0xffff0000, v40
    v_pk_mul_f32 v[58:59], v[58:59], v[56:57]
    v_cvt_pk_bf16_f32 v40, v58, v59
    v_lshlrev_b32 v60, 16, v41
    v_and_b32 v61, 0xffff0000, v41
    v_pk_mul_f32 v[60:61], v[60:61], v[56:57]
    v_cvt_pk_bf16_f32 v41, v60, v61
    v_lshlrev_b32 v58, 16, v42
    v_and_b32 v59, 0xffff0000, v42
    v_pk_mul_f32 v[58:59], v[58:59], v[56:57]
    v_cvt_pk_bf16_f32 v42, v58, v59
    v_lshlrev_b32 v60, 16, v43
    v_and_b32 v61, 0xffff0000, v43
    v_pk_mul_f32 v[60:61], v[60:61], v[56:57]
    v_cvt_pk_bf16_f32 v43, v60, v61
    ds_write_b128 v3, v[40:43] offset:13056
    v_lshlrev_b32 v58, 16, v44
    v_and_b32 v59, 0xffff0000, v44
    v_pk_mul_f32 v[58:59], v[58:59], v[56:57]
    v_cvt_pk_bf16_f32 v44, v58, v59
    v_lshlrev_b32 v60, 16, v45
    v_and_b32 v61, 0xffff0000, v45
    v_pk_mul_f32 v[60:61], v[60:61], v[56:57]
    v_cvt_pk_bf16_f32 v45, v60, v61
    v_lshlrev_b32 v58, 16, v46
    v_and_b32 v59, 0xffff0000, v46
    v_pk_mul_f32 v[58:59], v[58:59], v[56:57]
    v_cvt_pk_bf16_f32 v46, v58, v59
    v_lshlrev_b32 v60, 16, v47
    v_and_b32 v61, 0xffff0000, v47
    v_pk_mul_f32 v[60:61], v[60:61], v[56:57]
    v_cvt_pk_bf16_f32 v47, v60, v61
    ds_write_b128 v3, v[44:47] offset:15232
    v_lshlrev_b32 v58, 16, v48
    v_and_b32 v59, 0xffff0000, v48
    v_pk_mul_f32 v[58:59], v[58:59], v[56:57]
    v_cvt_pk_bf16_f32 v48, v58, v59
    v_lshlrev_b32 v60, 16, v49
    v_and_b32 v61, 0xffff0000, v49
    v_pk_mul_f32 v[60:61], v[60:61], v[56:57]
    v_cvt_pk_bf16_f32 v49, v60, v61
    v_lshlrev_b32 v58, 16, v50
    v_and_b32 v59, 0xffff0000, v50
    v_pk_mul_f32 v[58:59], v[58:59], v[56:57]
    v_cvt_pk_bf16_f32 v50, v58, v59
    v_lshlrev_b32 v60, 16, v51
    v_and_b32 v61, 0xffff0000, v51
    v_pk_mul_f32 v[60:61], v[60:61], v[56:57]
    v_cvt_pk_bf16_f32 v51, v60, v61
    ds_write_b128 v3, v[48:51] offset:17408
    s_waitcnt lgkmcnt(0)
    s_barrier
    ds_read_b128 v[16:19], v10 offset:0
    ds_read_b128 v[20:23], v10 offset:19584
    ds_read_b128 v[24:27], v10 offset:1088
    ds_read_b128 v[28:31], v10 offset:20672
    ds_read_b128 v[32:35], v10 offset:2176
    ds_read_b128 v[36:39], v10 offset:21760
    ds_read_b128 v[40:43], v10 offset:3264
    ds_read_b128 v[44:47], v10 offset:22848
    s_waitcnt lgkmcnt(6)
    v_mfma_f32_16x16x32_bf16 v[64:67], v[16:19], a[0:3], 0
    v_mfma_f32_16x16x32_bf16 v[68:71], v[16:19], a[4:7], 0
    v_mfma_f32_16x16x32_bf16 v[72:75], v[16:19], a[8:11], 0
    v_mfma_f32_16x16x32_bf16 v[76:79], v[20:23], a[0:3], 0
    v_mfma_f32_16x16x32_bf16 v[80:83], v[20:23], a[4:7], 0
    v_mfma_f32_16x16x32_bf16 v[84:87], v[20:23], a[8:11], 0
    ds_read_b128 v[16:19], v10 offset:4352
    ds_read_b128 v[20:23], v10 offset:23936
    s_waitcnt lgkmcnt(6)
    v_mfma_f32_16x16x32_bf16 v[64:67], v[24:27], a[12:15], v[64:67]
    v_mfma_f32_16x16x32_bf16 v[68:71], v[24:27], a[16:19], v[68:71]
    v_mfma_f32_16x16x32_bf16 v[72:75], v[24:27], a[20:23], v[72:75]
    v_mfma_f32_16x16x32_bf16 v[76:79], v[28:31], a[12:15], v[76:79]
    v_mfma_f32_16x16x32_bf16 v[80:83], v[28:31], a[16:19], v[80:83]
    v_mfma_f32_16x16x32_bf16 v[84:87], v[28:31], a[20:23], v[84:87]
    ds_read_b128 v[24:27], v10 offset:5440
    ds_read_b128 v[28:31], v10 offset:25024
    s_waitcnt lgkmcnt(6)
    v_mfma_f32_16x16x32_bf16 v[64:67], v[32:35], a[24:27], v[64:67]
    v_mfma_f32_16x16x32_bf16 v[68:71], v[32:35], a[28:31], v[68:71]
    v_mfma_f32_16x16x32_bf16 v[72:75], v[32:35], a[32:35], v[72:75]
    v_mfma_f32_16x16x32_bf16 v[76:79], v[36:39], a[24:27], v[76:79]
    v_mfma_f32_16x16x32_bf16 v[80:83], v[36:39], a[28:31], v[80:83]
    v_mfma_f32_16x16x32_bf16 v[84:87], v[36:39], a[32:35], v[84:87]
    ds_read_b128 v[32:35], v10 offset:6528
    ds_read_b128 v[36:39], v10 offset:26112
    s_waitcnt lgkmcnt(6)
    v_mfma_f32_16x16x32_bf16 v[64:67], v[40:43], a[36:39], v[64:67]
    v_mfma_f32_16x16x32_bf16 v[68:71], v[40:43], a[40:43], v[68:71]
    v_mfma_f32_16x16x32_bf16 v[72:75], v[40:43], a[44:47], v[72:75]
    v_mfma_f32_16x16x32_bf16 v[76:79], v[44:47], a[36:39], v[76:79]
    v_mfma_f32_16x16x32_bf16 v[80:83], v[44:47], a[40:43], v[80:83]
    v_mfma_f32_16x16x32_bf16 v[84:87], v[44:47], a[44:47], v[84:87]
    ds_read_b128 v[40:43], v10 offset:7616
    ds_read_b128 v[44:47], v10 offset:27200
    s_waitcnt lgkmcnt(6)
    v_mfma_f32_16x16x32_bf16 v[64:67], v[16:19], a[48:51], v[64:67]
    v_mfma_f32_16x16x32_bf16 v[68:71], v[16:19], a[52:55], v[68:71]
    v_mfma_f32_16x16x32_bf16 v[72:75], v[16:19], a[56:59], v[72:75]
    v_mfma_f32_16x16x32_bf16 v[76:79], v[20:23], a[48:51], v[76:79]
    v_mfma_f32_16x16x32_bf16 v[80:83], v[20:23], a[52:55], v[80:83]
    v_mfma_f32_16x16x32_bf16 v[84:87], v[20:23], a[56:59], v[84:87]
    ds_read_b128 v[16:19], v10 offset:8704
    ds_read_b128 v[20:23], v10 offset:28288
    s_waitcnt lgkmcnt(6)
    v_mfma_f32_16x16x32_bf16 v[64:67], v[24:27], a[60:63], v[64:67]
    v_mfma_f32_16x16x32_bf16 v[68:71], v[24:27], a[64:67], v[68:71]
    v_mfma_f32_16x16x32_bf16 v[72:75], v[24:27], a[68:71], v[72:75]
    v_mfma_f32_16x16x32_bf16 v[76:79], v[28:31], a[60:63], v[76:79]
    v_mfma_f32_16x16x32_bf16 v[80:83], v[28:31], a[64:67], v[80:83]
    v_mfma_f32_16x16x32_bf16 v[84:87], v[28:31], a[68:71], v[84:87]
    ds_read_b128 v[24:27], v10 offset:9792
    ds_read_b128 v[28:31], v10 offset:29376
    s_waitcnt lgkmcnt(6)
    v_mfma_f32_16x16x32_bf16 v[64:67], v[32:35], a[72:75], v[64:67]
    v_mfma_f32_16x16x32_bf16 v[68:71], v[32:35], a[76:79], v[68:71]
    v_mfma_f32_16x16x32_bf16 v[72:75], v[32:35], a[80:83], v[72:75]
    v_mfma_f32_16x16x32_bf16 v[76:79], v[36:39], a[72:75], v[76:79]
    v_mfma_f32_16x16x32_bf16 v[80:83], v[36:39], a[76:79], v[80:83]
    v_mfma_f32_16x16x32_bf16 v[84:87], v[36:39], a[80:83], v[84:87]
    ds_read_b128 v[32:35], v10 offset:10880
    ds_read_b128 v[36:39], v10 offset:30464
    s_waitcnt lgkmcnt(6)
    v_mfma_f32_16x16x32_bf16 v[64:67], v[40:43], a[84:87], v[64:67]
    v_mfma_f32_16x16x32_bf16 v[68:71], v[40:43], a[88:91], v[68:71]
    v_mfma_f32_16x16x32_bf16 v[72:75], v[40:43], a[92:95], v[72:75]
    v_mfma_f32_16x16x32_bf16 v[76:79], v[44:47], a[84:87], v[76:79]
    v_mfma_f32_16x16x32_bf16 v[80:83], v[44:47], a[88:91], v[80:83]
    v_mfma_f32_16x16x32_bf16 v[84:87], v[44:47], a[92:95], v[84:87]
    ds_read_b128 v[40:43], v10 offset:11968
    ds_read_b128 v[44:47], v10 offset:31552
    s_waitcnt lgkmcnt(6)
    v_mfma_f32_16x16x32_bf16 v[64:67], v[16:19], a[96:99], v[64:67]
    v_mfma_f32_16x16x32_bf16 v[68:71], v[16:19], a[100:103], v[68:71]
    v_mfma_f32_16x16x32_bf16 v[72:75], v[16:19], a[104:107], v[72:75]
    v_mfma_f32_16x16x32_bf16 v[76:79], v[20:23], a[96:99], v[76:79]
    v_mfma_f32_16x16x32_bf16 v[80:83], v[20:23], a[100:103], v[80:83]
    v_mfma_f32_16x16x32_bf16 v[84:87], v[20:23], a[104:107], v[84:87]
    ds_read_b128 v[16:19], v10 offset:13056
    ds_read_b128 v[20:23], v10 offset:32640
    s_waitcnt lgkmcnt(6)
    v_mfma_f32_16x16x32_bf16 v[64:67], v[24:27], a[108:111], v[64:67]
    v_mfma_f32_16x16x32_bf16 v[68:71], v[24:27], a[112:115], v[68:71]
    v_mfma_f32_16x16x32_bf16 v[72:75], v[24:27], a[116:119], v[72:75]
    v_mfma_f32_16x16x32_bf16 v[76:79], v[28:31], a[108:111], v[76:79]
    v_mfma_f32_16x16x32_bf16 v[80:83], v[28:31], a[112:115], v[80:83]
    v_mfma_f32_16x16x32_bf16 v[84:87], v[28:31], a[116:119], v[84:87]
    ds_read_b128 v[24:27], v10 offset:14144
    ds_read_b128 v[28:31], v10 offset:33728
    s_waitcnt lgkmcnt(6)
    v_mfma_f32_16x16x32_bf16 v[64:67], v[32:35], a[120:123], v[64:67]
    v_mfma_f32_16x16x32_bf16 v[68:71], v[32:35], a[124:127], v[68:71]
    v_mfma_f32_16x16x32_bf16 v[72:75], v[32:35], a[128:131], v[72:75]
    v_mfma_f32_16x16x32_bf16 v[76:79], v[36:39], a[120:123], v[76:79]
    v_mfma_f32_16x16x32_bf16 v[80:83], v[36:39], a[124:127], v[80:83]
    v_mfma_f32_16x16x32_bf16 v[84:87], v[36:39], a[128:131], v[84:87]
    ds_read_b128 v[32:35], v10 offset:15232
    ds_read_b128 v[36:39], v10 offset:34816
    s_waitcnt lgkmcnt(6)
    v_mfma_f32_16x16x32_bf16 v[64:67], v[40:43], a[132:135], v[64:67]
    v_mfma_f32_16x16x32_bf16 v[68:71], v[40:43], a[136:139], v[68:71]
    v_mfma_f32_16x16x32_bf16 v[72:75], v[40:43], a[140:143], v[72:75]
    v_mfma_f32_16x16x32_bf16 v[76:79], v[44:47], a[132:135], v[76:79]
    v_mfma_f32_16x16x32_bf16 v[80:83], v[44:47], a[136:139], v[80:83]
    v_mfma_f32_16x16x32_bf16 v[84:87], v[44:47], a[140:143], v[84:87]
    ds_read_b128 v[40:43], v10 offset:16320
    ds_read_b128 v[44:47], v10 offset:35904
    s_waitcnt lgkmcnt(6)
    v_mfma_f32_16x16x32_bf16 v[64:67], v[16:19], a[144:147], v[64:67]
    v_mfma_f32_16x16x32_bf16 v[68:71], v[16:19], a[148:151], v[68:71]
    v_mfma_f32_16x16x32_bf16 v[72:75], v[16:19], a[152:155], v[72:75]
    v_mfma_f32_16x16x32_bf16 v[76:79], v[20:23], a[144:147], v[76:79]
    v_mfma_f32_16x16x32_bf16 v[80:83], v[20:23], a[148:151], v[80:83]
    v_mfma_f32_16x16x32_bf16 v[84:87], v[20:23], a[152:155], v[84:87]
    ds_read_b128 v[16:19], v10 offset:17408
    ds_read_b128 v[20:23], v10 offset:36992
    s_waitcnt lgkmcnt(6)
    v_mfma_f32_16x16x32_bf16 v[64:67], v[24:27], a[156:159], v[64:67]
    v_mfma_f32_16x16x32_bf16 v[68:71], v[24:27], a[160:163], v[68:71]
    v_mfma_f32_16x16x32_bf16 v[72:75], v[24:27], a[164:167], v[72:75]
    v_mfma_f32_16x16x32_bf16 v[76:79], v[28:31], a[156:159], v[76:79]
    v_mfma_f32_16x16x32_bf16 v[80:83], v[28:31], a[160:163], v[80:83]
    v_mfma_f32_16x16x32_bf16 v[84:87], v[28:31], a[164:167], v[84:87]
    ds_read_b128 v[24:27], v10 offset:18496
    ds_read_b128 v[28:31], v10 offset:38080
    s_waitcnt lgkmcnt(6)
    v_mfma_f32_16x16x32_bf16 v[64:67], v[32:35], a[168:171], v[64:67]
    v_mfma_f32_16x16x32_bf16 v[68:71], v[32:35], a[172:175], v[68:71]
    v_mfma_f32_16x16x32_bf16 v[72:75], v[32:35], a[176:179], v[72:75]
    v_mfma_f32_16x16x32_bf16 v[76:79], v[36:39], a[168:171], v[76:79]
    v_mfma_f32_16x16x32_bf16 v[80:83], v[36:39], a[172:175], v[80:83]
    v_mfma_f32_16x16x32_bf16 v[84:87], v[36:39], a[176:179], v[84:87]
    s_waitcnt lgkmcnt(4)
    v_mfma_f32_16x16x32_bf16 v[64:67], v[40:43], a[180:183], v[64:67]
    v_mfma_f32_16x16x32_bf16 v[68:71], v[40:43], a[184:187], v[68:71]
    v_mfma_f32_16x16x32_bf16 v[72:75], v[40:43], a[188:191], v[72:75]
    v_mfma_f32_16x16x32_bf16 v[76:79], v[44:47], a[180:183], v[76:79]
    v_mfma_f32_16x16x32_bf16 v[80:83], v[44:47], a[184:187], v[80:83]
    v_mfma_f32_16x16x32_bf16 v[84:87], v[44:47], a[188:191], v[84:87]
    s_waitcnt lgkmcnt(2)
    v_mfma_f32_16x16x32_bf16 v[64:67], v[16:19], a[192:195], v[64:67]
    v_mfma_f32_16x16x32_bf16 v[68:71], v[16:19], a[196:199], v[68:71]
    v_mfma_f32_16x16x32_bf16 v[72:75], v[16:19], a[200:203], v[72:75]
    v_mfma_f32_16x16x32_bf16 v[76:79], v[20:23], a[192:195], v[76:79]
    v_mfma_f32_16x16x32_bf16 v[80:83], v[20:23], a[196:199], v[80:83]
    v_mfma_f32_16x16x32_bf16 v[84:87], v[20:23], a[200:203], v[84:87]
    s_waitcnt lgkmcnt(0)
    v_mfma_f32_16x16x32_bf16 v[64:67], v[24:27], a[204:207], v[64:67]
    v_mfma_f32_16x16x32_bf16 v[68:71], v[24:27], a[208:211], v[68:71]
    v_mfma_f32_16x16x32_bf16 v[72:75], v[24:27], a[212:215], v[72:75]
    v_mfma_f32_16x16x32_bf16 v[76:79], v[28:31], a[204:207], v[76:79]
    v_mfma_f32_16x16x32_bf16 v[80:83], v[28:31], a[208:211], v[80:83]
    v_mfma_f32_16x16x32_bf16 v[84:87], v[28:31], a[212:215], v[84:87]
    s_mul_i32 s8, s7, 196608
    s_lshl_b32 s9, s3, 7
    s_add_u32 s8, s8, s9
    s_add_u32 s8, s8, 87031808
    v_cvt_pk_bf16_f32 v16, v64, v65
    v_cvt_pk_bf16_f32 v17, v66, v67
    v_cvt_pk_bf16_f32 v18, v76, v77
    v_cvt_pk_bf16_f32 v19, v78, v79
    buffer_store_dwordx4 v[16:19], v7, s[20:23], s8 offen sc1
    s_add_u32 s8, s8, 65536
    v_cvt_pk_bf16_f32 v20, v68, v69
    v_cvt_pk_bf16_f32 v21, v70, v71
    v_cvt_pk_bf16_f32 v22, v80, v81
    v_cvt_pk_bf16_f32 v23, v82, v83
    buffer_store_dwordx4 v[20:23], v7, s[20:23], s8 offen sc1
    s_add_u32 s8, s8, 65536
    v_cvt_pk_bf16_f32 v24, v72, v73
    v_cvt_pk_bf16_f32 v25, v74, v75
    v_cvt_pk_bf16_f32 v26, v84, v85
    v_cvt_pk_bf16_f32 v27, v86, v87
    buffer_store_dwordx4 v[24:27], v7, s[20:23], s8 offen sc1
    s_add_u32 s3, s3, 3
    s_lshl_b32 s6, s44, 2
    s_add_u32 s6, s6, 93915136
    s_sub_u32 s9, s3, 56
    s_cmp_lt_u32 s9, 3
    s_cbranch_scc0 M_D_m
    s_waitcnt vmcnt(0)
    s_barrier
    s_cmp_lg_u32 s5, 0
    s_cbranch_scc1 M_D_loop
    v_mov_b32 v8, 1
    s_mov_b64 exec, 1
    buffer_store_dword v8, off, s[20:23], s6 sc1
    s_mov_b64 exec, -1
    s_branch M_D_loop
M_D_m:
    s_barrier
    s_cmp_lt_u32 s3, 64
    s_cbranch_scc1 M_D_loop
    s_waitcnt vmcnt(0)
    s_barrier
    s_cmp_lg_u32 s5, 0
    s_cbranch_scc1 p2_21b
    v_mov_b32 v8, 2
    s_mov_b64 exec, 1
    buffer_store_dword v8, off, s[20:23], s6 sc1
    s_mov_b64 exec, -1
p2_21b:
M_D_n:
    s_cmp_eq_u32 s95, 1
    s_cbranch_scc1 M_D_e
    s_add_u32 s95, s95, 1
    s_add_u32 s20, s20, 100663296
    s_addc_u32 s21, s21, 0
    s_mov_b32 s22, 167772160
    s_add_u32 s24, s20, 96468992
    s_addc_u32 s25, s21, 0
    s_mov_b32 s3, s40
    s_branch M_D_loop
M_D_e:
    s_add_u32 s44, s44, 171
    s_mov_b32 s42, 7
    s_branch M_E_go
M_Efin:
    s_cmp_ge_u32 s4, 159
    s_cbranch_scc1 M_end
    s_load_dwordx2 s[16:17], s[0:1], 96
    s_waitcnt vmcnt(0) lgkmcnt(0)
    s_barrier
    s_mov_b32 s84, s16
    s_and_b32 s85, s17, 0xffff
    s_mov_b32 s86, 268435456
    s_mov_b32 s87, 0x00020000
    s_add_u32 s20, s84, 100663296
    s_addc_u32 s21, s85, 0
    s_mov_b32 s22, 167772160
    s_mov_b32 s95, 1
    s_mov_b32 s44, s4
    s_mov_b32 s42, 64
    s_branch M_E_go
M_E:
    s_sub_u32 s44, s44, 9
    s_mov_b32 s42, 4
M_E_go:
    v_mbcnt_lo_u32_b32 v0, -1, 0
    v_mbcnt_hi_u32_b32 v0, -1, v0
    s_mul_hi_u32 s3, s44, 1431655766
    s_mul_i32 s43, s3, 3
    s_sub_u32 s43, s44, s43
    s_mov_b32 s40, s3
    v_lshlrev_b32 v6, 4, v0
    v_lshrrev_b32 v2, 3, v0
    v_lshlrev_b32 v2, 13, v2
    v_and_b32 v3, 7, v0
    v_lshl_add_u32 v2, v3, 4, v2
    v_and_b32 v3, 3, v0
    v_lshrrev_b32 v4, 4, v0
    v_bfe_u32 v5, v0, 2, 2
    v_lshl_add_u32 v5, v4, 3, v5
    v_lshlrev_b32 v5, 6, v5
    v_lshl_add_u32 v5, v3, 3, v5
    v_and_b32 v7, 15, v0
    v_mul_u32_u24 v7, 1152, v7
    v_mul_u32_u24 v8, 24, v4
    v_add_u32 v7, v7, v8
    v_mov_b32 v8, 44
wd_22:
    global_load_dword v9, v8, s[28:29] sc1
    s_waitcnt vmcnt(0)
    v_readfirstlane_b32 s9, v9
    s_cmp_ge_u32 s9, 96
    s_cbranch_scc1 wd_22d
    s_sleep 4
    s_sub_u32 s94, s94, 1
    s_cbranch_scc0 wd_22
    s_mov_b32 s94, 0
wd_22d:
    s_lshl_b32 s7, s43, 2
    s_add_u32 s7, s7, s5
    s_mul_i32 s10, s7, 55296
    s_add_u32 s10, s10, 202375168
    s_add_u32 s11, s10, 18432
    s_add_u32 s12, s10, 36864
    buffer_load_dwordx4 a[0:3], v6, s[84:87], s10 offen offset:0 sc1
    buffer_load_dwordx4 a[4:7], v6, s[84:87], s11 offen offset:0 sc1
    buffer_load_dwordx4 a[8:11], v6, s[84:87], s12 offen offset:0 sc1
    buffer_load_dwordx4 a[12:15], v6, s[84:87], s10 offen offset:1024 sc1
    buffer_load_dwordx4 a[16:19], v6, s[84:87], s11 offen offset:1024 sc1
    buffer_load_dwordx4 a[20:23], v6, s[84:87], s12 offen offset:1024 sc1
    buffer_load_dwordx4 a[24:27], v6, s[84:87], s10 offen offset:2048 sc1
    buffer_load_dwordx4 a[28:31], v6, s[84:87], s11 offen offset:2048 sc1
    buffer_load_dwordx4 a[32:35], v6, s[84:87], s12 offen offset:2048 sc1
    buffer_load_dwordx4 a[36:39], v6, s[84:87], s10 offen offset:3072 sc1
    buffer_load_dwordx4 a[40:43], v6, s[84:87], s11 offen offset:3072 sc1
    buffer_load_dwordx4 a[44:47], v6, s[84:87], s12 offen offset:3072 sc1
    s_add_u32 s10, s10, 4096
    s_add_u32 s11, s11, 4096
    s_add_u32 s12, s12, 4096
    buffer_load_dwordx4 a[48:51], v6, s[84:87], s10 offen offset:0 sc1
    buffer_load_dwordx4 a[52:55], v6, s[84:87], s11 offen offset:0 sc1
    buffer_load_dwordx4 a[56:59], v6, s[84:87], s12 offen offset:0 sc1
    buffer_load_dwordx4 a[60:63], v6, s[84:87], s10 offen offset:1024 sc1
    buffer_load_dwordx4 a[64:67], v6, s[84:87], s11 offen offset:1024 sc1
    buffer_load_dwordx4 a[68:71], v6, s[84:87], s12 offen offset:1024 sc1
    buffer_load_dwordx4 a[72:75], v6, s[84:87], s10 offen offset:2048 sc1
    buffer_load_dwordx4 a[76:79], v6, s[84:87], s11 offen offset:2048 sc1
    buffer_load_dwordx4 a[80:83], v6, s[84:87], s12 offen offset:2048 sc1
    buffer_load_dwordx4 a[84:87], v6, s[84:87], s10 offen offset:3072 sc1
    buffer_load_dwordx4 a[88:91], v6, s[84:87], s11 offen offset:3072 sc1
    buffer_load_dwordx4 a[92:95], v6, s[84:87], s12 offen offset:3072 sc1
    s_add_u32 s10, s10, 4096
    s_add_u32 s11, s11, 4096
    s_add_u32 s12, s12, 4096
    buffer_load_dwordx4 a[96:99], v6, s[84:87], s10 offen offset:0 sc1
    buffer_load_dwordx4 a[100:103], v6, s[84:87], s11 offen offset:0 sc1
    buffer_load_dwordx4 a[104:107], v6, s[84:87], s12 offen offset:0 sc1
    buffer_load_dwordx4 a[108:111], v6, s[84:87], s10 offen offset:1024 sc1
    buffer_load_dwordx4 a[112:115], v6, s[84:87], s11 offen offset:1024 sc1
    buffer_load_dwordx4 a[116:119], v6, s[84:87], s12 offen offset:1024 sc1
    buffer_load_dwordx4 a[120:123], v6, s[84:87], s10 offen offset:2048 sc1
    buffer_load_dwordx4 a[124:127], v6, s[84:87], s11 offen offset:2048 sc1
    buffer_load_dwordx4 a[128:131], v6, s[84:87], s12 offen offset:2048 sc1
    buffer_load_dwordx4 a[132:135], v6, s[84:87], s10 offen offset:3072 sc1
    buffer_load_dwordx4 a[136:139], v6, s[84:87], s11 offen offset:3072 sc1
    buffer_load_dwordx4 a[140:143], v6, s[84:87], s12 offen offset:3072 sc1
    s_add_u32 s10, s10, 4096
    s_add_u32 s11, s11, 4096
    s_add_u32 s12, s12, 4096
    buffer_load_dwordx4 a[144:147], v6, s[84:87], s10 offen offset:0 sc1
    buffer_load_dwordx4 a[148:151], v6, s[84:87], s11 offen offset:0 sc1
    buffer_load_dwordx4 a[152:155], v6, s[84:87], s12 offen offset:0 sc1
    buffer_load_dwordx4 a[156:159], v6, s[84:87], s10 offen offset:1024 sc1
    buffer_load_dwordx4 a[160:163], v6, s[84:87], s11 offen offset:1024 sc1
    buffer_load_dwordx4 a[164:167], v6, s[84:87], s12 offen offset:1024 sc1
    buffer_load_dwordx4 a[168:171], v6, s[84:87], s10 offen offset:2048 sc1
    buffer_load_dwordx4 a[172:175], v6, s[84:87], s11 offen offset:2048 sc1
    buffer_load_dwordx4 a[176:179], v6, s[84:87], s12 offen offset:2048 sc1
    buffer_load_dwordx4 a[180:183], v6, s[84:87], s10 offen offset:3072 sc1
    buffer_load_dwordx4 a[184:187], v6, s[84:87], s11 offen offset:3072 sc1
    buffer_load_dwordx4 a[188:191], v6, s[84:87], s12 offen offset:3072 sc1
    s_add_u32 s10, s10, 4096
    s_add_u32 s11, s11, 4096
    s_add_u32 s12, s12, 4096
    buffer_load_dwordx4 a[192:195], v6, s[84:87], s10 offen offset:0 sc1
    buffer_load_dwordx4 a[196:199], v6, s[84:87], s11 offen offset:0 sc1
    buffer_load_dwordx4 a[200:203], v6, s[84:87], s12 offen offset:0 sc1
    buffer_load_dwordx4 a[204:207], v6, s[84:87], s10 offen offset:1024 sc1
    buffer_load_dwordx4 a[208:211], v6, s[84:87], s11 offen offset:1024 sc1
    buffer_load_dwordx4 a[212:215], v6, s[84:87], s12 offen offset:1024 sc1
M_E_layer:
    s_load_dwordx2 s[18:19], s[0:1], 80
    s_add_u32 s16, s84, 197132288
    s_addc_u32 s17, s85, 0
    s_waitcnt lgkmcnt(0)
    s_cmp_eq_u32 s95, 0
    s_cselect_b32 s18, s16, s18
    s_cselect_b32 s19, s17, s19
    s_mov_b32 s80, s18
    s_and_b32 s81, s19, 0xffff
    s_mov_b32 s82, 2359296
    s_mov_b32 s83, 0x00020000
    s_mov_b32 s6, 93915136
    s_cmp_lg_u32 s5, 1
    s_cbranch_scc1 wf_23d
    v_lshrrev_b32 v8, 2, v6
    v_min_u32 v8, 32, v8
wf_23:
    buffer_load_dword v9, v8, s[20:23], s6 offen sc1
    s_waitcnt vmcnt(0)
    v_cmp_gt_u32 vcc, 1, v9
    s_cbranch_vccz wf_23d
    s_sleep 2
    s_sub_u32 s94, s94, 1
    s_cbranch_scc0 wf_23
    s_mov_b32 s94, 0
wf_23d:
    s_barrier
    s_getpc_b64 s[8:9]
wm_24:
    s_add_u32 s8, s8, M_E_loop-wm_24
    s_addc_u32 s9, s9, 0
    v_lshlrev_b32 v8, 3, v6
    v_add_u32 v8, 0, v8
    v_min_u32 v8, M_E_n-M_E_loop, v8
    global_load_dword v9, v8, s[8:9]
    s_waitcnt vmcnt(0)
    s_mov_b32 s6, 93917184
    s_cmp_lg_u32 s5, 1
    s_cbranch_scc1 wf_25d
    v_lshlrev_b32 v8, 1, v6
    v_add_u32 v10, 2048, v8
    v_min_u32 v10, 2304, v10
wf_25:
    buffer_load_dword v9, v8, s[20:23], s6 offen sc1
    buffer_load_dword v11, v10, s[20:23], s6 offen sc1
    s_waitcnt vmcnt(0)
    v_min_u32 v9, v9, v11
    v_cmp_gt_u32 vcc, 1, v9
    s_cbranch_vccz wf_25d
    s_sleep 2
    s_sub_u32 s94, s94, 1
    s_cbranch_scc0 wf_25
    s_mov_b32 s94, 0
wf_25d:
    s_barrier
    s_mov_b32 s14, 0
    s_mov_b32 s39, 0
    v_mov_b32 v12, v5
    s_mul_i32 s6, s5, 589824
    s_lshl_b32 s9, s3, 7
    s_add_u32 s6, s6, s9
    s_add_u32 s6, s6, 90177536
    s_mul_i32 s9, s5, 9216
    s_add_u32 s9, s9, s14
    s_xor_b32 s14, s14, 36864
    s_mov_b32 m0, s9
    s_nop 0
    buffer_load_dwordx4 v2, s[20:23], s6 offen sc1 lds
    s_add_u32 s6, s6, 65536
    s_add_u32 s9, s9, 1024
    s_mov_b32 m0, s9
    s_nop 0
    buffer_load_dwordx4 v2, s[20:23], s6 offen sc1 lds
    s_add_u32 s6, s6, 65536
    s_add_u32 s9, s9, 1024
    s_mov_b32 m0, s9
    s_nop 0
    buffer_load_dwordx4 v2, s[20:23], s6 offen sc1 lds
    s_add_u32 s6, s6, 65536
    s_add_u32 s9, s9, 1024
    s_mov_b32 m0, s9
    s_nop 0
    buffer_load_dwordx4 v2, s[20:23], s6 offen sc1 lds
    s_add_u32 s6, s6, 65536
    s_add_u32 s9, s9, 1024
    s_mov_b32 m0, s9
    s_nop 0
    buffer_load_dwordx4 v2, s[20:23], s6 offen sc1 lds
    s_add_u32 s6, s6, 65536
    s_add_u32 s9, s9, 1024
    s_mov_b32 m0, s9
    s_nop 0
    buffer_load_dwordx4 v2, s[20:23], s6 offen sc1 lds
    s_add_u32 s6, s6, 65536
    s_add_u32 s9, s9, 1024
    s_mov_b32 m0, s9
    s_nop 0
    buffer_load_dwordx4 v2, s[20:23], s6 offen sc1 lds
    s_add_u32 s6, s6, 65536
    s_add_u32 s9, s9, 1024
    s_mov_b32 m0, s9
    s_nop 0
    buffer_load_dwordx4 v2, s[20:23], s6 offen sc1 lds
    s_add_u32 s6, s6, 65536
    s_add_u32 s9, s9, 1024
    s_mov_b32 m0, s9
    s_nop 0
    buffer_load_dwordx4 v2, s[20:23], s6 offen sc1 lds
M_E_loop:
    s_mul_i32 s10, s3, 36864
    s_mul_i32 s11, s7, 96
    s_add_u32 s10, s10, s11
    s_add_u32 s11, s10, 18432
    s_add_u32 s12, s10, 83886080
    s_add_u32 s13, s11, 83886080
    buffer_load_dwordx4 v[48:51], v7, s[20:23], s12 offen sc1
    buffer_load_dwordx2 v[52:53], v7, s[20:23], s12 offen offset:16 sc1
    buffer_load_dwordx4 v[54:57], v7, s[20:23], s13 offen sc1
    buffer_load_dwordx2 v[58:59], v7, s[20:23], s13 offen offset:16 sc1
    s_add_u32 s15, s3, s42
    s_cmp_lt_u32 s15, 64
    s_cbranch_scc1 M_E_pf
    s_waitcnt vmcnt(4)
    s_branch M_E_c
M_E_pf:
    s_mul_i32 s6, s5, 589824
    s_lshl_b32 s9, s15, 7
    s_add_u32 s6, s6, s9
    s_add_u32 s6, s6, 90177536
    s_mul_i32 s9, s5, 9216
    s_add_u32 s9, s9, s14
    s_xor_b32 s14, s14, 36864
    s_mov_b32 m0, s9
    s_nop 0
    buffer_load_dwordx4 v2, s[20:23], s6 offen sc1 lds
    s_add_u32 s6, s6, 65536
    s_add_u32 s9, s9, 1024
    s_mov_b32 m0, s9
    s_nop 0
    buffer_load_dwordx4 v2, s[20:23], s6 offen sc1 lds
    s_add_u32 s6, s6, 65536
    s_add_u32 s9, s9, 1024
    s_mov_b32 m0, s9
    s_nop 0
    buffer_load_dwordx4 v2, s[20:23], s6 offen sc1 lds
    s_add_u32 s6, s6, 65536
    s_add_u32 s9, s9, 1024
    s_mov_b32 m0, s9
    s_nop 0
    buffer_load_dwordx4 v2, s[20:23], s6 offen sc1 lds
    s_add_u32 s6, s6, 65536
    s_add_u32 s9, s9, 1024
    s_mov_b32 m0, s9
    s_nop 0
    buffer_load_dwordx4 v2, s[20:23], s6 offen sc1 lds
    s_add_u32 s6, s6, 65536
    s_add_u32 s9, s9, 1024
    s_mov_b32 m0, s9
    s_nop 0
    buffer_load_dwordx4 v2, s[20:23], s6 offen sc1 lds
    s_add_u32 s6, s6, 65536
    s_add_u32 s9, s9, 1024
    s_mov_b32 m0, s9
    s_nop 0
    buffer_load_dwordx4 v2, s[20:23], s6 offen sc1 lds
    s_add_u32 s6, s6, 65536
    s_add_u32 s9, s9, 1024
    s_mov_b32 m0, s9
    s_nop 0
    buffer_load_dwordx4 v2, s[20:23], s6 offen sc1 lds
    s_add_u32 s6, s6, 65536
    s_add_u32 s9, s9, 1024
    s_mov_b32 m0, s9
    s_nop 0
    buffer_load_dwordx4 v2, s[20:23], s6 offen sc1 lds
    s_waitcnt vmcnt(13)
M_E_c:
    s_barrier
    ds_read_b64_tr_b16 v[16:17], v12 offset:0
    ds_read_b64_tr_b16 v[18:19], v12 offset:256
    ds_read_b64_tr_b16 v[20:21], v12 offset:32
    ds_read_b64_tr_b16 v[22:23], v12 offset:288
    ds_read_b64_tr_b16 v[24:25], v12 offset:2048
    ds_read_b64_tr_b16 v[26:27], v12 offset:2304
    ds_read_b64_tr_b16 v[28:29], v12 offset:2080
    ds_read_b64_tr_b16 v[30:31], v12 offset:2336
    ds_read_b64_tr_b16 v[32:33], v12 offset:4096
    ds_read_b64_tr_b16 v[34:35], v12 offset:4352
    ds_read_b64_tr_b16 v[36:37], v12 offset:4128
    ds_read_b64_tr_b16 v[38:39], v12 offset:4384
    ds_read_b64_tr_b16 v[40:41], v12 offset:6144
    ds_read_b64_tr_b16 v[42:43], v12 offset:6400
    ds_read_b64_tr_b16 v[44:45], v12 offset:6176
    ds_read_b64_tr_b16 v[46:47], v12 offset:6432
    s_waitcnt lgkmcnt(12)
    v_mfma_f32_16x16x32_bf16 v[64:67], a[0:3], v[16:19], 0
    v_mfma_f32_16x16x32_bf16 v[68:71], a[4:7], v[16:19], 0
    v_mfma_f32_16x16x32_bf16 v[72:75], a[8:11], v[16:19], 0
    v_mfma_f32_16x16x32_bf16 v[76:79], a[0:3], v[20:23], 0
    v_mfma_f32_16x16x32_bf16 v[80:83], a[4:7], v[20:23], 0
    v_mfma_f32_16x16x32_bf16 v[84:87], a[8:11], v[20:23], 0
    ds_read_b64_tr_b16 v[16:17], v12 offset:8192
    ds_read_b64_tr_b16 v[18:19], v12 offset:8448
    ds_read_b64_tr_b16 v[20:21], v12 offset:8224
    ds_read_b64_tr_b16 v[22:23], v12 offset:8480
    s_waitcnt lgkmcnt(12)
    v_mfma_f32_16x16x32_bf16 v[64:67], a[12:15], v[24:27], v[64:67]
    v_mfma_f32_16x16x32_bf16 v[68:71], a[16:19], v[24:27], v[68:71]
    v_mfma_f32_16x16x32_bf16 v[72:75], a[20:23], v[24:27], v[72:75]
    v_mfma_f32_16x16x32_bf16 v[76:79], a[12:15], v[28:31], v[76:79]
    v_mfma_f32_16x16x32_bf16 v[80:83], a[16:19], v[28:31], v[80:83]
    v_mfma_f32_16x16x32_bf16 v[84:87], a[20:23], v[28:31], v[84:87]
    ds_read_b64_tr_b16 v[24:25], v12 offset:10240
    ds_read_b64_tr_b16 v[26:27], v12 offset:10496
    ds_read_b64_tr_b16 v[28:29], v12 offset:10272
    ds_read_b64_tr_b16 v[30:31], v12 offset:10528
    s_waitcnt lgkmcnt(12)
    v_mfma_f32_16x16x32_bf16 v[64:67], a[24:27], v[32:35], v[64:67]
    v_mfma_f32_16x16x32_bf16 v[68:71], a[28:31], v[32:35], v[68:71]
    v_mfma_f32_16x16x32_bf16 v[72:75], a[32:35], v[32:35], v[72:75]
    v_mfma_f32_16x16x32_bf16 v[76:79], a[24:27], v[36:39], v[76:79]
    v_mfma_f32_16x16x32_bf16 v[80:83], a[28:31], v[36:39], v[80:83]
    v_mfma_f32_16x16x32_bf16 v[84:87], a[32:35], v[36:39], v[84:87]
    ds_read_b64_tr_b16 v[32:33], v12 offset:12288
    ds_read_b64_tr_b16 v[34:35], v12 offset:12544
    ds_read_b64_tr_b16 v[36:37], v12 offset:12320
    ds_read_b64_tr_b16 v[38:39], v12 offset:12576
    s_waitcnt lgkmcnt(12)
    v_mfma_f32_16x16x32_bf16 v[64:67], a[36:39], v[40:43], v[64:67]
    v_mfma_f32_16x16x32_bf16 v[68:71], a[40:43], v[40:43], v[68:71]
    v_mfma_f32_16x16x32_bf16 v[72:75], a[44:47], v[40:43], v[72:75]
    v_mfma_f32_16x16x32_bf16 v[76:79], a[36:39], v[44:47], v[76:79]
    v_mfma_f32_16x16x32_bf16 v[80:83], a[40:43], v[44:47], v[80:83]
    v_mfma_f32_16x16x32_bf16 v[84:87], a[44:47], v[44:47], v[84:87]
    ds_read_b64_tr_b16 v[40:41], v12 offset:14336
    ds_read_b64_tr_b16 v[42:43], v12 offset:14592
    ds_read_b64_tr_b16 v[44:45], v12 offset:14368
    ds_read_b64_tr_b16 v[46:47], v12 offset:14624
    s_waitcnt lgkmcnt(12)
    v_mfma_f32_16x16x32_bf16 v[64:67], a[48:51], v[16:19], v[64:67]
    v_mfma_f32_16x16x32_bf16 v[68:71], a[52:55], v[16:19], v[68:71]
    v_mfma_f32_16x16x32_bf16 v[72:75], a[56:59], v[16:19], v[72:75]
    v_mfma_f32_16x16x32_bf16 v[76:79], a[48:51], v[20:23], v[76:79]
    v_mfma_f32_16x16x32_bf16 v[80:83], a[52:55], v[20:23], v[80:83]
    v_mfma_f32_16x16x32_bf16 v[84:87], a[56:59], v[20:23], v[84:87]
    ds_read_b64_tr_b16 v[16:17], v12 offset:16384
    ds_read_b64_tr_b16 v[18:19], v12 offset:16640
    ds_read_b64_tr_b16 v[20:21], v12 offset:16416
    ds_read_b64_tr_b16 v[22:23], v12 offset:16672
    s_waitcnt lgkmcnt(12)
    v_mfma_f32_16x16x32_bf16 v[64:67], a[60:63], v[24:27], v[64:67]
    v_mfma_f32_16x16x32_bf16 v[68:71], a[64:67], v[24:27], v[68:71]
    v_mfma_f32_16x16x32_bf16 v[72:75], a[68:71], v[24:27], v[72:75]
    v_mfma_f32_16x16x32_bf16 v[76:79], a[60:63], v[28:31], v[76:79]
    v_mfma_f32_16x16x32_bf16 v[80:83], a[64:67], v[28:31], v[80:83]
    v_mfma_f32_16x16x32_bf16 v[84:87], a[68:71], v[28:31], v[84:87]
    ds_read_b64_tr_b16 v[24:25], v12 offset:18432
    ds_read_b64_tr_b16 v[26:27], v12 offset:18688
    ds_read_b64_tr_b16 v[28:29], v12 offset:18464
    ds_read_b64_tr_b16 v[30:31], v12 offset:18720
    s_waitcnt lgkmcnt(12)
    v_mfma_f32_16x16x32_bf16 v[64:67], a[72:75], v[32:35], v[64:67]
    v_mfma_f32_16x16x32_bf16 v[68:71], a[76:79], v[32:35], v[68:71]
    v_mfma_f32_16x16x32_bf16 v[72:75], a[80:83], v[32:35], v[72:75]
    v_mfma_f32_16x16x32_bf16 v[76:79], a[72:75], v[36:39], v[76:79]
    v_mfma_f32_16x16x32_bf16 v[80:83], a[76:79], v[36:39], v[80:83]
    v_mfma_f32_16x16x32_bf16 v[84:87], a[80:83], v[36:39], v[84:87]
    ds_read_b64_tr_b16 v[32:33], v12 offset:20480
    ds_read_b64_tr_b16 v[34:35], v12 offset:20736
    ds_read_b64_tr_b16 v[36:37], v12 offset:20512
    ds_read_b64_tr_b16 v[38:39], v12 offset:20768
    s_waitcnt lgkmcnt(12)
    v_mfma_f32_16x16x32_bf16 v[64:67], a[84:87], v[40:43], v[64:67]
    v_mfma_f32_16x16x32_bf16 v[68:71], a[88:91], v[40:43], v[68:71]
    v_mfma_f32_16x16x32_bf16 v[72:75], a[92:95], v[40:43], v[72:75]
    v_mfma_f32_16x16x32_bf16 v[76:79], a[84:87], v[44:47], v[76:79]
    v_mfma_f32_16x16x32_bf16 v[80:83], a[88:91], v[44:47], v[80:83]
    v_mfma_f32_16x16x32_bf16 v[84:87], a[92:95], v[44:47], v[84:87]
    ds_read_b64_tr_b16 v[40:41], v12 offset:22528
    ds_read_b64_tr_b16 v[42:43], v12 offset:22784
    ds_read_b64_tr_b16 v[44:45], v12 offset:22560
    ds_read_b64_tr_b16 v[46:47], v12 offset:22816
    s_waitcnt lgkmcnt(12)
    v_mfma_f32_16x16x32_bf16 v[64:67], a[96:99], v[16:19], v[64:67]
    v_mfma_f32_16x16x32_bf16 v[68:71], a[100:103], v[16:19], v[68:71]
    v_mfma_f32_16x16x32_bf16 v[72:75], a[104:107], v[16:19], v[72:75]
    v_mfma_f32_16x16x32_bf16 v[76:79], a[96:99], v[20:23], v[76:79]
    v_mfma_f32_16x16x32_bf16 v[80:83], a[100:103], v[20:23], v[80:83]
    v_mfma_f32_16x16x32_bf16 v[84:87], a[104:107], v[20:23], v[84:87]
    ds_read_b64_tr_b16 v[16:17], v12 offset:24576
    ds_read_b64_tr_b16 v[18:19], v12 offset:24832
    ds_read_b64_tr_b16 v[20:21], v12 offset:24608
    ds_read_b64_tr_b16 v[22:23], v12 offset:24864
    s_waitcnt lgkmcnt(12)
    v_mfma_f32_16x16x32_bf16 v[64:67], a[108:111], v[24:27], v[64:67]
    v_mfma_f32_16x16x32_bf16 v[68:71], a[112:115], v[24:27], v[68:71]
    v_mfma_f32_16x16x32_bf16 v[72:75], a[116:119], v[24:27], v[72:75]
    v_mfma_f32_16x16x32_bf16 v[76:79], a[108:111], v[28:31], v[76:79]
    v_mfma_f32_16x16x32_bf16 v[80:83], a[112:115], v[28:31], v[80:83]
    v_mfma_f32_16x16x32_bf16 v[84:87], a[116:119], v[28:31], v[84:87]
    ds_read_b64_tr_b16 v[24:25], v12 offset:26624
    ds_read_b64_tr_b16 v[26:27], v12 offset:26880
    ds_read_b64_tr_b16 v[28:29], v12 offset:26656
    ds_read_b64_tr_b16 v[30:31], v12 offset:26912
    s_waitcnt lgkmcnt(12)
    v_mfma_f32_16x16x32_bf16 v[64:67], a[120:123], v[32:35], v[64:67]
    v_mfma_f32_16x16x32_bf16 v[68:71], a[124:127], v[32:35], v[68:71]
    v_mfma_f32_16x16x32_bf16 v[72:75], a[128:131], v[32:35], v[72:75]
    v_mfma_f32_16x16x32_bf16 v[76:79], a[120:123], v[36:39], v[76:79]
    v_mfma_f32_16x16x32_bf16 v[80:83], a[124:127], v[36:39], v[80:83]
    v_mfma_f32_16x16x32_bf16 v[84:87], a[128:131], v[36:39], v[84:87]
    ds_read_b64_tr_b16 v[32:33], v12 offset:28672
    ds_read_b64_tr_b16 v[34:35], v12 offset:28928
    ds_read_b64_tr_b16 v[36:37], v12 offset:28704
    ds_read_b64_tr_b16 v[38:39], v12 offset:28960
    s_waitcnt lgkmcnt(12)
    v_mfma_f32_16x16x32_bf16 v[64:67], a[132:135], v[40:43], v[64:67]
    v_mfma_f32_16x16x32_bf16 v[68:71], a[136:139], v[40:43], v[68:71]
    v_mfma_f32_16x16x32_bf16 v[72:75], a[140:143], v[40:43], v[72:75]
    v_mfma_f32_16x16x32_bf16 v[76:79], a[132:135], v[44:47], v[76:79]
    v_mfma_f32_16x16x32_bf16 v[80:83], a[136:139], v[44:47], v[80:83]
    v_mfma_f32_16x16x32_bf16 v[84:87], a[140:143], v[44:47], v[84:87]
    ds_read_b64_tr_b16 v[40:41], v12 offset:30720
    ds_read_b64_tr_b16 v[42:43], v12 offset:30976
    ds_read_b64_tr_b16 v[44:45], v12 offset:30752
    ds_read_b64_tr_b16 v[46:47], v12 offset:31008
    s_waitcnt lgkmcnt(12)
    v_mfma_f32_16x16x32_bf16 v[64:67], a[144:147], v[16:19], v[64:67]
    v_mfma_f32_16x16x32_bf16 v[68:71], a[148:151], v[16:19], v[68:71]
    v_mfma_f32_16x16x32_bf16 v[72:75], a[152:155], v[16:19], v[72:75]
    v_mfma_f32_16x16x32_bf16 v[76:79], a[144:147], v[20:23], v[76:79]
    v_mfma_f32_16x16x32_bf16 v[80:83], a[148:151], v[20:23], v[80:83]
    v_mfma_f32_16x16x32_bf16 v[84:87], a[152:155], v[20:23], v[84:87]
    ds_read_b64_tr_b16 v[16:17], v12 offset:32768
    ds_read_b64_tr_b16 v[18:19], v12 offset:33024
    ds_read_b64_tr_b16 v[20:21], v12 offset:32800
    ds_read_b64_tr_b16 v[22:23], v12 offset:33056
    s_waitcnt lgkmcnt(12)
    v_mfma_f32_16x16x32_bf16 v[64:67], a[156:159], v[24:27], v[64:67]
    v_mfma_f32_16x16x32_bf16 v[68:71], a[160:163], v[24:27], v[68:71]
    v_mfma_f32_16x16x32_bf16 v[72:75], a[164:167], v[24:27], v[72:75]
    v_mfma_f32_16x16x32_bf16 v[76:79], a[156:159], v[28:31], v[76:79]
    v_mfma_f32_16x16x32_bf16 v[80:83], a[160:163], v[28:31], v[80:83]
    v_mfma_f32_16x16x32_bf16 v[84:87], a[164:167], v[28:31], v[84:87]
    ds_read_b64_tr_b16 v[24:25], v12 offset:34816
    ds_read_b64_tr_b16 v[26:27], v12 offset:35072
    ds_read_b64_tr_b16 v[28:29], v12 offset:34848
    ds_read_b64_tr_b16 v[30:31], v12 offset:35104
    s_waitcnt lgkmcnt(12)
    v_mfma_f32_16x16x32_bf16 v[64:67], a[168:171], v[32:35], v[64:67]
    v_mfma_f32_16x16x32_bf16 v[68:71], a[172:175], v[32:35], v[68:71]
    v_mfma_f32_16x16x32_bf16 v[72:75], a[176:179], v[32:35], v[72:75]
    v_mfma_f32_16x16x32_bf16 v[76:79], a[168:171], v[36:39], v[76:79]
    v_mfma_f32_16x16x32_bf16 v[80:83], a[172:175], v[36:39], v[80:83]
    v_mfma_f32_16x16x32_bf16 v[84:87], a[176:179], v[36:39], v[84:87]
    s_waitcnt lgkmcnt(8)
    v_mfma_f32_16x16x32_bf16 v[64:67], a[180:183], v[40:43], v[64:67]
    v_mfma_f32_16x16x32_bf16 v[68:71], a[184:187], v[40:43], v[68:71]
    v_mfma_f32_16x16x32_bf16 v[72:75], a[188:191], v[40:43], v[72:75]
    v_mfma_f32_16x16x32_bf16 v[76:79], a[180:183], v[44:47], v[76:79]
    v_mfma_f32_16x16x32_bf16 v[80:83], a[184:187], v[44:47], v[80:83]
    v_mfma_f32_16x16x32_bf16 v[84:87], a[188:191], v[44:47], v[84:87]
    s_waitcnt lgkmcnt(4)
    v_mfma_f32_16x16x32_bf16 v[64:67], a[192:195], v[16:19], v[64:67]
    v_mfma_f32_16x16x32_bf16 v[68:71], a[196:199], v[16:19], v[68:71]
    v_mfma_f32_16x16x32_bf16 v[72:75], a[200:203], v[16:19], v[72:75]
    v_mfma_f32_16x16x32_bf16 v[76:79], a[192:195], v[20:23], v[76:79]
    v_mfma_f32_16x16x32_bf16 v[80:83], a[196:199], v[20:23], v[80:83]
    v_mfma_f32_16x16x32_bf16 v[84:87], a[200:203], v[20:23], v[84:87]
    s_waitcnt lgkmcnt(0)
    v_mfma_f32_16x16x32_bf16 v[64:67], a[204:207], v[24:27], v[64:67]
    v_mfma_f32_16x16x32_bf16 v[68:71], a[208:211], v[24:27], v[68:71]
    v_mfma_f32_16x16x32_bf16 v[72:75], a[212:215], v[24:27], v[72:75]
    v_mfma_f32_16x16x32_bf16 v[76:79], a[204:207], v[28:31], v[76:79]
    v_mfma_f32_16x16x32_bf16 v[80:83], a[208:211], v[28:31], v[80:83]
    v_mfma_f32_16x16x32_bf16 v[84:87], a[212:215], v[28:31], v[84:87]
    s_waitcnt vmcnt(0)
    v_lshlrev_b32 v10, 16, v48
    v_and_b32 v11, 0xffff0000, v48
    v_pk_add_f32 v[10:11], v[10:11], v[64:65]
    v_cvt_pk_bf16_f32 v48, v10, v11
    v_lshlrev_b32 v10, 16, v49
    v_and_b32 v11, 0xffff0000, v49
    v_pk_add_f32 v[10:11], v[10:11], v[66:67]
    v_cvt_pk_bf16_f32 v49, v10, v11
    v_lshlrev_b32 v10, 16, v50
    v_and_b32 v11, 0xffff0000, v50
    v_pk_add_f32 v[10:11], v[10:11], v[68:69]
    v_cvt_pk_bf16_f32 v50, v10, v11
    v_lshlrev_b32 v10, 16, v51
    v_and_b32 v11, 0xffff0000, v51
    v_pk_add_f32 v[10:11], v[10:11], v[70:71]
    v_cvt_pk_bf16_f32 v51, v10, v11
    v_lshlrev_b32 v10, 16, v52
    v_and_b32 v11, 0xffff0000, v52
    v_pk_add_f32 v[10:11], v[10:11], v[72:73]
    v_cvt_pk_bf16_f32 v52, v10, v11
    v_lshlrev_b32 v10, 16, v53
    v_and_b32 v11, 0xffff0000, v53
    v_pk_add_f32 v[10:11], v[10:11], v[74:75]
    v_cvt_pk_bf16_f32 v53, v10, v11
    v_lshlrev_b32 v10, 16, v54
    v_and_b32 v11, 0xffff0000, v54
    v_pk_add_f32 v[10:11], v[10:11], v[76:77]
    v_cvt_pk_bf16_f32 v54, v10, v11
    v_lshlrev_b32 v10, 16, v55
    v_and_b32 v11, 0xffff0000, v55
    v_pk_add_f32 v[10:11], v[10:11], v[78:79]
    v_cvt_pk_bf16_f32 v55, v10, v11
    v_lshlrev_b32 v10, 16, v56
    v_and_b32 v11, 0xffff0000, v56
    v_pk_add_f32 v[10:11], v[10:11], v[80:81]
    v_cvt_pk_bf16_f32 v56, v10, v11
    v_lshlrev_b32 v10, 16, v57
    v_and_b32 v11, 0xffff0000, v57
    v_pk_add_f32 v[10:11], v[10:11], v[82:83]
    v_cvt_pk_bf16_f32 v57, v10, v11
    v_lshlrev_b32 v10, 16, v58
    v_and_b32 v11, 0xffff0000, v58
    v_pk_add_f32 v[10:11], v[10:11], v[84:85]
    v_cvt_pk_bf16_f32 v58, v10, v11
    v_lshlrev_b32 v10, 16, v59
    v_and_b32 v11, 0xffff0000, v59
    v_pk_add_f32 v[10:11], v[10:11], v[86:87]
    v_cvt_pk_bf16_f32 v59, v10, v11
    v_xor_b32 v12, 36864, v12
    s_cmp_eq_u32 s95, 0
    s_cbranch_scc1 M_E_s0
    buffer_store_dwordx4 v[48:51], v7, s[80:83], s10 offen
    buffer_store_dwordx2 v[52:53], v7, s[80:83], s10 offen offset:16
    buffer_store_dwordx4 v[54:57], v7, s[80:83], s11 offen
    buffer_store_dwordx2 v[58:59], v7, s[80:83], s11 offen offset:16
    s_barrier
    s_branch M_E_n
M_E_s0:
    buffer_store_dwordx4 v[48:51], v7, s[80:83], s10 offen sc1
    buffer_store_dwordx2 v[52:53], v7, s[80:83], s10 offen offset:16 sc1
    buffer_store_dwordx4 v[54:57], v7, s[80:83], s11 offen sc1
    buffer_store_dwordx2 v[58:59], v7, s[80:83], s11 offen offset:16 sc1
    s_lshl_b32 s6, s3, 4
    s_lshl_b32 s9, s43, 2
    s_add_u32 s6, s6, s9
    s_add_u32 s6, s6, 194576384
    s_waitcnt vmcnt(0)
    s_barrier
    s_cmp_lg_u32 s5, 0
    s_cbranch_scc1 p2_26b
    v_mov_b32 v10, 2
    s_mov_b64 exec, 1
    buffer_store_dword v10, off, s[20:23], s6 sc1
    s_mov_b64 exec, -1
p2_26b:
M_E_n:
    s_add_u32 s3, s3, s42
    s_cmp_lt_u32 s3, 64
    s_cbranch_scc1 M_E_loop
    s_cmp_eq_u32 s95, 1
    s_cbranch_scc1 M_end
    s_add_u32 s95, s95, 1
    s_add_u32 s20, s20, 100663296
    s_addc_u32 s21, s21, 0
    s_mov_b32 s22, 167772160
    s_add_u32 s24, s20, 96468992
    s_addc_u32 s25, s21, 0
    s_add_u32 s3, s40, 53
    s_mov_b32 s42, 7
    s_branch M_E_layer
M_L5:
    v_mbcnt_lo_u32_b32 v0, -1, 0
    v_mbcnt_hi_u32_b32 v0, -1, v0
    s_lshl_b32 s2, s40, 2
    s_add_u32 s2, s2, s5
    s_waitcnt vmcnt(0) lgkmcnt(0)
    s_barrier
    s_cmp_ge_u32 s40, 73
    s_cbranch_scc1 M_L5_end2
    s_mov_b32 s3, s2
    s_min_u32 s2, s2, 288
    s_lshl_b32 s10, s5, 13
    v_lshlrev_b32 v32, 4, v0
    v_lshrrev_b32 v33, 5, v0
    v_bfe_u32 v34, v0, 2, 2
    v_lshl_add_u32 v33, v33, 2, v34
    v_lshlrev_b32 v33, 8, v33
    v_and_b32 v34, 1, v0
    v_lshl_add_u32 v33, v34, 7, v33
    v_bfe_u32 v34, v0, 4, 1
    v_lshl_add_u32 v33, v34, 4, v33
    v_bfe_u32 v34, v0, 1, 1
    v_lshl_add_u32 v33, v34, 3, v33
    s_mov_b32 s14, -1
    s_cmp_eq_u32 s2, 0
    s_cselect_b32 s6, 1, 0
    s_cselect_b32 s14, 0x0f0f0f0f, s14
    s_cmp_eq_u32 s2, 288
    s_cselect_b32 s6, 1, s6
    s_cselect_b32 s14, 0xf0f0f0f0, s14
    s_cselect_b32 s12, 0, s2
    s_cselect_b32 s13, 64, 0
    s_mov_b32 s15, s14
    s_lshl_b32 s12, s12, 13
    s_add_u32 s11, s10, s13
    v_add_u32 v33, s11, v33
    v_and_b32 v35, 31, v0
    v_lshlrev_b32 v35, 8, v35
    v_lshrrev_b32 v34, 5, v0
    v_lshl_add_u32 v35, v34, 7, v35
    v_and_b32 v34, 7, v0
    v_lshl_add_u32 v35, v34, 4, v35
    v_xor_b32 v35, s13, v35
    v_add_u32 v35, s10, v35
    v_lshrrev_b32 v34, 4, v0
    v_lshlrev_b32 v34, 4, v34
    v_xor_b32 v36, v32, v34
    v_add_u32 v36, s10, v36
    v_xor_b32 v37, 64, v36
    s_getpc_b64 s[8:9]
wm_27:
    s_add_u32 s8, s8, M_L5_c0-wm_27
    s_addc_u32 s9, s9, 0
    v_lshlrev_b32 v38, 3, v32
    v_add_u32 v38, 0, v38
    v_min_u32 v38, M_L5_end-M_L5_c0, v38
    global_load_dword v39, v38, s[8:9]
    s_waitcnt vmcnt(0)
    v_mov_b32 v38, 48
wd_28:
    global_load_dword v39, v38, s[28:29] sc1
    s_waitcnt vmcnt(0)
    v_readfirstlane_b32 s9, v39
    s_cmp_ge_u32 s9, 87
    s_cbranch_scc1 wd_28d
    s_sleep 4
    s_sub_u32 s94, s94, 1
    s_cbranch_scc0 wd_28
    s_mov_b32 s94, 0
wd_28d:
    s_mov_b32 s8, 206602240
    buffer_load_dwordx4 a[0:3], v32, s[84:87], s8 offen offset:0 sc1
    buffer_load_dwordx4 a[4:7], v32, s[84:87], s8 offen offset:1024 sc1
    buffer_load_dwordx4 a[8:11], v32, s[84:87], s8 offen offset:2048 sc1
    buffer_load_dwordx4 a[12:15], v32, s[84:87], s8 offen offset:3072 sc1
    s_add_u32 s8, s8, 4096
    buffer_load_dwordx4 a[16:19], v32, s[84:87], s8 offen offset:0 sc1
    buffer_load_dwordx4 a[20:23], v32, s[84:87], s8 offen offset:1024 sc1
    buffer_load_dwordx4 a[24:27], v32, s[84:87], s8 offen offset:2048 sc1
    buffer_load_dwordx4 a[28:31], v32, s[84:87], s8 offen offset:3072 sc1
    s_add_u32 s8, s8, 4096
    buffer_load_dwordx4 a[32:35], v32, s[84:87], s8 offen offset:0 sc1
    buffer_load_dwordx4 a[36:39], v32, s[84:87], s8 offen offset:1024 sc1
    buffer_load_dwordx4 a[40:43], v32, s[84:87], s8 offen offset:2048 sc1
    buffer_load_dwordx4 a[44:47], v32, s[84:87], s8 offen offset:3072 sc1
    s_add_u32 s8, s8, 4096
    buffer_load_dwordx4 a[48:51], v32, s[84:87], s8 offen offset:0 sc1
    buffer_load_dwordx4 a[52:55], v32, s[84:87], s8 offen offset:1024 sc1
    buffer_load_dwordx4 a[56:59], v32, s[84:87], s8 offen offset:2048 sc1
    buffer_load_dwordx4 a[60:63], v32, s[84:87], s8 offen offset:3072 sc1
    s_add_u32 s8, s8, 4096
    buffer_load_dwordx4 a[64:67], v32, s[84:87], s8 offen offset:0 sc1
    buffer_load_dwordx4 a[68:71], v32, s[84:87], s8 offen offset:1024 sc1
    buffer_load_dwordx4 a[72:75], v32, s[84:87], s8 offen offset:2048 sc1
    buffer_load_dwordx4 a[76:79], v32, s[84:87], s8 offen offset:3072 sc1
    s_add_u32 s8, s8, 4096
    buffer_load_dwordx4 a[80:83], v32, s[84:87], s8 offen offset:0 sc1
    buffer_load_dwordx4 a[84:87], v32, s[84:87], s8 offen offset:1024 sc1
    s_mov_b32 s8, 206569472
    buffer_load_dwordx4 v[176:179], v32, s[84:87], s8 offen offset:0 sc1
    buffer_load_dwordx4 v[180:183], v32, s[84:87], s8 offen offset:1024 sc1
    buffer_load_dwordx4 v[184:187], v32, s[84:87], s8 offen offset:2048 sc1
    buffer_load_dwordx4 v[188:191], v32, s[84:87], s8 offen offset:3072 sc1
    s_add_u32 s8, s8, 4096
    buffer_load_dwordx4 v[192:195], v32, s[84:87], s8 offen offset:0 sc1
    buffer_load_dwordx4 v[196:199], v32, s[84:87], s8 offen offset:1024 sc1
    buffer_load_dwordx4 v[200:203], v32, s[84:87], s8 offen offset:2048 sc1
    buffer_load_dwordx4 v[204:207], v32, s[84:87], s8 offen offset:3072 sc1
    s_add_u32 s8, s8, 4096
    buffer_load_dwordx4 v[208:211], v32, s[84:87], s8 offen offset:0 sc1
    buffer_load_dwordx4 v[212:215], v32, s[84:87], s8 offen offset:1024 sc1
    buffer_load_dwordx4 v[216:219], v32, s[84:87], s8 offen offset:2048 sc1
    buffer_load_dwordx4 v[220:223], v32, s[84:87], s8 offen offset:3072 sc1
    s_add_u32 s8, s8, 4096
    buffer_load_dwordx4 v[224:227], v32, s[84:87], s8 offen offset:0 sc1
    buffer_load_dwordx4 v[228:231], v32, s[84:87], s8 offen offset:1024 sc1
    buffer_load_dwordx4 v[232:235], v32, s[84:87], s8 offen offset:2048 sc1
    buffer_load_dwordx4 v[236:239], v32, s[84:87], s8 offen offset:3072 sc1
    s_add_u32 s8, s8, 4096
    buffer_load_dwordx4 a[96:99], v32, s[84:87], s8 offen offset:0 sc1
    buffer_load_dwordx4 a[100:103], v32, s[84:87], s8 offen offset:1024 sc1
    buffer_load_dwordx4 a[104:107], v32, s[84:87], s8 offen offset:2048 sc1
    buffer_load_dwordx4 a[108:111], v32, s[84:87], s8 offen offset:3072 sc1
    s_add_u32 s8, s8, 4096
    buffer_load_dwordx4 a[112:115], v32, s[84:87], s8 offen offset:0 sc1
    buffer_load_dwordx4 a[116:119], v32, s[84:87], s8 offen offset:1024 sc1
    buffer_load_dwordx4 a[120:123], v32, s[84:87], s8 offen offset:2048 sc1
    buffer_load_dwordx4 a[124:127], v32, s[84:87], s8 offen offset:3072 sc1
    s_add_u32 s8, s8, 4096
    buffer_load_dwordx4 a[128:131], v32, s[84:87], s8 offen offset:0 sc1
    buffer_load_dwordx4 a[132:135], v32, s[84:87], s8 offen offset:1024 sc1
    buffer_load_dwordx4 a[136:139], v32, s[84:87], s8 offen offset:2048 sc1
    buffer_load_dwordx4 a[140:143], v32, s[84:87], s8 offen offset:3072 sc1
    s_add_u32 s8, s8, 4096
    buffer_load_dwordx4 a[144:147], v32, s[84:87], s8 offen offset:0 sc1
    buffer_load_dwordx4 a[148:151], v32, s[84:87], s8 offen offset:1024 sc1
    buffer_load_dwordx4 a[152:155], v32, s[84:87], s8 offen offset:2048 sc1
    buffer_load_dwordx4 a[156:159], v32, s[84:87], s8 offen offset:3072 sc1
    s_add_u32 s8, s8, 4096
    s_lshl_b32 s8, s2, 13
    s_add_u32 s8, s8, 203423744
    buffer_load_dwordx4 v[0:3], v32, s[84:87], s8 offen offset:0 sc1
    buffer_load_dwordx4 v[4:7], v32, s[84:87], s8 offen offset:1024 sc1
    buffer_load_dwordx4 v[8:11], v32, s[84:87], s8 offen offset:2048 sc1
    buffer_load_dwordx4 v[12:15], v32, s[84:87], s8 offen offset:3072 sc1
    s_add_u32 s8, s8, 4096
    buffer_load_dwordx4 v[16:19], v32, s[84:87], s8 offen offset:0 sc1
    buffer_load_dwordx4 v[20:23], v32, s[84:87], s8 offen offset:1024 sc1
    buffer_load_dwordx4 v[24:27], v32, s[84:87], s8 offen offset:2048 sc1
    buffer_load_dwordx4 v[28:31], v32, s[84:87], s8 offen offset:3072 sc1
    s_mov_b32 s7, 93915136
    s_cmp_lg_u32 s5, 1
    s_cbranch_scc1 wf_29d
    v_lshrrev_b32 v38, 2, v32
    v_min_u32 v38, 32, v38
wf_29:
    buffer_load_dword v39, v38, s[20:23], s7 offen sc1
    s_waitcnt vmcnt(0)
    v_cmp_gt_u32 vcc, 1, v39
    s_cbranch_vccz wf_29d
    s_sleep 2
    s_sub_u32 s94, s94, 1
    s_cbranch_scc0 wf_29
    s_mov_b32 s94, 0
wf_29d:
    s_barrier
    s_add_u32 s8, s12, 87031808
    s_mov_b32 m0, s10
    s_nop 0
    buffer_load_dwordx4 v32, s[20:23], s8 offen offset:0 sc1 lds
    buffer_load_dwordx4 v32, s[20:23], s8 offen offset:1024 sc1 lds
    buffer_load_dwordx4 v32, s[20:23], s8 offen offset:2048 sc1 lds
    buffer_load_dwordx4 v32, s[20:23], s8 offen offset:3072 sc1 lds
    s_add_u32 s11, s8, 4096
    s_add_u32 m0, s10, 4096
    s_nop 0
    buffer_load_dwordx4 v32, s[20:23], s11 offen offset:0 sc1 lds
    buffer_load_dwordx4 v32, s[20:23], s11 offen offset:1024 sc1 lds
    buffer_load_dwordx4 v32, s[20:23], s11 offen offset:2048 sc1 lds
    s_waitcnt vmcnt(0)
    ds_read_b64_tr_b16 v[128:129], v33 offset:0
    ds_read_b64_tr_b16 v[130:131], v33 offset:2048
    ds_read_b64_tr_b16 v[136:137], v33 offset:32
    ds_read_b64_tr_b16 v[138:139], v33 offset:2080
    ds_read_b64_tr_b16 v[144:145], v33 offset:64
    ds_read_b64_tr_b16 v[146:147], v33 offset:2112
    ds_read_b64_tr_b16 v[152:153], v33 offset:96
    ds_read_b64_tr_b16 v[154:155], v33 offset:2144
    s_waitcnt lgkmcnt(0)
    s_cmp_eq_u32 s6, 0
    s_cbranch_scc1 M_L5_c0
    v_mov_b32 v144, 0
    v_mov_b32 v145, 0
    v_mov_b32 v146, 0
    v_mov_b32 v147, 0
    v_mov_b32 v152, 0
    v_mov_b32 v153, 0
    v_mov_b32 v154, 0
    v_mov_b32 v155, 0
    s_nop 1
M_L5_c0:
    v_mfma_f32_32x32x16_bf16 v[64:79], v[128:131], a[0:3], 0
    v_mfma_f32_32x32x16_bf16 v[96:111], v[144:147], a[0:3], 0
    v_mfma_f32_32x32x16_bf16 v[64:79], v[144:147], a[8:11], v[64:79]
    v_mfma_f32_32x32x16_bf16 v[96:111], v[128:131], a[16:19], v[96:111]
    v_mfma_f32_32x32x16_bf16 v[80:95], v[136:139], a[0:3], 0
    v_mfma_f32_32x32x16_bf16 v[112:127], v[152:155], a[0:3], 0
    v_mfma_f32_32x32x16_bf16 v[80:95], v[152:155], a[8:11], v[80:95]
    v_mfma_f32_32x32x16_bf16 v[112:127], v[136:139], a[16:19], v[112:127]
    s_cmp_lg_u32 s5, 1
    s_cbranch_scc1 wf_30d
    v_lshrrev_b32 v38, 2, v32
    v_min_u32 v38, 32, v38
wf_30:
    buffer_load_dword v39, v38, s[20:23], s7 offen sc1
    s_waitcnt vmcnt(0)
    v_cmp_gt_u32 vcc, 2, v39
    s_cbranch_vccz wf_30d
    s_sleep 2
    s_sub_u32 s94, s94, 1
    s_cbranch_scc0 wf_30
    s_mov_b32 s94, 0
wf_30d:
    s_barrier
    buffer_load_dwordx4 v32, s[20:23], s11 offen offset:3072 sc1 lds
    s_waitcnt vmcnt(0)
    s_cmp_ge_u32 s3, 289
    s_cbranch_scc1 M_L5_end2
    ds_read_b64_tr_b16 v[132:133], v33 offset:4096
    ds_read_b64_tr_b16 v[134:135], v33 offset:6144
    ds_read_b64_tr_b16 v[140:141], v33 offset:4128
    ds_read_b64_tr_b16 v[142:143], v33 offset:6176
    ds_read_b64_tr_b16 v[148:149], v33 offset:4160
    ds_read_b64_tr_b16 v[150:151], v33 offset:6208
    ds_read_b64_tr_b16 v[156:157], v33 offset:4192
    ds_read_b64_tr_b16 v[158:159], v33 offset:6240
    s_waitcnt lgkmcnt(0)
    s_cmp_eq_u32 s6, 0
    s_cbranch_scc1 M_L5_c1
    v_mov_b32 v148, 0
    v_mov_b32 v149, 0
    v_mov_b32 v150, 0
    v_mov_b32 v151, 0
    v_mov_b32 v156, 0
    v_mov_b32 v157, 0
    v_mov_b32 v158, 0
    v_mov_b32 v159, 0
    s_nop 1
M_L5_c1:
    v_mfma_f32_32x32x16_bf16 v[64:79], v[132:135], a[4:7], v[64:79]
    v_mfma_f32_32x32x16_bf16 v[96:111], v[148:151], a[4:7], v[96:111]
    v_mfma_f32_32x32x16_bf16 v[64:79], v[148:151], a[12:15], v[64:79]
    v_mfma_f32_32x32x16_bf16 v[96:111], v[132:135], a[20:23], v[96:111]
    v_mfma_f32_32x32x16_bf16 v[80:95], v[140:143], a[4:7], v[80:95]
    v_mfma_f32_32x32x16_bf16 v[112:127], v[156:159], a[4:7], v[112:127]
    v_mfma_f32_32x32x16_bf16 v[80:95], v[156:159], a[12:15], v[80:95]
    v_mfma_f32_32x32x16_bf16 v[112:127], v[140:143], a[20:23], v[112:127]
    v_pk_mul_f32 v[40:41], v[64:65], v[176:177]
    v_pk_mul_f32 v[42:43], v[96:97], v[176:177]
    v_pk_fma_f32 v[40:41], v[96:97], v[178:179], v[40:41]
    v_pk_fma_f32 v[42:43], v[64:65], v[178:179], v[42:43] neg_lo:[1,0,0] neg_hi:[1,0,0]
    v_cvt_pk_bf16_f32 v128, v40, v41
    v_cvt_pk_bf16_f32 v144, v42, v43
    v_cvt_pk_bf16_f32 v160, -v40, -v41
    v_pk_mul_f32 v[44:45], v[66:67], v[180:181]
    v_pk_mul_f32 v[46:47], v[98:99], v[180:181]
    v_pk_fma_f32 v[44:45], v[98:99], v[182:183], v[44:45]
    v_pk_fma_f32 v[46:47], v[66:67], v[182:183], v[46:47] neg_lo:[1,0,0] neg_hi:[1,0,0]
    v_cvt_pk_bf16_f32 v129, v44, v45
    v_cvt_pk_bf16_f32 v145, v46, v47
    v_cvt_pk_bf16_f32 v161, -v44, -v45
    v_pk_mul_f32 v[40:41], v[68:69], v[184:185]
    v_pk_mul_f32 v[42:43], v[100:101], v[184:185]
    v_pk_fma_f32 v[40:41], v[100:101], v[186:187], v[40:41]
    v_pk_fma_f32 v[42:43], v[68:69], v[186:187], v[42:43] neg_lo:[1,0,0] neg_hi:[1,0,0]
    v_cvt_pk_bf16_f32 v130, v40, v41
    v_cvt_pk_bf16_f32 v146, v42, v43
    v_cvt_pk_bf16_f32 v162, -v40, -v41
    v_pk_mul_f32 v[44:45], v[70:71], v[188:189]
    v_pk_mul_f32 v[46:47], v[102:103], v[188:189]
    v_pk_fma_f32 v[44:45], v[102:103], v[190:191], v[44:45]
    v_pk_fma_f32 v[46:47], v[70:71], v[190:191], v[46:47] neg_lo:[1,0,0] neg_hi:[1,0,0]
    v_cvt_pk_bf16_f32 v131, v44, v45
    v_cvt_pk_bf16_f32 v147, v46, v47
    v_cvt_pk_bf16_f32 v163, -v44, -v45
    v_pk_mul_f32 v[40:41], v[72:73], v[192:193]
    v_pk_mul_f32 v[42:43], v[104:105], v[192:193]
    v_pk_fma_f32 v[40:41], v[104:105], v[194:195], v[40:41]
    v_pk_fma_f32 v[42:43], v[72:73], v[194:195], v[42:43] neg_lo:[1,0,0] neg_hi:[1,0,0]
    v_cvt_pk_bf16_f32 v132, v40, v41
    v_cvt_pk_bf16_f32 v148, v42, v43
    v_cvt_pk_bf16_f32 v164, -v40, -v41
    v_pk_mul_f32 v[44:45], v[74:75], v[196:197]
    v_pk_mul_f32 v[46:47], v[106:107], v[196:197]
    v_pk_fma_f32 v[44:45], v[106:107], v[198:199], v[44:45]
    v_pk_fma_f32 v[46:47], v[74:75], v[198:199], v[46:47] neg_lo:[1,0,0] neg_hi:[1,0,0]
    v_cvt_pk_bf16_f32 v133, v44, v45
    v_cvt_pk_bf16_f32 v149, v46, v47
    v_cvt_pk_bf16_f32 v165, -v44, -v45
    v_pk_mul_f32 v[40:41], v[76:77], v[200:201]
    v_pk_mul_f32 v[42:43], v[108:109], v[200:201]
    v_pk_fma_f32 v[40:41], v[108:109], v[202:203], v[40:41]
    v_pk_fma_f32 v[42:43], v[76:77], v[202:203], v[42:43] neg_lo:[1,0,0] neg_hi:[1,0,0]
    v_cvt_pk_bf16_f32 v134, v40, v41
    v_cvt_pk_bf16_f32 v150, v42, v43
    v_cvt_pk_bf16_f32 v166, -v40, -v41
    v_pk_mul_f32 v[44:45], v[78:79], v[204:205]
    v_pk_mul_f32 v[46:47], v[110:111], v[204:205]
    v_pk_fma_f32 v[44:45], v[110:111], v[206:207], v[44:45]
    v_pk_fma_f32 v[46:47], v[78:79], v[206:207], v[46:47] neg_lo:[1,0,0] neg_hi:[1,0,0]
    v_cvt_pk_bf16_f32 v135, v44, v45
    v_cvt_pk_bf16_f32 v151, v46, v47
    v_cvt_pk_bf16_f32 v167, -v44, -v45
    v_pk_mul_f32 v[40:41], v[80:81], v[208:209]
    v_pk_mul_f32 v[42:43], v[112:113], v[208:209]
    v_pk_fma_f32 v[40:41], v[112:113], v[210:211], v[40:41]
    v_pk_fma_f32 v[42:43], v[80:81], v[210:211], v[42:43] neg_lo:[1,0,0] neg_hi:[1,0,0]
    v_cvt_pk_bf16_f32 v136, v40, v41
    v_cvt_pk_bf16_f32 v152, v42, v43
    v_cvt_pk_bf16_f32 v168, -v40, -v41
    v_pk_mul_f32 v[44:45], v[82:83], v[212:213]
    v_pk_mul_f32 v[46:47], v[114:115], v[212:213]
    v_pk_fma_f32 v[44:45], v[114:115], v[214:215], v[44:45]
    v_pk_fma_f32 v[46:47], v[82:83], v[214:215], v[46:47] neg_lo:[1,0,0] neg_hi:[1,0,0]
    v_cvt_pk_bf16_f32 v137, v44, v45
    v_cvt_pk_bf16_f32 v153, v46, v47
    v_cvt_pk_bf16_f32 v169, -v44, -v45
    v_pk_mul_f32 v[40:41], v[84:85], v[216:217]
    v_pk_mul_f32 v[42:43], v[116:117], v[216:217]
    v_pk_fma_f32 v[40:41], v[116:117], v[218:219], v[40:41]
    v_pk_fma_f32 v[42:43], v[84:85], v[218:219], v[42:43] neg_lo:[1,0,0] neg_hi:[1,0,0]
    v_cvt_pk_bf16_f32 v138, v40, v41
    v_cvt_pk_bf16_f32 v154, v42, v43
    v_cvt_pk_bf16_f32 v170, -v40, -v41
    v_pk_mul_f32 v[44:45], v[86:87], v[220:221]
    v_pk_mul_f32 v[46:47], v[118:119], v[220:221]
    v_pk_fma_f32 v[44:45], v[118:119], v[222:223], v[44:45]
    v_pk_fma_f32 v[46:47], v[86:87], v[222:223], v[46:47] neg_lo:[1,0,0] neg_hi:[1,0,0]
    v_cvt_pk_bf16_f32 v139, v44, v45
    v_cvt_pk_bf16_f32 v155, v46, v47
    v_cvt_pk_bf16_f32 v171, -v44, -v45
    v_pk_mul_f32 v[40:41], v[88:89], v[224:225]
    v_pk_mul_f32 v[42:43], v[120:121], v[224:225]
    v_pk_fma_f32 v[40:41], v[120:121], v[226:227], v[40:41]
    v_pk_fma_f32 v[42:43], v[88:89], v[226:227], v[42:43] neg_lo:[1,0,0] neg_hi:[1,0,0]
    v_cvt_pk_bf16_f32 v140, v40, v41
    v_cvt_pk_bf16_f32 v156, v42, v43
    v_cvt_pk_bf16_f32 v172, -v40, -v41
    v_pk_mul_f32 v[44:45], v[90:91], v[228:229]
    v_pk_mul_f32 v[46:47], v[122:123], v[228:229]
    v_pk_fma_f32 v[44:45], v[122:123], v[230:231], v[44:45]
    v_pk_fma_f32 v[46:47], v[90:91], v[230:231], v[46:47] neg_lo:[1,0,0] neg_hi:[1,0,0]
    v_cvt_pk_bf16_f32 v141, v44, v45
    v_cvt_pk_bf16_f32 v157, v46, v47
    v_cvt_pk_bf16_f32 v173, -v44, -v45
    v_pk_mul_f32 v[40:41], v[92:93], v[232:233]
    v_pk_mul_f32 v[42:43], v[124:125], v[232:233]
    v_pk_fma_f32 v[40:41], v[124:125], v[234:235], v[40:41]
    v_pk_fma_f32 v[42:43], v[92:93], v[234:235], v[42:43] neg_lo:[1,0,0] neg_hi:[1,0,0]
    v_cvt_pk_bf16_f32 v142, v40, v41
    v_cvt_pk_bf16_f32 v158, v42, v43
    v_cvt_pk_bf16_f32 v174, -v40, -v41
    v_pk_mul_f32 v[44:45], v[94:95], v[236:237]
    v_pk_mul_f32 v[46:47], v[126:127], v[236:237]
    v_pk_fma_f32 v[44:45], v[126:127], v[238:239], v[44:45]
    v_pk_fma_f32 v[46:47], v[94:95], v[238:239], v[46:47] neg_lo:[1,0,0] neg_hi:[1,0,0]
    v_cvt_pk_bf16_f32 v143, v44, v45
    v_cvt_pk_bf16_f32 v159, v46, v47
    v_cvt_pk_bf16_f32 v175, -v44, -v45
    v_mfma_f32_32x32x16_bf16 v[64:79], a[24:27], v[128:131], 0
    v_mfma_f32_32x32x16_bf16 v[96:111], a[24:27], v[144:147], 0
    v_mfma_f32_32x32x16_bf16 v[64:79], a[28:31], v[132:135], v[64:79]
    v_mfma_f32_32x32x16_bf16 v[96:111], a[28:31], v[148:151], v[96:111]
    v_mfma_f32_32x32x16_bf16 v[64:79], a[32:35], v[136:139], v[64:79]
    v_mfma_f32_32x32x16_bf16 v[96:111], a[32:35], v[152:155], v[96:111]
    v_mfma_f32_32x32x16_bf16 v[64:79], a[36:39], v[140:143], v[64:79]
    v_mfma_f32_32x32x16_bf16 v[96:111], a[36:39], v[156:159], v[96:111]
    v_mfma_f32_32x32x16_bf16 v[64:79], a[56:59], v[144:147], v[64:79]
    v_mfma_f32_32x32x16_bf16 v[96:111], a[56:59], v[160:163], v[96:111]
    v_mfma_f32_32x32x16_bf16 v[64:79], a[60:63], v[148:151], v[64:79]
    v_mfma_f32_32x32x16_bf16 v[96:111], a[60:63], v[164:167], v[96:111]
    v_mfma_f32_32x32x16_bf16 v[64:79], a[64:67], v[152:155], v[64:79]
    v_mfma_f32_32x32x16_bf16 v[96:111], a[64:67], v[168:171], v[96:111]
    v_mfma_f32_32x32x16_bf16 v[64:79], a[68:71], v[156:159], v[64:79]
    v_mfma_f32_32x32x16_bf16 v[96:111], a[68:71], v[172:175], v[96:111]
    v_mfma_f32_32x32x16_bf16 v[80:95], a[40:43], v[128:131], 0
    v_mfma_f32_32x32x16_bf16 v[112:127], a[40:43], v[144:147], 0
    v_lshlrev_b32 v48, 16, v0
    v_lshlrev_b32 v49, 16, v1
    v_and_b32 v50, 0xffff0000, v0
    v_and_b32 v51, 0xffff0000, v1
    v_mul_f32 v40, v64, v48
    v_mul_f32 v42, v96, v48
    v_mfma_f32_32x32x16_bf16 v[80:95], a[44:47], v[132:135], v[80:95]
    v_mul_f32 v41, v65, v49
    v_mul_f32 v43, v97, v49
    v_fma_f32 v40, -v96, v50, v40
    v_fma_f32 v42, v64, v50, v42
    v_fma_f32 v41, -v97, v51, v41
    v_fma_f32 v43, v65, v51, v43
    v_mfma_f32_32x32x16_bf16 v[112:127], a[44:47], v[148:151], v[112:127]
    v_cvt_pk_bf16_f32 v176, v40, v41
    v_cvt_pk_bf16_f32 v192, v42, v43
    v_cvt_pk_bf16_f32 v208, -v42, -v43
    v_lshlrev_b32 v52, 16, v2
    v_lshlrev_b32 v53, 16, v3
    v_and_b32 v54, 0xffff0000, v2
    v_mfma_f32_32x32x16_bf16 v[80:95], a[48:51], v[136:139], v[80:95]
    v_and_b32 v55, 0xffff0000, v3
    v_mul_f32 v44, v66, v52
    v_mul_f32 v46, v98, v52
    v_mul_f32 v45, v67, v53
    v_mul_f32 v47, v99, v53
    v_fma_f32 v44, -v98, v54, v44
    v_mfma_f32_32x32x16_bf16 v[112:127], a[48:51], v[152:155], v[112:127]
    v_fma_f32 v46, v66, v54, v46
    v_fma_f32 v45, -v99, v55, v45
    v_fma_f32 v47, v67, v55, v47
    v_cvt_pk_bf16_f32 v177, v44, v45
    v_cvt_pk_bf16_f32 v193, v46, v47
    v_cvt_pk_bf16_f32 v209, -v46, -v47
    v_mfma_f32_32x32x16_bf16 v[80:95], a[52:55], v[140:143], v[80:95]
    v_lshlrev_b32 v48, 16, v4
    v_lshlrev_b32 v49, 16, v5
    v_and_b32 v50, 0xffff0000, v4
    v_and_b32 v51, 0xffff0000, v5
    v_mul_f32 v40, v68, v48
    v_mul_f32 v42, v100, v48
    v_mfma_f32_32x32x16_bf16 v[112:127], a[52:55], v[156:159], v[112:127]
    v_mul_f32 v41, v69, v49
    v_mul_f32 v43, v101, v49
    v_fma_f32 v40, -v100, v50, v40
    v_fma_f32 v42, v68, v50, v42
    v_fma_f32 v41, -v101, v51, v41
    v_fma_f32 v43, v69, v51, v43
    v_mfma_f32_32x32x16_bf16 v[80:95], a[72:75], v[144:147], v[80:95]
    v_cvt_pk_bf16_f32 v178, v40, v41
    v_cvt_pk_bf16_f32 v194, v42, v43
    v_cvt_pk_bf16_f32 v210, -v42, -v43
    v_lshlrev_b32 v52, 16, v6
    v_lshlrev_b32 v53, 16, v7
    v_and_b32 v54, 0xffff0000, v6
    v_mfma_f32_32x32x16_bf16 v[112:127], a[72:75], v[160:163], v[112:127]
    v_and_b32 v55, 0xffff0000, v7
    v_mul_f32 v44, v70, v52
    v_mul_f32 v46, v102, v52
    v_mul_f32 v45, v71, v53
    v_mul_f32 v47, v103, v53
    v_fma_f32 v44, -v102, v54, v44
    v_mfma_f32_32x32x16_bf16 v[80:95], a[76:79], v[148:151], v[80:95]
    v_fma_f32 v46, v70, v54, v46
    v_fma_f32 v45, -v103, v55, v45
    v_fma_f32 v47, v71, v55, v47
    v_cvt_pk_bf16_f32 v179, v44, v45
    v_cvt_pk_bf16_f32 v195, v46, v47
    v_cvt_pk_bf16_f32 v211, -v46, -v47
    v_mfma_f32_32x32x16_bf16 v[112:127], a[76:79], v[164:167], v[112:127]
    v_lshlrev_b32 v48, 16, v8
    v_lshlrev_b32 v49, 16, v9
    v_and_b32 v50, 0xffff0000, v8
    v_and_b32 v51, 0xffff0000, v9
    v_mul_f32 v40, v72, v48
    v_mul_f32 v42, v104, v48
    v_mfma_f32_32x32x16_bf16 v[80:95], a[80:83], v[152:155], v[80:95]
    v_mul_f32 v41, v73, v49
    v_mul_f32 v43, v105, v49
    v_fma_f32 v40, -v104, v50, v40
    v_fma_f32 v42, v72, v50, v42
    v_fma_f32 v41, -v105, v51, v41
    v_fma_f32 v43, v73, v51, v43
    v_mfma_f32_32x32x16_bf16 v[112:127], a[80:83], v[168:171], v[112:127]
    v_cvt_pk_bf16_f32 v180, v40, v41
    v_cvt_pk_bf16_f32 v196, v42, v43
    v_cvt_pk_bf16_f32 v212, -v42, -v43
    v_lshlrev_b32 v52, 16, v10
    v_lshlrev_b32 v53, 16, v11
    v_and_b32 v54, 0xffff0000, v10
    v_mfma_f32_32x32x16_bf16 v[80:95], a[84:87], v[156:159], v[80:95]
    v_and_b32 v55, 0xffff0000, v11
    v_mul_f32 v44, v74, v52
    v_mul_f32 v46, v106, v52
    v_mul_f32 v45, v75, v53
    v_mul_f32 v47, v107, v53
    v_fma_f32 v44, -v106, v54, v44
    v_mfma_f32_32x32x16_bf16 v[112:127], a[84:87], v[172:175], v[112:127]
    v_fma_f32 v46, v74, v54, v46
    v_fma_f32 v45, -v107, v55, v45
    v_fma_f32 v47, v75, v55, v47
    v_cvt_pk_bf16_f32 v181, v44, v45
    v_cvt_pk_bf16_f32 v197, v46, v47
    v_cvt_pk_bf16_f32 v213, -v46, -v47
    v_lshlrev_b32 v48, 16, v12
    v_lshlrev_b32 v49, 16, v13
    v_and_b32 v50, 0xffff0000, v12
    v_and_b32 v51, 0xffff0000, v13
    v_mul_f32 v40, v76, v48
    v_mul_f32 v42, v108, v48
    v_mul_f32 v41, v77, v49
    v_mul_f32 v43, v109, v49
    v_fma_f32 v40, -v108, v50, v40
    v_fma_f32 v42, v76, v50, v42
    v_fma_f32 v41, -v109, v51, v41
    v_fma_f32 v43, v77, v51, v43
    v_cvt_pk_bf16_f32 v182, v40, v41
    v_cvt_pk_bf16_f32 v198, v42, v43
    v_cvt_pk_bf16_f32 v214, -v42, -v43
    v_lshlrev_b32 v52, 16, v14
    v_lshlrev_b32 v53, 16, v15
    v_and_b32 v54, 0xffff0000, v14
    v_and_b32 v55, 0xffff0000, v15
    v_mul_f32 v44, v78, v52
    v_mul_f32 v46, v110, v52
    v_mul_f32 v45, v79, v53
    v_mul_f32 v47, v111, v53
    v_fma_f32 v44, -v110, v54, v44
    v_fma_f32 v46, v78, v54, v46
    v_fma_f32 v45, -v111, v55, v45
    v_fma_f32 v47, v79, v55, v47
    v_cvt_pk_bf16_f32 v183, v44, v45
    v_cvt_pk_bf16_f32 v199, v46, v47
    v_cvt_pk_bf16_f32 v215, -v46, -v47
    v_lshlrev_b32 v48, 16, v16
    v_lshlrev_b32 v49, 16, v17
    v_and_b32 v50, 0xffff0000, v16
    v_and_b32 v51, 0xffff0000, v17
    v_pk_mul_f32 v[40:41], v[80:81], v[48:49]
    v_pk_mul_f32 v[42:43], v[112:113], v[48:49]
    v_pk_fma_f32 v[40:41], v[112:113], v[50:51], v[40:41] neg_lo:[1,0,0] neg_hi:[1,0,0]
    v_pk_fma_f32 v[42:43], v[80:81], v[50:51], v[42:43]
    v_cvt_pk_bf16_f32 v184, v40, v41
    v_cvt_pk_bf16_f32 v200, v42, v43
    v_cvt_pk_bf16_f32 v216, -v42, -v43
    v_lshlrev_b32 v52, 16, v18
    v_lshlrev_b32 v53, 16, v19
    v_and_b32 v54, 0xffff0000, v18
    v_and_b32 v55, 0xffff0000, v19
    v_pk_mul_f32 v[44:45], v[82:83], v[52:53]
    v_pk_mul_f32 v[46:47], v[114:115], v[52:53]
    v_pk_fma_f32 v[44:45], v[114:115], v[54:55], v[44:45] neg_lo:[1,0,0] neg_hi:[1,0,0]
    v_pk_fma_f32 v[46:47], v[82:83], v[54:55], v[46:47]
    v_cvt_pk_bf16_f32 v185, v44, v45
    v_cvt_pk_bf16_f32 v201, v46, v47
    v_cvt_pk_bf16_f32 v217, -v46, -v47
    v_lshlrev_b32 v48, 16, v20
    v_lshlrev_b32 v49, 16, v21
    v_and_b32 v50, 0xffff0000, v20
    v_and_b32 v51, 0xffff0000, v21
    v_pk_mul_f32 v[40:41], v[84:85], v[48:49]
    v_pk_mul_f32 v[42:43], v[116:117], v[48:49]
    v_pk_fma_f32 v[40:41], v[116:117], v[50:51], v[40:41] neg_lo:[1,0,0] neg_hi:[1,0,0]
    v_pk_fma_f32 v[42:43], v[84:85], v[50:51], v[42:43]
    v_cvt_pk_bf16_f32 v186, v40, v41
    v_cvt_pk_bf16_f32 v202, v42, v43
    v_cvt_pk_bf16_f32 v218, -v42, -v43
    v_lshlrev_b32 v52, 16, v22
    v_lshlrev_b32 v53, 16, v23
    v_and_b32 v54, 0xffff0000, v22
    v_and_b32 v55, 0xffff0000, v23
    v_pk_mul_f32 v[44:45], v[86:87], v[52:53]
    v_pk_mul_f32 v[46:47], v[118:119], v[52:53]
    v_pk_fma_f32 v[44:45], v[118:119], v[54:55], v[44:45] neg_lo:[1,0,0] neg_hi:[1,0,0]
    v_pk_fma_f32 v[46:47], v[86:87], v[54:55], v[46:47]
    v_cvt_pk_bf16_f32 v187, v44, v45
    v_cvt_pk_bf16_f32 v203, v46, v47
    v_cvt_pk_bf16_f32 v219, -v46, -v47
    v_lshlrev_b32 v48, 16, v24
    v_lshlrev_b32 v49, 16, v25
    v_and_b32 v50, 0xffff0000, v24
    v_and_b32 v51, 0xffff0000, v25
    v_pk_mul_f32 v[40:41], v[88:89], v[48:49]
    v_pk_mul_f32 v[42:43], v[120:121], v[48:49]
    v_pk_fma_f32 v[40:41], v[120:121], v[50:51], v[40:41] neg_lo:[1,0,0] neg_hi:[1,0,0]
    v_pk_fma_f32 v[42:43], v[88:89], v[50:51], v[42:43]
    v_cvt_pk_bf16_f32 v188, v40, v41
    v_cvt_pk_bf16_f32 v204, v42, v43
    v_cvt_pk_bf16_f32 v220, -v42, -v43
    v_lshlrev_b32 v52, 16, v26
    v_lshlrev_b32 v53, 16, v27
    v_and_b32 v54, 0xffff0000, v26
    v_and_b32 v55, 0xffff0000, v27
    v_pk_mul_f32 v[44:45], v[90:91], v[52:53]
    v_pk_mul_f32 v[46:47], v[122:123], v[52:53]
    v_pk_fma_f32 v[44:45], v[122:123], v[54:55], v[44:45] neg_lo:[1,0,0] neg_hi:[1,0,0]
    v_pk_fma_f32 v[46:47], v[90:91], v[54:55], v[46:47]
    v_cvt_pk_bf16_f32 v189, v44, v45
    v_cvt_pk_bf16_f32 v205, v46, v47
    v_cvt_pk_bf16_f32 v221, -v46, -v47
    v_lshlrev_b32 v48, 16, v28
    v_lshlrev_b32 v49, 16, v29
    v_and_b32 v50, 0xffff0000, v28
    v_and_b32 v51, 0xffff0000, v29
    v_pk_mul_f32 v[40:41], v[92:93], v[48:49]
    v_pk_mul_f32 v[42:43], v[124:125], v[48:49]
    v_pk_fma_f32 v[40:41], v[124:125], v[50:51], v[40:41] neg_lo:[1,0,0] neg_hi:[1,0,0]
    v_pk_fma_f32 v[42:43], v[92:93], v[50:51], v[42:43]
    v_cvt_pk_bf16_f32 v190, v40, v41
    v_cvt_pk_bf16_f32 v206, v42, v43
    v_cvt_pk_bf16_f32 v222, -v42, -v43
    v_lshlrev_b32 v52, 16, v30
    v_lshlrev_b32 v53, 16, v31
    v_and_b32 v54, 0xffff0000, v30
    v_and_b32 v55, 0xffff0000, v31
    v_pk_mul_f32 v[44:45], v[94:95], v[52:53]
    v_pk_mul_f32 v[46:47], v[126:127], v[52:53]
    v_pk_fma_f32 v[44:45], v[126:127], v[54:55], v[44:45] neg_lo:[1,0,0] neg_hi:[1,0,0]
    v_pk_fma_f32 v[46:47], v[94:95], v[54:55], v[46:47]
    v_cvt_pk_bf16_f32 v191, v44, v45
    v_cvt_pk_bf16_f32 v207, v46, v47
    v_cvt_pk_bf16_f32 v223, -v46, -v47
    v_mfma_f32_32x32x16_bf16 v[64:79], v[176:179], a[24:27], 0
    v_accvgpr_read_b32 v128, a96
    v_accvgpr_read_b32 v129, a97
    v_accvgpr_read_b32 v130, a98
    v_accvgpr_read_b32 v131, a99
    v_accvgpr_read_b32 v132, a100
    v_mfma_f32_32x32x16_bf16 v[96:111], v[192:195], a[24:27], 0
    v_accvgpr_read_b32 v133, a101
    v_accvgpr_read_b32 v134, a102
    v_accvgpr_read_b32 v135, a103
    v_accvgpr_read_b32 v136, a104
    v_accvgpr_read_b32 v137, a105
    v_mfma_f32_32x32x16_bf16 v[64:79], v[180:183], a[28:31], v[64:79]
    v_accvgpr_read_b32 v138, a106
    v_accvgpr_read_b32 v139, a107
    v_accvgpr_read_b32 v140, a108
    v_accvgpr_read_b32 v141, a109
    v_accvgpr_read_b32 v142, a110
    v_mfma_f32_32x32x16_bf16 v[96:111], v[196:199], a[28:31], v[96:111]
    v_accvgpr_read_b32 v143, a111
    v_accvgpr_read_b32 v144, a112
    v_accvgpr_read_b32 v145, a113
    v_accvgpr_read_b32 v146, a114
    v_accvgpr_read_b32 v147, a115
    v_mfma_f32_32x32x16_bf16 v[64:79], v[184:187], a[32:35], v[64:79]
    v_accvgpr_read_b32 v148, a116
    v_accvgpr_read_b32 v149, a117
    v_accvgpr_read_b32 v150, a118
    v_accvgpr_read_b32 v151, a119
    v_accvgpr_read_b32 v152, a120
    v_mfma_f32_32x32x16_bf16 v[96:111], v[200:203], a[32:35], v[96:111]
    v_accvgpr_read_b32 v153, a121
    v_accvgpr_read_b32 v154, a122
    v_accvgpr_read_b32 v155, a123
    v_accvgpr_read_b32 v156, a124
    v_accvgpr_read_b32 v157, a125
    v_mfma_f32_32x32x16_bf16 v[64:79], v[188:191], a[36:39], v[64:79]
    v_accvgpr_read_b32 v158, a126
    v_accvgpr_read_b32 v159, a127
    v_accvgpr_read_b32 v160, a128
    v_accvgpr_read_b32 v161, a129
    v_accvgpr_read_b32 v162, a130
    v_mfma_f32_32x32x16_bf16 v[96:111], v[204:207], a[36:39], v[96:111]
    v_accvgpr_read_b32 v163, a131
    v_accvgpr_read_b32 v164, a132
    v_accvgpr_read_b32 v165, a133
    v_accvgpr_read_b32 v166, a134
    v_accvgpr_read_b32 v167, a135
    v_mfma_f32_32x32x16_bf16 v[64:79], v[208:211], a[56:59], v[64:79]
    v_accvgpr_read_b32 v168, a136
    v_accvgpr_read_b32 v169, a137
    v_accvgpr_read_b32 v170, a138
    v_accvgpr_read_b32 v171, a139
    v_accvgpr_read_b32 v172, a140
    v_mfma_f32_32x32x16_bf16 v[96:111], v[176:179], a[56:59], v[96:111]
    v_accvgpr_read_b32 v173, a141
    v_accvgpr_read_b32 v174, a142
    v_accvgpr_read_b32 v175, a143
    v_accvgpr_read_b32 v240, a144
    v_accvgpr_read_b32 v241, a145
    v_mfma_f32_32x32x16_bf16 v[64:79], v[212:215], a[60:63], v[64:79]
    v_accvgpr_read_b32 v242, a146
    v_accvgpr_read_b32 v243, a147
    v_accvgpr_read_b32 v244, a148
    v_accvgpr_read_b32 v245, a149
    v_accvgpr_read_b32 v246, a150
    v_mfma_f32_32x32x16_bf16 v[96:111], v[180:183], a[60:63], v[96:111]
    v_accvgpr_read_b32 v247, a151
    v_accvgpr_read_b32 v248, a152
    v_accvgpr_read_b32 v249, a153
    v_accvgpr_read_b32 v250, a154
    v_accvgpr_read_b32 v251, a155
    v_mfma_f32_32x32x16_bf16 v[64:79], v[216:219], a[64:67], v[64:79]
    v_accvgpr_read_b32 v252, a156
    v_accvgpr_read_b32 v253, a157
    v_accvgpr_read_b32 v254, a158
    v_accvgpr_read_b32 v255, a159
    v_mfma_f32_32x32x16_bf16 v[96:111], v[184:187], a[64:67], v[96:111]
    v_mfma_f32_32x32x16_bf16 v[64:79], v[220:223], a[68:71], v[64:79]
    v_mfma_f32_32x32x16_bf16 v[96:111], v[188:191], a[68:71], v[96:111]
    v_mfma_f32_32x32x16_bf16 v[80:95], v[176:179], a[40:43], 0
    v_mfma_f32_32x32x16_bf16 v[112:127], v[192:195], a[40:43], 0
    v_mul_f32 v40, v64, v128
    v_mul_f32 v42, v96, v128
    v_mul_f32 v41, v65, v129
    v_mul_f32 v43, v97, v129
    v_fma_f32 v40, -v96, v130, v40
    v_fma_f32 v42, v64, v130, v42
    v_mfma_f32_32x32x16_bf16 v[80:95], v[180:183], a[44:47], v[80:95]
    v_fma_f32 v41, -v97, v131, v41
    v_fma_f32 v43, v65, v131, v43
    v_cvt_pk_bf16_f32 v0, v40, v41
    v_cvt_pk_bf16_f32 v16, v42, v43
    v_mul_f32 v44, v66, v132
    v_mul_f32 v46, v98, v132
    v_mfma_f32_32x32x16_bf16 v[112:127], v[196:199], a[44:47], v[112:127]
    v_mul_f32 v45, v67, v133
    v_mul_f32 v47, v99, v133
    v_fma_f32 v44, -v98, v134, v44
    v_fma_f32 v46, v66, v134, v46
    v_fma_f32 v45, -v99, v135, v45
    v_fma_f32 v47, v67, v135, v47
    v_mfma_f32_32x32x16_bf16 v[80:95], v[184:187], a[48:51], v[80:95]
    v_cvt_pk_bf16_f32 v1, v44, v45
    v_cvt_pk_bf16_f32 v17, v46, v47
    v_mul_f32 v40, v68, v136
    v_mul_f32 v42, v100, v136
    v_mul_f32 v41, v69, v137
    v_mul_f32 v43, v101, v137
    v_mfma_f32_32x32x16_bf16 v[112:127], v[200:203], a[48:51], v[112:127]
    v_fma_f32 v40, -v100, v138, v40
    v_fma_f32 v42, v68, v138, v42
    v_fma_f32 v41, -v101, v139, v41
    v_fma_f32 v43, v69, v139, v43
    v_cvt_pk_bf16_f32 v2, v40, v41
    v_cvt_pk_bf16_f32 v18, v42, v43
    v_mfma_f32_32x32x16_bf16 v[80:95], v[188:191], a[52:55], v[80:95]
    v_mul_f32 v44, v70, v140
    v_mul_f32 v46, v102, v140
    v_mul_f32 v45, v71, v141
    v_mul_f32 v47, v103, v141
    v_fma_f32 v44, -v102, v142, v44
    v_fma_f32 v46, v70, v142, v46
    v_mfma_f32_32x32x16_bf16 v[112:127], v[204:207], a[52:55], v[112:127]
    v_fma_f32 v45, -v103, v143, v45
    v_fma_f32 v47, v71, v143, v47
    v_cvt_pk_bf16_f32 v3, v44, v45
    v_cvt_pk_bf16_f32 v19, v46, v47
    v_mul_f32 v40, v72, v144
    v_mul_f32 v42, v104, v144
    v_mfma_f32_32x32x16_bf16 v[80:95], v[208:211], a[72:75], v[80:95]
    v_mul_f32 v41, v73, v145
    v_mul_f32 v43, v105, v145
    v_fma_f32 v40, -v104, v146, v40
    v_fma_f32 v42, v72, v146, v42
    v_fma_f32 v41, -v105, v147, v41
    v_fma_f32 v43, v73, v147, v43
    v_mfma_f32_32x32x16_bf16 v[112:127], v[176:179], a[72:75], v[112:127]
    v_cvt_pk_bf16_f32 v4, v40, v41
    v_cvt_pk_bf16_f32 v20, v42, v43
    v_mul_f32 v44, v74, v148
    v_mul_f32 v46, v106, v148
    v_mul_f32 v45, v75, v149
    v_mul_f32 v47, v107, v149
    v_mfma_f32_32x32x16_bf16 v[80:95], v[212:215], a[76:79], v[80:95]
    v_fma_f32 v44, -v106, v150, v44
    v_fma_f32 v46, v74, v150, v46
    v_fma_f32 v45, -v107, v151, v45
    v_fma_f32 v47, v75, v151, v47
    v_cvt_pk_bf16_f32 v5, v44, v45
    v_cvt_pk_bf16_f32 v21, v46, v47
    v_mfma_f32_32x32x16_bf16 v[112:127], v[180:183], a[76:79], v[112:127]
    v_mul_f32 v40, v76, v152
    v_mul_f32 v42, v108, v152
    v_mul_f32 v41, v77, v153
    v_mul_f32 v43, v109, v153
    v_fma_f32 v40, -v108, v154, v40
    v_fma_f32 v42, v76, v154, v42
    v_mfma_f32_32x32x16_bf16 v[80:95], v[216:219], a[80:83], v[80:95]
    v_fma_f32 v41, -v109, v155, v41
    v_fma_f32 v43, v77, v155, v43
    v_cvt_pk_bf16_f32 v6, v40, v41
    v_cvt_pk_bf16_f32 v22, v42, v43
    v_mul_f32 v44, v78, v156
    v_mul_f32 v46, v110, v156
    v_mfma_f32_32x32x16_bf16 v[112:127], v[184:187], a[80:83], v[112:127]
    v_mul_f32 v45, v79, v157
    v_mul_f32 v47, v111, v157
    v_fma_f32 v44, -v110, v158, v44
    v_fma_f32 v46, v78, v158, v46
    v_fma_f32 v45, -v111, v159, v45
    v_fma_f32 v47, v79, v159, v47
    v_mfma_f32_32x32x16_bf16 v[80:95], v[220:223], a[84:87], v[80:95]
    v_cvt_pk_bf16_f32 v7, v44, v45
    v_cvt_pk_bf16_f32 v23, v46, v47
    v_mfma_f32_32x32x16_bf16 v[112:127], v[188:191], a[84:87], v[112:127]
    v_mfma_f32_32x32x16_bf16 v[64:79], v[0:3], a[0:3], 0
    v_mfma_f32_32x32x16_bf16 v[96:111], v[16:19], a[0:3], 0
    v_mul_f32 v40, v80, v160
    v_mul_f32 v42, v112, v160
    v_mul_f32 v41, v81, v161
    v_mul_f32 v43, v113, v161
    v_fma_f32 v40, -v112, v162, v40
    v_fma_f32 v42, v80, v162, v42
    v_mfma_f32_32x32x16_bf16 v[64:79], v[4:7], a[4:7], v[64:79]
    v_fma_f32 v41, -v113, v163, v41
    v_fma_f32 v43, v81, v163, v43
    v_cvt_pk_bf16_f32 v8, v40, v41
    v_cvt_pk_bf16_f32 v24, v42, v43
    v_mul_f32 v44, v82, v164
    v_mul_f32 v46, v114, v164
    v_mfma_f32_32x32x16_bf16 v[96:111], v[20:23], a[4:7], v[96:111]
    v_mul_f32 v45, v83, v165
    v_mul_f32 v47, v115, v165
    v_fma_f32 v44, -v114, v166, v44
    v_fma_f32 v46, v82, v166, v46
    v_fma_f32 v45, -v115, v167, v45
    v_fma_f32 v47, v83, v167, v47
    v_mfma_f32_32x32x16_bf16 v[64:79], v[16:19], a[16:19], v[64:79]
    v_cvt_pk_bf16_f32 v9, v44, v45
    v_cvt_pk_bf16_f32 v25, v46, v47
    v_mul_f32 v40, v84, v168
    v_mul_f32 v42, v116, v168
    v_mul_f32 v41, v85, v169
    v_mul_f32 v43, v117, v169
    v_mfma_f32_32x32x16_bf16 v[96:111], v[0:3], a[8:11], v[96:111]
    v_fma_f32 v40, -v116, v170, v40
    v_fma_f32 v42, v84, v170, v42
    v_fma_f32 v41, -v117, v171, v41
    v_fma_f32 v43, v85, v171, v43
    v_cvt_pk_bf16_f32 v10, v40, v41
    v_cvt_pk_bf16_f32 v26, v42, v43
    v_mfma_f32_32x32x16_bf16 v[64:79], v[20:23], a[20:23], v[64:79]
    v_mul_f32 v44, v86, v172
    v_mul_f32 v46, v118, v172
    v_mul_f32 v45, v87, v173
    v_mul_f32 v47, v119, v173
    v_fma_f32 v44, -v118, v174, v44
    v_fma_f32 v46, v86, v174, v46
    v_mfma_f32_32x32x16_bf16 v[96:111], v[4:7], a[12:15], v[96:111]
    v_fma_f32 v45, -v119, v175, v45
    v_fma_f32 v47, v87, v175, v47
    v_cvt_pk_bf16_f32 v11, v44, v45
    v_cvt_pk_bf16_f32 v27, v46, v47
    v_pk_mul_f32 v[40:41], v[88:89], v[240:241]
    v_pk_mul_f32 v[42:43], v[120:121], v[240:241]
    v_pk_fma_f32 v[40:41], v[120:121], v[242:243], v[40:41] neg_lo:[1,0,0] neg_hi:[1,0,0]
    v_pk_fma_f32 v[42:43], v[88:89], v[242:243], v[42:43]
    v_cvt_pk_bf16_f32 v12, v40, v41
    v_cvt_pk_bf16_f32 v28, v42, v43
    v_pk_mul_f32 v[44:45], v[90:91], v[244:245]
    v_pk_mul_f32 v[46:47], v[122:123], v[244:245]
    v_pk_fma_f32 v[44:45], v[122:123], v[246:247], v[44:45] neg_lo:[1,0,0] neg_hi:[1,0,0]
    v_pk_fma_f32 v[46:47], v[90:91], v[246:247], v[46:47]
    v_cvt_pk_bf16_f32 v13, v44, v45
    v_cvt_pk_bf16_f32 v29, v46, v47
    v_pk_mul_f32 v[40:41], v[92:93], v[248:249]
    v_pk_mul_f32 v[42:43], v[124:125], v[248:249]
    v_pk_fma_f32 v[40:41], v[124:125], v[250:251], v[40:41] neg_lo:[1,0,0] neg_hi:[1,0,0]
    v_pk_fma_f32 v[42:43], v[92:93], v[250:251], v[42:43]
    v_cvt_pk_bf16_f32 v14, v40, v41
    v_cvt_pk_bf16_f32 v30, v42, v43
    v_pk_mul_f32 v[44:45], v[94:95], v[252:253]
    v_pk_mul_f32 v[46:47], v[126:127], v[252:253]
    v_pk_fma_f32 v[44:45], v[126:127], v[254:255], v[44:45] neg_lo:[1,0,0] neg_hi:[1,0,0]
    v_pk_fma_f32 v[46:47], v[94:95], v[254:255], v[46:47]
    v_cvt_pk_bf16_f32 v15, v44, v45
    v_cvt_pk_bf16_f32 v31, v46, v47
    v_mfma_f32_32x32x16_bf16 v[80:95], v[8:11], a[0:3], 0
    v_mfma_f32_32x32x16_bf16 v[112:127], v[24:27], a[0:3], 0
    v_cvt_pk_bf16_f32 v128, v64, v65
    v_cvt_pk_bf16_f32 v129, v66, v67
    v_cvt_pk_bf16_f32 v130, v68, v69
    v_cvt_pk_bf16_f32 v131, v70, v71
    v_mfma_f32_32x32x16_bf16 v[80:95], v[12:15], a[4:7], v[80:95]
    v_xor_b32 v38, 0, v35
    ds_write_b128 v38, v[128:131]
    v_cvt_pk_bf16_f32 v132, v72, v73
    v_cvt_pk_bf16_f32 v133, v74, v75
    v_mfma_f32_32x32x16_bf16 v[112:127], v[28:31], a[4:7], v[112:127]
    v_cvt_pk_bf16_f32 v134, v76, v77
    v_cvt_pk_bf16_f32 v135, v78, v79
    v_xor_b32 v39, 16, v35
    ds_write_b128 v39, v[132:135]
    v_mfma_f32_32x32x16_bf16 v[80:95], v[24:27], a[16:19], v[80:95]
    v_cvt_pk_bf16_f32 v144, v96, v97
    v_cvt_pk_bf16_f32 v145, v98, v99
    v_cvt_pk_bf16_f32 v146, v100, v101
    v_cvt_pk_bf16_f32 v147, v102, v103
    v_mfma_f32_32x32x16_bf16 v[112:127], v[8:11], a[8:11], v[112:127]
    v_xor_b32 v38, 64, v35
    ds_write_b128 v38, v[144:147]
    v_cvt_pk_bf16_f32 v148, v104, v105
    v_cvt_pk_bf16_f32 v149, v106, v107
    v_mfma_f32_32x32x16_bf16 v[80:95], v[28:31], a[20:23], v[80:95]
    v_cvt_pk_bf16_f32 v150, v108, v109
    v_cvt_pk_bf16_f32 v151, v110, v111
    v_xor_b32 v39, 80, v35
    ds_write_b128 v39, v[148:151]
    v_mfma_f32_32x32x16_bf16 v[112:127], v[12:15], a[12:15], v[112:127]
    s_add_u32 s12, s12, 90177536
    s_nop 2
    v_cvt_pk_bf16_f32 v136, v80, v81
    v_cvt_pk_bf16_f32 v137, v82, v83
    v_cvt_pk_bf16_f32 v138, v84, v85
    v_cvt_pk_bf16_f32 v139, v86, v87
    v_xor_b32 v38, 32, v35
    ds_write_b128 v38, v[136:139]
    v_cvt_pk_bf16_f32 v140, v88, v89
    v_cvt_pk_bf16_f32 v141, v90, v91
    v_cvt_pk_bf16_f32 v142, v92, v93
    v_cvt_pk_bf16_f32 v143, v94, v95
    v_xor_b32 v39, 48, v35
    ds_write_b128 v39, v[140:143]
    v_cvt_pk_bf16_f32 v152, v112, v113
    v_cvt_pk_bf16_f32 v153, v114, v115
    v_cvt_pk_bf16_f32 v154, v116, v117
    v_cvt_pk_bf16_f32 v155, v118, v119
    v_xor_b32 v38, 96, v35
    ds_write_b128 v38, v[152:155]
    v_cvt_pk_bf16_f32 v156, v120, v121
    v_cvt_pk_bf16_f32 v157, v122, v123
    v_cvt_pk_bf16_f32 v158, v124, v125
    v_cvt_pk_bf16_f32 v159, v126, v127
    v_xor_b32 v39, 112, v35
    ds_write_b128 v39, v[156:159]
    ds_read_b128 v[0:3], v36 offset:0
    ds_read_b128 v[4:7], v37 offset:1024
    ds_read_b128 v[8:11], v36 offset:2048
    ds_read_b128 v[12:15], v37 offset:3072
    ds_read_b128 v[16:19], v36 offset:4096
    ds_read_b128 v[20:23], v37 offset:5120
    ds_read_b128 v[24:27], v36 offset:6144
    ds_read_b128 v[28:31], v37 offset:7168
    s_mov_b64 exec, s[14:15]
    s_waitcnt lgkmcnt(7)
    buffer_store_dwordx4 v[0:3], v32, s[20:23], s12 offen offset:0 sc1
    s_waitcnt lgkmcnt(6)
    buffer_store_dwordx4 v[4:7], v32, s[20:23], s12 offen offset:1024 sc1
    s_waitcnt lgkmcnt(5)
    buffer_store_dwordx4 v[8:11], v32, s[20:23], s12 offen offset:2048 sc1
    s_waitcnt lgkmcnt(4)
    buffer_store_dwordx4 v[12:15], v32, s[20:23], s12 offen offset:3072 sc1
    s_add_u32 s12, s12, 4096
    s_waitcnt lgkmcnt(3)
    buffer_store_dwordx4 v[16:19], v32, s[20:23], s12 offen offset:0 sc1
    s_waitcnt lgkmcnt(2)
    buffer_store_dwordx4 v[20:23], v32, s[20:23], s12 offen offset:1024 sc1
    s_waitcnt lgkmcnt(1)
    buffer_store_dwordx4 v[24:27], v32, s[20:23], s12 offen offset:2048 sc1
    s_waitcnt lgkmcnt(0)
    buffer_store_dwordx4 v[28:31], v32, s[20:23], s12 offen offset:3072 sc1
    s_mov_b64 exec, -1
M_L5_end2:
    s_lshl_b32 s7, s40, 5
    s_add_u32 s7, s7, 93917184
    s_waitcnt vmcnt(0)
    s_barrier
    s_cmp_lg_u32 s5, 0
    s_cbranch_scc1 p2_31b
    v_mov_b32 v38, 2
    s_mov_b64 exec, 1
    buffer_store_dword v38, off, s[20:23], s7 sc1
    s_mov_b64 exec, -1
p2_31b:
M_L5_end:
    s_cmp_eq_u32 s95, 1
    s_cbranch_scc1 M_end
    s_add_u32 s95, s95, 1
    s_add_u32 s20, s20, 100663296
    s_addc_u32 s21, s21, 0
    s_mov_b32 s22, 167772160
    s_add_u32 s24, s20, 96468992
    s_addc_u32 s25, s21, 0
    s_cmp_eq_u32 s41, 0
    s_cbranch_scc1 M_C
    s_branch M_L5
.section .rodata,"a"
.p2align 6
.amdhsa_kernel interleave_layers__memory_aug_recurrent_mem_tr__spectral_gfnet__prompt_kernel
  .amdhsa_next_free_vgpr 512
  .amdhsa_next_free_sgpr 102
  .amdhsa_accum_offset 256
  .amdhsa_group_segment_fixed_size 0
  .amdhsa_kernarg_size 104
  .amdhsa_user_sgpr_count 2
  .amdhsa_user_sgpr_kernarg_segment_ptr 1
  .amdhsa_system_sgpr_workgroup_id_x 1
.end_amdhsa_kernel
```
